```python
import torch

def _softmax(x, axis=-1):
    return torch.softmax(x, dim=axis)

def _gelu(x):
    return torch.nn.functional.gelu(x, approximate='tanh')

def _silu(x):
    return torch.nn.functional.silu(x)

def _sigmoid(x):
    return torch.sigmoid(x)

def _layernorm(x, axis=-1, eps=1e-05):
    m = x.mean(dim=axis, keepdim=True)
    v = x.var(dim=axis, keepdim=True, unbiased=False)
    return (x - m) / torch.sqrt(v + eps)

def _scatter_add(tgt, idx, src, axis=0):
    return tgt.clone().index_add_(axis, idx, src)

def _segment_sum(src, seg, n):
    out = torch.zeros((n,) + src.shape[1:], dtype=src.dtype)
    return out.index_add_(0, seg, src)

def _pad(x, pw):
    flat = tuple((v for pair in reversed(pw) for v in pair))
    return torch.nn.functional.pad(x, flat)
kernel_name = 'adaLN_cond__spectral_gfnet__glu_gated_bilinear__prompt'

def setup_inputs():

    _w = lambda a: (lambda t: t.to(torch.bfloat16) if t.is_floating_point() else t)(torch.as_tensor(a))

    def _A_setup():
        B, S, D = (1, 2048, 576)
        Df = D // 2 + 1
        return {'x': _w((lambda *s: torch.randn(*s, dtype=torch.bfloat16) * 0.05)(B, S, D)), 'w_r': _w((lambda *s: torch.randn(*s, dtype=torch.bfloat16) * 3.2)(S, Df) * 0.02), 'w_i': _w((lambda *s: torch.randn(*s, dtype=torch.bfloat16) * 3.2)(S, Df) * 0.02)}
    _A_in = _A_setup()

    def _B_setup():
        B, S, D, F = (1, 2048, 576, 4608)
        return {'x': _w((lambda *s: torch.randn(*s, dtype=torch.bfloat16) * 0.05)(B, S, D)), 'w_gate': _w((lambda *s: torch.randn(*s, dtype=torch.bfloat16) * 0.4)(D, F) * D ** (-0.5)), 'w_up': _w((lambda *s: torch.randn(*s, dtype=torch.bfloat16) * 0.4)(D, F) * D ** (-0.5)), 'w_down': _w((lambda *s: torch.randn(*s, dtype=torch.bfloat16) * 0.4)(F, D) * F ** (-0.5))}
    _B_in = _B_setup()
    return {'A_x': _A_in['x'], 'A_w_r': _A_in['w_r'], 'A_w_i': _A_in['w_i'], 'B_x': _B_in['x'], 'B_w_gate': _B_in['w_gate'], 'B_w_up': _B_in['w_up'], 'B_w_down': _B_in['w_down'], 'c': _w((lambda *s: torch.randn(*s, dtype=torch.bfloat16) * 0.1)(1, 576) * 8.0), 'w_mod': _w((lambda *s: torch.randn(*s, dtype=torch.bfloat16) * 0.1)(576, 6 * 576) * 576 ** (-0.5) * 8.0)}

def reference(A_x, A_w_r, A_w_i, B_x, B_w_gate, B_w_up, B_w_down, c, w_mod):

    def _A_ref(x, w_r, w_i):
        B, S, D = x.shape
        X = (lambda x, axes=(-2, -1): torch.fft.rfft2(x.float(), dim=axes))(x, axes=(-2, -1))
        W = w_r + 1j * w_i
        X = X * W
        y = (lambda x, s, axes=(-2, -1): torch.fft.irfft2(x, s=s, dim=axes).to(torch.bfloat16))(X, (S, D), axes=(-2, -1))
        return y

    def _B_ref(x, w_gate, w_up, w_down):
        g = torch.einsum('bsd,df->bsf', x, w_gate)
        u = torch.einsum('bsd,df->bsf', x, w_up)
        h = g * u
        return torch.einsum('bsf,fd->bsd', h, w_down)
    x = A_x
    mod = (_silu(c) @ w_mod).reshape(c.shape[0], 6, 1, -1)
    sa, ca, ga, sb, cb, gb = (mod[:, 0].clone(), mod[:, 1].clone(), mod[:, 2].clone(), mod[:, 3].clone(), mod[:, 4].clone(), mod[:, 5].clone())
    h = _layernorm(x, axis=-1) * (1 + ca) + sa
    x = x + ga * _A_ref(h, A_w_r, A_w_i)
    h = _layernorm(x, axis=-1) * (1 + cb) + sb
    x = x + gb * _B_ref(h, B_w_gate, B_w_up, B_w_down)
    return x
```

```asm
; @launch kernel=k1_kernel grid=(256,1,1) block=(384,1,1) lds=42240
; @launch kernel=k2_kernel grid=(578,1,1) block=(64,1,1) lds=4096
; @launch kernel=k3_kernel grid=(256,1,1) block=(576,1,1) lds=38144
; @launch kernel=k4_kernel grid=(256,1,1) block=(512,1,1) lds=163840
.amdgcn_target "amdgcn-amd-amdhsa--gfx950"
.text
.globl k1_kernel
.p2align 8
.type k1_kernel,@function
k1_kernel:
    s_cmp_ge_u32 s2, 256
    s_cbranch_scc1 K1_end
    s_cmp_ge_u32 s2, 64
    s_cbranch_scc1 K1_cons
    s_load_dwordx4 s[4:7], s[0:1], 56
    s_load_dwordx4 s[8:11], s[0:1], 80
    s_load_dwordx4 s[44:47], s[0:1], 8
    v_lshrrev_b32 v1, 3, v0
    v_and_b32 v2, 7, v0
    v_mul_u32_u24 v3, 6912, v1
    v_lshl_add_u32 v3, v2, 4, v3
    v_lshlrev_b32 v4, 1, v1
    v_lshrrev_b32 v7, 6, v0
    v_and_b32 v9, 63, v0
    v_lshlrev_b32 v5, 8, v7
    v_lshl_add_u32 v5, v2, 5, v5
    v_bfe_u32 v8, v0, 4, 2
    v_lshl_add_u32 v5, v8, 3, v5
    v_lshlrev_b32 v6, 2, v9
    s_mul_i32 s36, s2, 57
    s_lshr_b32 s36, s36, 10
    s_mul_i32 s37, s36, 18
    s_sub_u32 s37, s2, s37
    s_mul_i32 s38, s36, 1990656
    s_lshl_b32 s39, s37, 7
    s_add_u32 s38, s38, s39
    s_mul_i32 s39, s36, 576
    s_waitcnt lgkmcnt(0)
    s_mov_b32 s12, s4
    s_mov_b32 s13, s5
    s_mov_b32 s14, 1152
    s_mov_b32 s15, 0x20000
    s_mov_b32 s16, s6
    s_mov_b32 s17, s7
    s_mov_b32 s18, 3981312
    s_mov_b32 s19, 0x20000
    s_cmp_ge_u32 s2, 36
    s_cbranch_scc1 K1_pk
    buffer_load_ushort v12, v4, s[12:15], s39 offen offset:0
    buffer_load_ushort v13, v4, s[12:15], s39 offen offset:96
    buffer_load_ushort v14, v4, s[12:15], s39 offen offset:192
    buffer_load_ushort v15, v4, s[12:15], s39 offen offset:288
    buffer_load_ushort v16, v4, s[12:15], s39 offen offset:384
    buffer_load_ushort v17, v4, s[12:15], s39 offen offset:480
    buffer_load_dwordx4 v[44:47], v3, s[16:19], s38 offen
    s_add_u32 s38, s38, 331776
    buffer_load_dwordx4 v[48:51], v3, s[16:19], s38 offen
    s_add_u32 s38, s38, 331776
    buffer_load_dwordx4 v[52:55], v3, s[16:19], s38 offen
    s_add_u32 s38, s38, 331776
    buffer_load_dwordx4 v[56:59], v3, s[16:19], s38 offen
    s_add_u32 s38, s38, 331776
    buffer_load_dwordx4 v[60:63], v3, s[16:19], s38 offen
    s_add_u32 s38, s38, 331776
    buffer_load_dwordx4 v[64:67], v3, s[16:19], s38 offen
    s_add_u32 s20, s10, 16384
    s_addc_u32 s21, s11, 0
    s_mov_b32 s22, 13824
    s_mov_b32 s23, 0x20000
    s_mul_i32 s40, s36, 4608
    s_lshl_b32 s41, s37, 8
    s_add_u32 s40, s40, s41
    s_waitcnt vmcnt(6)
    v_lshlrev_b32 v12, 16, v12
    v_lshlrev_b32 v13, 16, v13
    v_lshlrev_b32 v14, 16, v14
    v_lshlrev_b32 v15, 16, v15
    v_lshlrev_b32 v16, 16, v16
    v_lshlrev_b32 v17, 16, v17
    v_mul_f32 v24, 0xbfb8aa3b, v12
    v_mul_f32 v25, 0xbfb8aa3b, v13
    v_mul_f32 v26, 0xbfb8aa3b, v14
    v_mul_f32 v27, 0xbfb8aa3b, v15
    v_mul_f32 v28, 0xbfb8aa3b, v16
    v_mul_f32 v29, 0xbfb8aa3b, v17
    v_exp_f32 v24, v24
    v_exp_f32 v25, v25
    v_exp_f32 v26, v26
    v_exp_f32 v27, v27
    v_exp_f32 v28, v28
    v_exp_f32 v29, v29
    v_add_f32 v24, 1.0, v24
    v_add_f32 v25, 1.0, v25
    v_add_f32 v26, 1.0, v26
    v_add_f32 v27, 1.0, v27
    v_add_f32 v28, 1.0, v28
    v_add_f32 v29, 1.0, v29
    v_rcp_f32 v24, v24
    v_rcp_f32 v25, v25
    v_rcp_f32 v26, v26
    v_rcp_f32 v27, v27
    v_rcp_f32 v28, v28
    v_rcp_f32 v29, v29
    v_mul_f32 v12, v12, v24
    v_mul_f32 v13, v13, v25
    v_mul_f32 v14, v14, v26
    v_mul_f32 v15, v15, v27
    v_mul_f32 v16, v16, v28
    v_mul_f32 v17, v17, v29
    v_cvt_pk_bf16_f32 v12, v12, v12
    v_cvt_pk_bf16_f32 v13, v13, v13
    v_cvt_pk_bf16_f32 v14, v14, v14
    v_cvt_pk_bf16_f32 v15, v15, v15
    v_cvt_pk_bf16_f32 v16, v16, v16
    v_cvt_pk_bf16_f32 v17, v17, v17
    v_lshlrev_b32 v12, 16, v12
    v_lshlrev_b32 v13, 16, v13
    v_lshlrev_b32 v14, 16, v14
    v_lshlrev_b32 v15, 16, v15
    v_lshlrev_b32 v16, 16, v16
    v_lshlrev_b32 v17, 16, v17
    s_waitcnt vmcnt(5)
    v_lshlrev_b32 v7, 16, v44
    v_and_b32 v8, 0xffff0000, v44
    v_mul_f32 v36, v7, v12
    v_mul_f32 v37, v8, v12
    v_lshlrev_b32 v7, 16, v45
    v_and_b32 v8, 0xffff0000, v45
    v_mul_f32 v38, v7, v12
    v_mul_f32 v39, v8, v12
    v_lshlrev_b32 v7, 16, v46
    v_and_b32 v8, 0xffff0000, v46
    v_mul_f32 v40, v7, v12
    v_mul_f32 v41, v8, v12
    v_lshlrev_b32 v7, 16, v47
    v_and_b32 v8, 0xffff0000, v47
    v_mul_f32 v42, v7, v12
    v_mul_f32 v43, v8, v12
    s_waitcnt vmcnt(4)
    v_lshlrev_b32 v7, 16, v48
    v_and_b32 v8, 0xffff0000, v48
    v_fmac_f32 v36, v7, v13
    v_fmac_f32 v37, v8, v13
    v_lshlrev_b32 v7, 16, v49
    v_and_b32 v8, 0xffff0000, v49
    v_fmac_f32 v38, v7, v13
    v_fmac_f32 v39, v8, v13
    v_lshlrev_b32 v7, 16, v50
    v_and_b32 v8, 0xffff0000, v50
    v_fmac_f32 v40, v7, v13
    v_fmac_f32 v41, v8, v13
    v_lshlrev_b32 v7, 16, v51
    v_and_b32 v8, 0xffff0000, v51
    v_fmac_f32 v42, v7, v13
    v_fmac_f32 v43, v8, v13
    s_waitcnt vmcnt(3)
    v_lshlrev_b32 v7, 16, v52
    v_and_b32 v8, 0xffff0000, v52
    v_fmac_f32 v36, v7, v14
    v_fmac_f32 v37, v8, v14
    v_lshlrev_b32 v7, 16, v53
    v_and_b32 v8, 0xffff0000, v53
    v_fmac_f32 v38, v7, v14
    v_fmac_f32 v39, v8, v14
    v_lshlrev_b32 v7, 16, v54
    v_and_b32 v8, 0xffff0000, v54
    v_fmac_f32 v40, v7, v14
    v_fmac_f32 v41, v8, v14
    v_lshlrev_b32 v7, 16, v55
    v_and_b32 v8, 0xffff0000, v55
    v_fmac_f32 v42, v7, v14
    v_fmac_f32 v43, v8, v14
    s_waitcnt vmcnt(2)
    v_lshlrev_b32 v7, 16, v56
    v_and_b32 v8, 0xffff0000, v56
    v_fmac_f32 v36, v7, v15
    v_fmac_f32 v37, v8, v15
    v_lshlrev_b32 v7, 16, v57
    v_and_b32 v8, 0xffff0000, v57
    v_fmac_f32 v38, v7, v15
    v_fmac_f32 v39, v8, v15
    v_lshlrev_b32 v7, 16, v58
    v_and_b32 v8, 0xffff0000, v58
    v_fmac_f32 v40, v7, v15
    v_fmac_f32 v41, v8, v15
    v_lshlrev_b32 v7, 16, v59
    v_and_b32 v8, 0xffff0000, v59
    v_fmac_f32 v42, v7, v15
    v_fmac_f32 v43, v8, v15
    s_waitcnt vmcnt(1)
    v_lshlrev_b32 v7, 16, v60
    v_and_b32 v8, 0xffff0000, v60
    v_fmac_f32 v36, v7, v16
    v_fmac_f32 v37, v8, v16
    v_lshlrev_b32 v7, 16, v61
    v_and_b32 v8, 0xffff0000, v61
    v_fmac_f32 v38, v7, v16
    v_fmac_f32 v39, v8, v16
    v_lshlrev_b32 v7, 16, v62
    v_and_b32 v8, 0xffff0000, v62
    v_fmac_f32 v40, v7, v16
    v_fmac_f32 v41, v8, v16
    v_lshlrev_b32 v7, 16, v63
    v_and_b32 v8, 0xffff0000, v63
    v_fmac_f32 v42, v7, v16
    v_fmac_f32 v43, v8, v16
    s_waitcnt vmcnt(0)
    v_lshlrev_b32 v7, 16, v64
    v_and_b32 v8, 0xffff0000, v64
    v_fmac_f32 v36, v7, v17
    v_fmac_f32 v37, v8, v17
    v_lshlrev_b32 v7, 16, v65
    v_and_b32 v8, 0xffff0000, v65
    v_fmac_f32 v38, v7, v17
    v_fmac_f32 v39, v8, v17
    v_lshlrev_b32 v7, 16, v66
    v_and_b32 v8, 0xffff0000, v66
    v_fmac_f32 v40, v7, v17
    v_fmac_f32 v41, v8, v17
    v_lshlrev_b32 v7, 16, v67
    v_and_b32 v8, 0xffff0000, v67
    v_fmac_f32 v42, v7, v17
    v_fmac_f32 v43, v8, v17
    v_permlane32_swap_b32 v36, v40
    v_permlane32_swap_b32 v37, v41
    v_permlane32_swap_b32 v38, v42
    v_permlane32_swap_b32 v39, v43
    v_add_f32 v36, v36, v40
    v_add_f32 v37, v37, v41
    v_add_f32 v38, v38, v42
    v_add_f32 v39, v39, v43
    s_nop 0
    v_permlane16_swap_b32 v36, v38
    v_permlane16_swap_b32 v37, v39
    v_add_f32 v36, v36, v38
    v_add_f32 v37, v37, v39
    s_nop 0
    v_add_f32_dpp v36, v36, v36 row_ror:8 row_mask:0xf bank_mask:0xf
    v_add_f32_dpp v37, v37, v37 row_ror:8 row_mask:0xf bank_mask:0xf
    ds_write_b64 v5, v[36:37] offset:0
    s_waitcnt lgkmcnt(0)
    s_barrier
    v_readfirstlane_b32 s42, v0
    s_nop 0
    s_cmp_lg_u32 s42, 0
    s_cbranch_scc1 K1_p3
    ds_read_b32 v36, v6 offset:0
    ds_read_b32 v37, v6 offset:256
    ds_read_b32 v38, v6 offset:512
    ds_read_b32 v39, v6 offset:768
    ds_read_b32 v40, v6 offset:1024
    ds_read_b32 v41, v6 offset:1280
    s_waitcnt lgkmcnt(0)
    v_add_f32 v36, v36, v37
    v_add_f32 v38, v38, v39
    v_add_f32 v40, v40, v41
    v_add_f32 v36, v36, v38
    v_add_f32 v36, v36, v40
    buffer_store_dword v36, v6, s[20:23], s40 offen sc1
    v_mov_b32 v7, 0
    v_mov_b32 v8, 1
    s_mov_b64 exec, 1
    v_lshlrev_b32 v7, 2, s2
    s_waitcnt vmcnt(0)
    global_store_dword v7, v8, s[8:9] sc1
    s_mov_b64 exec, -1
K1_p3:
    s_barrier
    s_add_u32 s37, s2, 18
    s_lshl_b32 s38, s37, 7
    buffer_load_ushort v12, v4, s[12:15], 0 offen offset:0
    buffer_load_ushort v13, v4, s[12:15], 0 offen offset:96
    buffer_load_ushort v14, v4, s[12:15], 0 offen offset:192
    buffer_load_ushort v15, v4, s[12:15], 0 offen offset:288
    buffer_load_ushort v16, v4, s[12:15], 0 offen offset:384
    buffer_load_ushort v17, v4, s[12:15], 0 offen offset:480
    buffer_load_ushort v18, v4, s[12:15], 0 offen offset:576
    buffer_load_ushort v19, v4, s[12:15], 0 offen offset:672
    buffer_load_ushort v20, v4, s[12:15], 0 offen offset:768
    buffer_load_ushort v21, v4, s[12:15], 0 offen offset:864
    buffer_load_ushort v22, v4, s[12:15], 0 offen offset:960
    buffer_load_ushort v23, v4, s[12:15], 0 offen offset:1056
    buffer_load_dwordx4 v[44:47], v3, s[16:19], s38 offen
    s_add_u32 s38, s38, 331776
    buffer_load_dwordx4 v[48:51], v3, s[16:19], s38 offen
    s_add_u32 s38, s38, 331776
    buffer_load_dwordx4 v[52:55], v3, s[16:19], s38 offen
    s_add_u32 s38, s38, 331776
    buffer_load_dwordx4 v[56:59], v3, s[16:19], s38 offen
    s_add_u32 s38, s38, 331776
    buffer_load_dwordx4 v[60:63], v3, s[16:19], s38 offen
    s_add_u32 s38, s38, 331776
    buffer_load_dwordx4 v[64:67], v3, s[16:19], s38 offen
    s_add_u32 s38, s38, 331776
    buffer_load_dwordx4 v[68:71], v3, s[16:19], s38 offen
    s_add_u32 s38, s38, 331776
    buffer_load_dwordx4 v[72:75], v3, s[16:19], s38 offen
    s_add_u32 s38, s38, 331776
    buffer_load_dwordx4 v[76:79], v3, s[16:19], s38 offen
    s_add_u32 s38, s38, 331776
    buffer_load_dwordx4 v[80:83], v3, s[16:19], s38 offen
    s_add_u32 s38, s38, 331776
    buffer_load_dwordx4 v[84:87], v3, s[16:19], s38 offen
    s_add_u32 s38, s38, 331776
    buffer_load_dwordx4 v[88:91], v3, s[16:19], s38 offen
    s_waitcnt vmcnt(12)
    v_lshlrev_b32 v12, 16, v12
    v_lshlrev_b32 v13, 16, v13
    v_lshlrev_b32 v14, 16, v14
    v_lshlrev_b32 v15, 16, v15
    v_lshlrev_b32 v16, 16, v16
    v_lshlrev_b32 v17, 16, v17
    v_lshlrev_b32 v18, 16, v18
    v_lshlrev_b32 v19, 16, v19
    v_lshlrev_b32 v20, 16, v20
    v_lshlrev_b32 v21, 16, v21
    v_lshlrev_b32 v22, 16, v22
    v_lshlrev_b32 v23, 16, v23
    v_mul_f32 v24, 0xbfb8aa3b, v12
    v_mul_f32 v25, 0xbfb8aa3b, v13
    v_mul_f32 v26, 0xbfb8aa3b, v14
    v_mul_f32 v27, 0xbfb8aa3b, v15
    v_mul_f32 v28, 0xbfb8aa3b, v16
    v_mul_f32 v29, 0xbfb8aa3b, v17
    v_mul_f32 v30, 0xbfb8aa3b, v18
    v_mul_f32 v31, 0xbfb8aa3b, v19
    v_mul_f32 v32, 0xbfb8aa3b, v20
    v_mul_f32 v33, 0xbfb8aa3b, v21
    v_mul_f32 v34, 0xbfb8aa3b, v22
    v_mul_f32 v35, 0xbfb8aa3b, v23
    v_exp_f32 v24, v24
    v_exp_f32 v25, v25
    v_exp_f32 v26, v26
    v_exp_f32 v27, v27
    v_exp_f32 v28, v28
    v_exp_f32 v29, v29
    v_exp_f32 v30, v30
    v_exp_f32 v31, v31
    v_exp_f32 v32, v32
    v_exp_f32 v33, v33
    v_exp_f32 v34, v34
    v_exp_f32 v35, v35
    v_add_f32 v24, 1.0, v24
    v_add_f32 v25, 1.0, v25
    v_add_f32 v26, 1.0, v26
    v_add_f32 v27, 1.0, v27
    v_add_f32 v28, 1.0, v28
    v_add_f32 v29, 1.0, v29
    v_add_f32 v30, 1.0, v30
    v_add_f32 v31, 1.0, v31
    v_add_f32 v32, 1.0, v32
    v_add_f32 v33, 1.0, v33
    v_add_f32 v34, 1.0, v34
    v_add_f32 v35, 1.0, v35
    v_rcp_f32 v24, v24
    v_rcp_f32 v25, v25
    v_rcp_f32 v26, v26
    v_rcp_f32 v27, v27
    v_rcp_f32 v28, v28
    v_rcp_f32 v29, v29
    v_rcp_f32 v30, v30
    v_rcp_f32 v31, v31
    v_rcp_f32 v32, v32
    v_rcp_f32 v33, v33
    v_rcp_f32 v34, v34
    v_rcp_f32 v35, v35
    v_mul_f32 v12, v12, v24
    v_mul_f32 v13, v13, v25
    v_mul_f32 v14, v14, v26
    v_mul_f32 v15, v15, v27
    v_mul_f32 v16, v16, v28
    v_mul_f32 v17, v17, v29
    v_mul_f32 v18, v18, v30
    v_mul_f32 v19, v19, v31
    v_mul_f32 v20, v20, v32
    v_mul_f32 v21, v21, v33
    v_mul_f32 v22, v22, v34
    v_mul_f32 v23, v23, v35
    v_cvt_pk_bf16_f32 v12, v12, v12
    v_cvt_pk_bf16_f32 v13, v13, v13
    v_cvt_pk_bf16_f32 v14, v14, v14
    v_cvt_pk_bf16_f32 v15, v15, v15
    v_cvt_pk_bf16_f32 v16, v16, v16
    v_cvt_pk_bf16_f32 v17, v17, v17
    v_cvt_pk_bf16_f32 v18, v18, v18
    v_cvt_pk_bf16_f32 v19, v19, v19
    v_cvt_pk_bf16_f32 v20, v20, v20
    v_cvt_pk_bf16_f32 v21, v21, v21
    v_cvt_pk_bf16_f32 v22, v22, v22
    v_cvt_pk_bf16_f32 v23, v23, v23
    v_lshlrev_b32 v12, 16, v12
    v_lshlrev_b32 v13, 16, v13
    v_lshlrev_b32 v14, 16, v14
    v_lshlrev_b32 v15, 16, v15
    v_lshlrev_b32 v16, 16, v16
    v_lshlrev_b32 v17, 16, v17
    v_lshlrev_b32 v18, 16, v18
    v_lshlrev_b32 v19, 16, v19
    v_lshlrev_b32 v20, 16, v20
    v_lshlrev_b32 v21, 16, v21
    v_lshlrev_b32 v22, 16, v22
    v_lshlrev_b32 v23, 16, v23
    s_waitcnt vmcnt(11)
    v_lshlrev_b32 v7, 16, v44
    v_and_b32 v8, 0xffff0000, v44
    v_mul_f32 v36, v7, v12
    v_mul_f32 v37, v8, v12
    v_lshlrev_b32 v7, 16, v45
    v_and_b32 v8, 0xffff0000, v45
    v_mul_f32 v38, v7, v12
    v_mul_f32 v39, v8, v12
    v_lshlrev_b32 v7, 16, v46
    v_and_b32 v8, 0xffff0000, v46
    v_mul_f32 v40, v7, v12
    v_mul_f32 v41, v8, v12
    v_lshlrev_b32 v7, 16, v47
    v_and_b32 v8, 0xffff0000, v47
    v_mul_f32 v42, v7, v12
    v_mul_f32 v43, v8, v12
    s_waitcnt vmcnt(10)
    v_lshlrev_b32 v7, 16, v48
    v_and_b32 v8, 0xffff0000, v48
    v_fmac_f32 v36, v7, v13
    v_fmac_f32 v37, v8, v13
    v_lshlrev_b32 v7, 16, v49
    v_and_b32 v8, 0xffff0000, v49
    v_fmac_f32 v38, v7, v13
    v_fmac_f32 v39, v8, v13
    v_lshlrev_b32 v7, 16, v50
    v_and_b32 v8, 0xffff0000, v50
    v_fmac_f32 v40, v7, v13
    v_fmac_f32 v41, v8, v13
    v_lshlrev_b32 v7, 16, v51
    v_and_b32 v8, 0xffff0000, v51
    v_fmac_f32 v42, v7, v13
    v_fmac_f32 v43, v8, v13
    s_waitcnt vmcnt(9)
    v_lshlrev_b32 v7, 16, v52
    v_and_b32 v8, 0xffff0000, v52
    v_fmac_f32 v36, v7, v14
    v_fmac_f32 v37, v8, v14
    v_lshlrev_b32 v7, 16, v53
    v_and_b32 v8, 0xffff0000, v53
    v_fmac_f32 v38, v7, v14
    v_fmac_f32 v39, v8, v14
    v_lshlrev_b32 v7, 16, v54
    v_and_b32 v8, 0xffff0000, v54
    v_fmac_f32 v40, v7, v14
    v_fmac_f32 v41, v8, v14
    v_lshlrev_b32 v7, 16, v55
    v_and_b32 v8, 0xffff0000, v55
    v_fmac_f32 v42, v7, v14
    v_fmac_f32 v43, v8, v14
    s_waitcnt vmcnt(8)
    v_lshlrev_b32 v7, 16, v56
    v_and_b32 v8, 0xffff0000, v56
    v_fmac_f32 v36, v7, v15
    v_fmac_f32 v37, v8, v15
    v_lshlrev_b32 v7, 16, v57
    v_and_b32 v8, 0xffff0000, v57
    v_fmac_f32 v38, v7, v15
    v_fmac_f32 v39, v8, v15
    v_lshlrev_b32 v7, 16, v58
    v_and_b32 v8, 0xffff0000, v58
    v_fmac_f32 v40, v7, v15
    v_fmac_f32 v41, v8, v15
    v_lshlrev_b32 v7, 16, v59
    v_and_b32 v8, 0xffff0000, v59
    v_fmac_f32 v42, v7, v15
    v_fmac_f32 v43, v8, v15
    s_waitcnt vmcnt(7)
    v_lshlrev_b32 v7, 16, v60
    v_and_b32 v8, 0xffff0000, v60
    v_fmac_f32 v36, v7, v16
    v_fmac_f32 v37, v8, v16
    v_lshlrev_b32 v7, 16, v61
    v_and_b32 v8, 0xffff0000, v61
    v_fmac_f32 v38, v7, v16
    v_fmac_f32 v39, v8, v16
    v_lshlrev_b32 v7, 16, v62
    v_and_b32 v8, 0xffff0000, v62
    v_fmac_f32 v40, v7, v16
    v_fmac_f32 v41, v8, v16
    v_lshlrev_b32 v7, 16, v63
    v_and_b32 v8, 0xffff0000, v63
    v_fmac_f32 v42, v7, v16
    v_fmac_f32 v43, v8, v16
    s_waitcnt vmcnt(6)
    v_lshlrev_b32 v7, 16, v64
    v_and_b32 v8, 0xffff0000, v64
    v_fmac_f32 v36, v7, v17
    v_fmac_f32 v37, v8, v17
    v_lshlrev_b32 v7, 16, v65
    v_and_b32 v8, 0xffff0000, v65
    v_fmac_f32 v38, v7, v17
    v_fmac_f32 v39, v8, v17
    v_lshlrev_b32 v7, 16, v66
    v_and_b32 v8, 0xffff0000, v66
    v_fmac_f32 v40, v7, v17
    v_fmac_f32 v41, v8, v17
    v_lshlrev_b32 v7, 16, v67
    v_and_b32 v8, 0xffff0000, v67
    v_fmac_f32 v42, v7, v17
    v_fmac_f32 v43, v8, v17
    s_waitcnt vmcnt(5)
    v_lshlrev_b32 v7, 16, v68
    v_and_b32 v8, 0xffff0000, v68
    v_fmac_f32 v36, v7, v18
    v_fmac_f32 v37, v8, v18
    v_lshlrev_b32 v7, 16, v69
    v_and_b32 v8, 0xffff0000, v69
    v_fmac_f32 v38, v7, v18
    v_fmac_f32 v39, v8, v18
    v_lshlrev_b32 v7, 16, v70
    v_and_b32 v8, 0xffff0000, v70
    v_fmac_f32 v40, v7, v18
    v_fmac_f32 v41, v8, v18
    v_lshlrev_b32 v7, 16, v71
    v_and_b32 v8, 0xffff0000, v71
    v_fmac_f32 v42, v7, v18
    v_fmac_f32 v43, v8, v18
    s_waitcnt vmcnt(4)
    v_lshlrev_b32 v7, 16, v72
    v_and_b32 v8, 0xffff0000, v72
    v_fmac_f32 v36, v7, v19
    v_fmac_f32 v37, v8, v19
    v_lshlrev_b32 v7, 16, v73
    v_and_b32 v8, 0xffff0000, v73
    v_fmac_f32 v38, v7, v19
    v_fmac_f32 v39, v8, v19
    v_lshlrev_b32 v7, 16, v74
    v_and_b32 v8, 0xffff0000, v74
    v_fmac_f32 v40, v7, v19
    v_fmac_f32 v41, v8, v19
    v_lshlrev_b32 v7, 16, v75
    v_and_b32 v8, 0xffff0000, v75
    v_fmac_f32 v42, v7, v19
    v_fmac_f32 v43, v8, v19
    s_waitcnt vmcnt(3)
    v_lshlrev_b32 v7, 16, v76
    v_and_b32 v8, 0xffff0000, v76
    v_fmac_f32 v36, v7, v20
    v_fmac_f32 v37, v8, v20
    v_lshlrev_b32 v7, 16, v77
    v_and_b32 v8, 0xffff0000, v77
    v_fmac_f32 v38, v7, v20
    v_fmac_f32 v39, v8, v20
    v_lshlrev_b32 v7, 16, v78
    v_and_b32 v8, 0xffff0000, v78
    v_fmac_f32 v40, v7, v20
    v_fmac_f32 v41, v8, v20
    v_lshlrev_b32 v7, 16, v79
    v_and_b32 v8, 0xffff0000, v79
    v_fmac_f32 v42, v7, v20
    v_fmac_f32 v43, v8, v20
    s_waitcnt vmcnt(2)
    v_lshlrev_b32 v7, 16, v80
    v_and_b32 v8, 0xffff0000, v80
    v_fmac_f32 v36, v7, v21
    v_fmac_f32 v37, v8, v21
    v_lshlrev_b32 v7, 16, v81
    v_and_b32 v8, 0xffff0000, v81
    v_fmac_f32 v38, v7, v21
    v_fmac_f32 v39, v8, v21
    v_lshlrev_b32 v7, 16, v82
    v_and_b32 v8, 0xffff0000, v82
    v_fmac_f32 v40, v7, v21
    v_fmac_f32 v41, v8, v21
    v_lshlrev_b32 v7, 16, v83
    v_and_b32 v8, 0xffff0000, v83
    v_fmac_f32 v42, v7, v21
    v_fmac_f32 v43, v8, v21
    s_waitcnt vmcnt(1)
    v_lshlrev_b32 v7, 16, v84
    v_and_b32 v8, 0xffff0000, v84
    v_fmac_f32 v36, v7, v22
    v_fmac_f32 v37, v8, v22
    v_lshlrev_b32 v7, 16, v85
    v_and_b32 v8, 0xffff0000, v85
    v_fmac_f32 v38, v7, v22
    v_fmac_f32 v39, v8, v22
    v_lshlrev_b32 v7, 16, v86
    v_and_b32 v8, 0xffff0000, v86
    v_fmac_f32 v40, v7, v22
    v_fmac_f32 v41, v8, v22
    v_lshlrev_b32 v7, 16, v87
    v_and_b32 v8, 0xffff0000, v87
    v_fmac_f32 v42, v7, v22
    v_fmac_f32 v43, v8, v22
    s_waitcnt vmcnt(0)
    v_lshlrev_b32 v7, 16, v88
    v_and_b32 v8, 0xffff0000, v88
    v_fmac_f32 v36, v7, v23
    v_fmac_f32 v37, v8, v23
    v_lshlrev_b32 v7, 16, v89
    v_and_b32 v8, 0xffff0000, v89
    v_fmac_f32 v38, v7, v23
    v_fmac_f32 v39, v8, v23
    v_lshlrev_b32 v7, 16, v90
    v_and_b32 v8, 0xffff0000, v90
    v_fmac_f32 v40, v7, v23
    v_fmac_f32 v41, v8, v23
    v_lshlrev_b32 v7, 16, v91
    v_and_b32 v8, 0xffff0000, v91
    v_fmac_f32 v42, v7, v23
    v_fmac_f32 v43, v8, v23
    v_permlane32_swap_b32 v36, v40
    v_permlane32_swap_b32 v37, v41
    v_permlane32_swap_b32 v38, v42
    v_permlane32_swap_b32 v39, v43
    v_add_f32 v36, v36, v40
    v_add_f32 v37, v37, v41
    v_add_f32 v38, v38, v42
    v_add_f32 v39, v39, v43
    s_nop 0
    v_permlane16_swap_b32 v36, v38
    v_permlane16_swap_b32 v37, v39
    v_add_f32 v36, v36, v38
    v_add_f32 v37, v37, v39
    s_nop 0
    v_add_f32_dpp v36, v36, v36 row_ror:8 row_mask:0xf bank_mask:0xf
    v_add_f32_dpp v37, v37, v37 row_ror:8 row_mask:0xf bank_mask:0xf
    ds_write_b64 v5, v[36:37] offset:2048
    s_mov_b32 s20, s10
    s_mov_b32 s21, s11
    s_mov_b32 s22, 6912
    s_mov_b32 s23, 0x20000
    s_waitcnt lgkmcnt(0)
    s_barrier
    s_cmp_lg_u32 s42, 0
    s_cbranch_scc1 K1_pend
    ds_read_b32 v36, v6 offset:2048
    ds_read_b32 v37, v6 offset:2304
    ds_read_b32 v38, v6 offset:2560
    ds_read_b32 v39, v6 offset:2816
    ds_read_b32 v40, v6 offset:3072
    ds_read_b32 v41, v6 offset:3328
    s_mul_i32 s26, s37, 57
    s_lshr_b32 s26, s26, 9
    s_mul_i32 s27, s26, 9
    s_sub_u32 s27, s37, s27
    s_lshl_b32 s27, s27, 8
    s_lshl_b32 s28, s26, 2
    s_lshr_b32 s29, 0x211200, s28
    s_and_b32 s29, s29, 15
    s_mul_i32 s29, s29, 2304
    s_add_u32 s27, s27, s29
    s_lshr_b32 s29, 0x32, s26
    s_and_b32 s29, s29, 1
    s_lshl_b32 s29, s29, 1
    s_add_u32 s27, s27, s29
    s_lshr_b32 s29, 0x12, s26
    s_and_b32 s29, s29, 1
    s_mul_i32 s29, s29, 0x3f800000
    s_waitcnt lgkmcnt(0)
    v_add_f32 v36, v36, v37
    v_add_f32 v38, v38, v39
    v_add_f32 v40, v40, v41
    v_add_f32 v36, v36, v38
    v_add_f32 v36, v36, v40
    v_cvt_pk_bf16_f32 v36, v36, v36
    v_lshlrev_b32 v36, 16, v36
    v_add_f32 v36, s29, v36
    v_cvt_pk_bf16_f32 v36, v36, v36
    buffer_store_short v36, v6, s[20:23], s27 offen
    s_branch K1_pend
K1_pk:
    s_add_u32 s20, s10, 32768
    s_addc_u32 s21, s11, 0
    s_mov_b32 s22, 32768
    s_mov_b32 s23, 0x20000
    s_cmp_lg_u32 s2, 55
    s_cbranch_scc1 K1_pz
    v_lshlrev_b32 v7, 7, v0
    v_mov_b32 v8, 0
    buffer_store_dword v8, v7, s[20:23], 0 offen
K1_pz:
    s_cmp_lt_u32 s2, 40
    s_cbranch_scc1 K1_pk0
    s_getpc_b64 s[40:41]
K1p_pc:
    s_add_u32 s40, s40, K1_cons-K1p_pc
    s_addc_u32 s41, s41, 0
    v_lshlrev_b32 v44, 7, v0
    v_min_u32 v44, CODE_END-K1_cons-4, v44
    global_load_dword v44, v44, s[40:41]
K1_pk0:
    v_lshrrev_b32 v7, 6, v0
    s_sub_u32 s57, s2, 36
    v_readfirstlane_b32 s49, v7
    s_mov_b32 s24, s44
    s_mov_b32 s25, s45
    s_mov_b32 s26, 1183744
    s_mov_b32 s27, 0x20000
    s_mov_b32 s28, s46
    s_mov_b32 s29, s47
    s_mov_b32 s30, 1183744
    s_mov_b32 s31, 0x20000
    s_add_u32 s32, s10, 54525952
    s_addc_u32 s33, s11, 0
    s_mov_b32 s34, 2443776
    s_mov_b32 s35, 0x20000
    s_mul_i32 s50, s57, 384
    v_add_u32 v7, s50, v0
    v_mul_u32_u24 v2, 56680, v7
    v_lshrrev_b32 v2, 21, v2
    v_mul_u32_u24 v8, 37, v2
    v_sub_u32 v4, v7, v8
    v_lshrrev_b32 v3, 4, v2
    v_and_b32 v7, 3, v2
    v_lshl_add_u32 v7, v7, 8, v3
    v_bfe_u32 v8, v2, 2, 1
    v_lshl_add_u32 v7, v8, 5, v7
    v_bfe_u32 v8, v2, 3, 1
    v_lshl_add_u32 v7, v8, 10, v7
    v_mul_u32_u24 v1, 578, v7
    v_and_b32 v1, -16, v1
    v_lshl_add_u32 v1, v4, 4, v1
    v_bfe_u32 v7, v2, 2, 2
    v_lshrrev_b32 v8, 8, v2
    v_lshl_add_u32 v7, v8, 2, v7
    v_mul_u32_u24 v7, 148, v7
    v_and_b32 v8, 3, v2
    v_lshl_add_u32 v7, v8, 4, v7
    v_and_b32 v8, 15, v3
    v_add_lshl_u32 v7, v7, v8, 4
    v_cmp_eq_u32 vcc, 36, v4
    s_nop 1
    v_cndmask_b32 v4, 2.0, v7, vcc
    v_and_b32 v3, 7, v3
    s_lshl_b32 s53, s50, 4
    s_mov_b32 s55, 0x05040100
    s_mov_b32 s56, 0x07060302
    s_mov_b32 s54, 2424832
    v_lshlrev_b32 v2, 4, v0
    s_mov_b32 s52, 0
    buffer_load_dwordx4 v[92:95], v1, s[24:27], s52 offen
    buffer_load_dwordx4 v[96:99], v1, s[28:31], s52 offen
    s_add_u32 s52, s52, 36992
    buffer_load_dwordx4 v[100:103], v1, s[24:27], s52 offen
    buffer_load_dwordx4 v[104:107], v1, s[28:31], s52 offen
    s_add_u32 s52, s52, 36992
    buffer_load_dwordx4 v[108:111], v1, s[24:27], s52 offen
    buffer_load_dwordx4 v[112:115], v1, s[28:31], s52 offen
    s_add_u32 s52, s52, 36992
    buffer_load_dwordx4 v[116:119], v1, s[24:27], s52 offen
    buffer_load_dwordx4 v[120:123], v1, s[28:31], s52 offen
    s_waitcnt vmcnt(0)
    v_perm_b32 v124, v96, v92, s55
    v_perm_b32 v125, v104, v100, s55
    v_perm_b32 v126, v112, v108, s55
    v_perm_b32 v127, v120, v116, s55
    buffer_store_dwordx4 v[124:127], v2, s[32:35], s53 offen sc1
    s_add_u32 s53, s53, 303104
    v_perm_b32 v128, v96, v92, s56
    v_perm_b32 v129, v104, v100, s56
    v_perm_b32 v130, v112, v108, s56
    v_perm_b32 v131, v120, v116, s56
    buffer_store_dwordx4 v[128:131], v2, s[32:35], s53 offen sc1
    s_add_u32 s53, s53, 303104
    v_cmp_eq_u32 vcc, 1, v3
    s_nop 1
    v_cndmask_b32 v36, v124, v128, vcc
    v_cndmask_b32 v37, v125, v129, vcc
    v_cndmask_b32 v38, v126, v130, vcc
    v_cndmask_b32 v39, v127, v131, vcc
    v_perm_b32 v132, v97, v93, s55
    v_perm_b32 v133, v105, v101, s55
    v_perm_b32 v134, v113, v109, s55
    v_perm_b32 v135, v121, v117, s55
    buffer_store_dwordx4 v[132:135], v2, s[32:35], s53 offen sc1
    s_add_u32 s53, s53, 303104
    v_cmp_eq_u32 vcc, 2, v3
    s_nop 1
    v_cndmask_b32 v36, v36, v132, vcc
    v_cndmask_b32 v37, v37, v133, vcc
    v_cndmask_b32 v38, v38, v134, vcc
    v_cndmask_b32 v39, v39, v135, vcc
    v_perm_b32 v136, v97, v93, s56
    v_perm_b32 v137, v105, v101, s56
    v_perm_b32 v138, v113, v109, s56
    v_perm_b32 v139, v121, v117, s56
    buffer_store_dwordx4 v[136:139], v2, s[32:35], s53 offen sc1
    s_add_u32 s53, s53, 303104
    v_cmp_eq_u32 vcc, 3, v3
    s_nop 1
    v_cndmask_b32 v36, v36, v136, vcc
    v_cndmask_b32 v37, v37, v137, vcc
    v_cndmask_b32 v38, v38, v138, vcc
    v_cndmask_b32 v39, v39, v139, vcc
    v_perm_b32 v140, v98, v94, s55
    v_perm_b32 v141, v106, v102, s55
    v_perm_b32 v142, v114, v110, s55
    v_perm_b32 v143, v122, v118, s55
    buffer_store_dwordx4 v[140:143], v2, s[32:35], s53 offen sc1
    s_add_u32 s53, s53, 303104
    v_cmp_eq_u32 vcc, 4, v3
    s_nop 1
    v_cndmask_b32 v36, v36, v140, vcc
    v_cndmask_b32 v37, v37, v141, vcc
    v_cndmask_b32 v38, v38, v142, vcc
    v_cndmask_b32 v39, v39, v143, vcc
    v_perm_b32 v144, v98, v94, s56
    v_perm_b32 v145, v106, v102, s56
    v_perm_b32 v146, v114, v110, s56
    v_perm_b32 v147, v122, v118, s56
    buffer_store_dwordx4 v[144:147], v2, s[32:35], s53 offen sc1
    s_add_u32 s53, s53, 303104
    v_cmp_eq_u32 vcc, 5, v3
    s_nop 1
    v_cndmask_b32 v36, v36, v144, vcc
    v_cndmask_b32 v37, v37, v145, vcc
    v_cndmask_b32 v38, v38, v146, vcc
    v_cndmask_b32 v39, v39, v147, vcc
    v_perm_b32 v148, v99, v95, s55
    v_perm_b32 v149, v107, v103, s55
    v_perm_b32 v150, v115, v111, s55
    v_perm_b32 v151, v123, v119, s55
    buffer_store_dwordx4 v[148:151], v2, s[32:35], s53 offen sc1
    s_add_u32 s53, s53, 303104
    v_cmp_eq_u32 vcc, 6, v3
    s_nop 1
    v_cndmask_b32 v36, v36, v148, vcc
    v_cndmask_b32 v37, v37, v149, vcc
    v_cndmask_b32 v38, v38, v150, vcc
    v_cndmask_b32 v39, v39, v151, vcc
    v_perm_b32 v152, v99, v95, s56
    v_perm_b32 v153, v107, v103, s56
    v_perm_b32 v154, v115, v111, s56
    v_perm_b32 v155, v123, v119, s56
    buffer_store_dwordx4 v[152:155], v2, s[32:35], s53 offen sc1
    v_cmp_eq_u32 vcc, 7, v3
    s_nop 1
    v_cndmask_b32 v36, v36, v152, vcc
    v_cndmask_b32 v37, v37, v153, vcc
    v_cndmask_b32 v38, v38, v154, vcc
    v_cndmask_b32 v39, v39, v155, vcc
    v_alignbit_b32 v36, v36, v36, 16
    v_xor_b32 v36, 0x80000000, v36
    v_alignbit_b32 v37, v37, v37, 16
    v_xor_b32 v37, 0x80000000, v37
    v_alignbit_b32 v38, v38, v38, 16
    v_xor_b32 v38, 0x80000000, v38
    v_alignbit_b32 v39, v39, v39, 16
    v_xor_b32 v39, 0x80000000, v39
    buffer_store_dwordx4 v[36:39], v4, s[32:35], s54 offen
K1_pend:
    s_endpgm
K1_cons:
    s_load_dwordx2 s[4:5], s[0:1], 0
    s_load_dwordx4 s[8:11], s[0:1], 80
    s_load_dwordx4 s[44:47], s[0:1], 8
    s_sub_u32 s3, s2, 64
    v_lshrrev_b32 v1, 6, v0
    s_and_b32 s14, s3, 7
    s_lshr_b32 s17, s3, 3
    v_readfirstlane_b32 s15, v1
    s_mul_i32 s18, s17, 43
    s_lshr_b32 s18, s18, 7
    s_mul_i32 s19, s18, 3
    s_sub_u32 s17, s17, s19
    s_lshl_b32 s14, s14, 3
    s_add_u32 s14, s14, s18
    s_and_b32 s16, s14, 32
    s_and_b32 s18, s14, 3
    s_lshl_b32 s18, s18, 3
    s_or_b32 s16, s16, s18
    s_bfe_u32 s18, s14, 0x20002
    s_lshl_b32 s18, s18, 1
    s_or_b32 s16, s16, s18
    s_bfe_u32 s18, s14, 0x10004
    s_or_b32 s16, s16, s18
    v_mul_u32_u24 v2, 5462, v0
    v_lshrrev_b32 v2, 16, v2
    v_mul_u32_u24 v3, 12, v2
    v_sub_u32 v3, v0, v3
    v_mul_u32_u24 v4, 73728, v2
    v_lshl_add_u32 v4, v3, 4, v4
    s_mul_i32 s18, s16, 1152
    s_waitcnt lgkmcnt(0)
    s_mov_b32 s20, s4
    s_mov_b32 s21, s5
    s_mov_b32 s22, 2359296
    s_mov_b32 s23, 0x20000
    buffer_load_dwordx4 v[12:15], v4, s[20:23], s18 offen offset:0
    buffer_load_dwordx4 v[16:19], v4, s[20:23], s18 offen offset:192
    buffer_load_dwordx4 v[20:23], v4, s[20:23], s18 offen offset:384
    buffer_load_dwordx4 v[24:27], v4, s[20:23], s18 offen offset:576
    buffer_load_dwordx4 v[28:31], v4, s[20:23], s18 offen offset:768
    buffer_load_dwordx4 v[32:35], v4, s[20:23], s18 offen offset:960
    s_add_u32 s24, s10, 16384
    s_addc_u32 s25, s11, 0
    s_mov_b32 s26, 13824
    s_mov_b32 s27, 0x20000
    s_add_u32 s32, s10, 65536
    s_addc_u32 s33, s11, 0
    s_mov_b32 s34, 2367488
    s_mov_b32 s35, 0x20000
    s_mul_i32 s36, s17, 6
    s_add_u32 s36, s36, s15
    s_cmp_ge_u32 s36, 9
    s_cselect_b32 s37, 1, 0
    s_mul_i32 s38, s37, 9
    s_sub_u32 s38, s36, s38
    s_lshl_b32 s38, s38, 5
    s_add_u32 s38, s38, s37
    v_and_b32 v9, 63, v0
    v_and_b32 v7, 15, v0
    v_lshrrev_b32 v8, 4, v9
    v_lshrrev_b32 v188, 2, v7
    v_lshl_add_u32 v188, v188, 1, s38
    v_and_b32 v189, 3, v7
    v_lshl_add_u32 v188, v189, 3, v188
    v_cvt_f32_u32 v188, v188
    v_mul_u32_u24 v189, 72, v8
    v_cvt_f32_u32 v189, v189
    s_mov_b32 s58, 0x44100000
    v_mul_f32 v172, v188, v189
    v_fmamk_f32 v173, v188, 0x3f800000, v172
    v_fmamk_f32 v174, v188, 0x41000000, v172
    v_fmamk_f32 v175, v188, 0x41100000, v172
    v_mul_f32 v176, 0x41000000, v188
    v_mul_f32 v142, 0x3ae38e39, v172
    v_mul_f32 v143, 0x3ae38e39, v173
    v_mul_f32 v144, 0x3ae38e39, v174
    v_mul_f32 v145, 0x3ae38e39, v175
    v_mul_f32 v146, 0x3ae38e39, v176
    v_floor_f32 v142, v142
    v_floor_f32 v143, v143
    v_floor_f32 v144, v144
    v_floor_f32 v145, v145
    v_floor_f32 v146, v146
    v_fma_f32 v172, -v142, s58, v172
    v_fma_f32 v173, -v143, s58, v173
    v_fma_f32 v174, -v144, s58, v174
    v_fma_f32 v175, -v145, s58, v175
    v_fma_f32 v176, -v146, s58, v176
    v_mul_f32 v172, 0x3ae38e39, v172
    v_mul_f32 v173, 0x3ae38e39, v173
    v_mul_f32 v174, 0x3ae38e39, v174
    v_mul_f32 v175, 0x3ae38e39, v175
    v_mul_f32 v176, 0x3ae38e39, v176
    v_mul_f32 v177, 0x3ae38e39, v188
    v_cos_f32 v178, v177
    v_cos_f32 v179, v176
    v_cos_f32 v140, v172
    v_sin_f32_e64 v148, -v172
    v_cos_f32 v141, v173
    v_sin_f32_e64 v149, -v173
    v_cos_f32 v156, v174
    v_sin_f32_e64 v164, -v174
    v_cos_f32 v157, v175
    v_sin_f32_e64 v165, -v175
    v_add_f32 v178, v178, v178
    v_add_f32 v179, v179, v179
    v_fma_f32 v142, v178, v141, -v140
    v_fma_f32 v150, v178, v149, -v148
    v_fma_f32 v158, v178, v157, -v156
    v_fma_f32 v166, v178, v165, -v164
    v_fma_f32 v143, v178, v142, -v141
    v_fma_f32 v151, v178, v150, -v149
    v_fma_f32 v159, v178, v158, -v157
    v_fma_f32 v167, v178, v166, -v165
    v_fma_f32 v144, v178, v143, -v142
    v_fma_f32 v152, v178, v151, -v150
    v_fma_f32 v160, v178, v159, -v158
    v_fma_f32 v168, v178, v167, -v166
    v_fma_f32 v145, v178, v144, -v143
    v_fma_f32 v153, v178, v152, -v151
    v_fma_f32 v161, v178, v160, -v159
    v_fma_f32 v169, v178, v168, -v167
    v_fma_f32 v146, v178, v145, -v144
    v_fma_f32 v154, v178, v153, -v152
    v_fma_f32 v162, v178, v161, -v160
    v_fma_f32 v170, v178, v169, -v168
    v_fma_f32 v147, v178, v146, -v145
    v_fma_f32 v155, v178, v154, -v153
    v_fma_f32 v163, v178, v162, -v161
    v_fma_f32 v171, v178, v170, -v169
    v_cvt_pk_bf16_f32 v36, v140, v141
    v_cvt_pk_bf16_f32 v72, v148, v149
    v_cvt_pk_bf16_f32 v37, v142, v143
    v_cvt_pk_bf16_f32 v73, v150, v151
    v_cvt_pk_bf16_f32 v38, v144, v145
    v_cvt_pk_bf16_f32 v74, v152, v153
    v_cvt_pk_bf16_f32 v39, v146, v147
    v_cvt_pk_bf16_f32 v75, v154, v155
    v_cvt_pk_bf16_f32 v40, v156, v157
    v_cvt_pk_bf16_f32 v76, v164, v165
    v_cvt_pk_bf16_f32 v41, v158, v159
    v_cvt_pk_bf16_f32 v77, v166, v167
    v_cvt_pk_bf16_f32 v42, v160, v161
    v_cvt_pk_bf16_f32 v78, v168, v169
    v_cvt_pk_bf16_f32 v43, v162, v163
    v_cvt_pk_bf16_f32 v79, v170, v171
    v_fma_f32 v140, v179, v156, -v140
    v_fma_f32 v141, v179, v157, -v141
    v_fma_f32 v142, v179, v158, -v142
    v_fma_f32 v143, v179, v159, -v143
    v_fma_f32 v144, v179, v160, -v144
    v_fma_f32 v145, v179, v161, -v145
    v_fma_f32 v146, v179, v162, -v146
    v_fma_f32 v147, v179, v163, -v147
    v_fma_f32 v148, v179, v164, -v148
    v_fma_f32 v149, v179, v165, -v149
    v_fma_f32 v150, v179, v166, -v150
    v_fma_f32 v151, v179, v167, -v151
    v_fma_f32 v152, v179, v168, -v152
    v_fma_f32 v153, v179, v169, -v153
    v_fma_f32 v154, v179, v170, -v154
    v_fma_f32 v155, v179, v171, -v155
    v_cvt_pk_bf16_f32 v44, v140, v141
    v_cvt_pk_bf16_f32 v80, v148, v149
    v_cvt_pk_bf16_f32 v45, v142, v143
    v_cvt_pk_bf16_f32 v81, v150, v151
    v_cvt_pk_bf16_f32 v46, v144, v145
    v_cvt_pk_bf16_f32 v82, v152, v153
    v_cvt_pk_bf16_f32 v47, v146, v147
    v_cvt_pk_bf16_f32 v83, v154, v155
    v_fma_f32 v156, v179, v140, -v156
    v_fma_f32 v157, v179, v141, -v157
    v_fma_f32 v158, v179, v142, -v158
    v_fma_f32 v159, v179, v143, -v159
    v_fma_f32 v160, v179, v144, -v160
    v_fma_f32 v161, v179, v145, -v161
    v_fma_f32 v162, v179, v146, -v162
    v_fma_f32 v163, v179, v147, -v163
    v_fma_f32 v164, v179, v148, -v164
    v_fma_f32 v165, v179, v149, -v165
    v_fma_f32 v166, v179, v150, -v166
    v_fma_f32 v167, v179, v151, -v167
    v_fma_f32 v168, v179, v152, -v168
    v_fma_f32 v169, v179, v153, -v169
    v_fma_f32 v170, v179, v154, -v170
    v_fma_f32 v171, v179, v155, -v171
    v_cvt_pk_bf16_f32 v48, v156, v157
    v_cvt_pk_bf16_f32 v84, v164, v165
    v_cvt_pk_bf16_f32 v49, v158, v159
    v_cvt_pk_bf16_f32 v85, v166, v167
    v_cvt_pk_bf16_f32 v50, v160, v161
    v_cvt_pk_bf16_f32 v86, v168, v169
    v_cvt_pk_bf16_f32 v51, v162, v163
    v_cvt_pk_bf16_f32 v87, v170, v171
    v_fma_f32 v140, v179, v156, -v140
    v_fma_f32 v141, v179, v157, -v141
    v_fma_f32 v142, v179, v158, -v142
    v_fma_f32 v143, v179, v159, -v143
    v_fma_f32 v144, v179, v160, -v144
    v_fma_f32 v145, v179, v161, -v145
    v_fma_f32 v146, v179, v162, -v146
    v_fma_f32 v147, v179, v163, -v147
    v_fma_f32 v148, v179, v164, -v148
    v_fma_f32 v149, v179, v165, -v149
    v_fma_f32 v150, v179, v166, -v150
    v_fma_f32 v151, v179, v167, -v151
    v_fma_f32 v152, v179, v168, -v152
    v_fma_f32 v153, v179, v169, -v153
    v_fma_f32 v154, v179, v170, -v154
    v_fma_f32 v155, v179, v171, -v155
    v_cvt_pk_bf16_f32 v52, v140, v141
    v_cvt_pk_bf16_f32 v88, v148, v149
    v_cvt_pk_bf16_f32 v53, v142, v143
    v_cvt_pk_bf16_f32 v89, v150, v151
    v_cvt_pk_bf16_f32 v54, v144, v145
    v_cvt_pk_bf16_f32 v90, v152, v153
    v_cvt_pk_bf16_f32 v55, v146, v147
    v_cvt_pk_bf16_f32 v91, v154, v155
    v_fma_f32 v156, v179, v140, -v156
    v_fma_f32 v157, v179, v141, -v157
    v_fma_f32 v158, v179, v142, -v158
    v_fma_f32 v159, v179, v143, -v159
    v_fma_f32 v160, v179, v144, -v160
    v_fma_f32 v161, v179, v145, -v161
    v_fma_f32 v162, v179, v146, -v162
    v_fma_f32 v163, v179, v147, -v163
    v_fma_f32 v164, v179, v148, -v164
    v_fma_f32 v165, v179, v149, -v165
    v_fma_f32 v166, v179, v150, -v166
    v_fma_f32 v167, v179, v151, -v167
    v_fma_f32 v168, v179, v152, -v168
    v_fma_f32 v169, v179, v153, -v169
    v_fma_f32 v170, v179, v154, -v170
    v_fma_f32 v171, v179, v155, -v171
    v_cvt_pk_bf16_f32 v56, v156, v157
    v_cvt_pk_bf16_f32 v92, v164, v165
    v_cvt_pk_bf16_f32 v57, v158, v159
    v_cvt_pk_bf16_f32 v93, v166, v167
    v_cvt_pk_bf16_f32 v58, v160, v161
    v_cvt_pk_bf16_f32 v94, v168, v169
    v_cvt_pk_bf16_f32 v59, v162, v163
    v_cvt_pk_bf16_f32 v95, v170, v171
    v_fma_f32 v140, v179, v156, -v140
    v_fma_f32 v141, v179, v157, -v141
    v_fma_f32 v142, v179, v158, -v142
    v_fma_f32 v143, v179, v159, -v143
    v_fma_f32 v144, v179, v160, -v144
    v_fma_f32 v145, v179, v161, -v145
    v_fma_f32 v146, v179, v162, -v146
    v_fma_f32 v147, v179, v163, -v147
    v_fma_f32 v148, v179, v164, -v148
    v_fma_f32 v149, v179, v165, -v149
    v_fma_f32 v150, v179, v166, -v150
    v_fma_f32 v151, v179, v167, -v151
    v_fma_f32 v152, v179, v168, -v152
    v_fma_f32 v153, v179, v169, -v153
    v_fma_f32 v154, v179, v170, -v154
    v_fma_f32 v155, v179, v171, -v155
    v_cvt_pk_bf16_f32 v60, v140, v141
    v_cvt_pk_bf16_f32 v96, v148, v149
    v_cvt_pk_bf16_f32 v61, v142, v143
    v_cvt_pk_bf16_f32 v97, v150, v151
    v_cvt_pk_bf16_f32 v62, v144, v145
    v_cvt_pk_bf16_f32 v98, v152, v153
    v_cvt_pk_bf16_f32 v63, v146, v147
    v_cvt_pk_bf16_f32 v99, v154, v155
    v_fma_f32 v156, v179, v140, -v156
    v_fma_f32 v157, v179, v141, -v157
    v_fma_f32 v158, v179, v142, -v158
    v_fma_f32 v159, v179, v143, -v159
    v_fma_f32 v160, v179, v144, -v160
    v_fma_f32 v161, v179, v145, -v161
    v_fma_f32 v162, v179, v146, -v162
    v_fma_f32 v163, v179, v147, -v163
    v_fma_f32 v164, v179, v148, -v164
    v_fma_f32 v165, v179, v149, -v165
    v_fma_f32 v166, v179, v150, -v166
    v_fma_f32 v167, v179, v151, -v167
    v_fma_f32 v168, v179, v152, -v168
    v_fma_f32 v169, v179, v153, -v169
    v_fma_f32 v170, v179, v154, -v170
    v_fma_f32 v171, v179, v155, -v171
    v_cvt_pk_bf16_f32 v64, v156, v157
    v_cvt_pk_bf16_f32 v100, v164, v165
    v_cvt_pk_bf16_f32 v65, v158, v159
    v_cvt_pk_bf16_f32 v101, v166, v167
    v_cvt_pk_bf16_f32 v66, v160, v161
    v_cvt_pk_bf16_f32 v102, v168, v169
    v_cvt_pk_bf16_f32 v67, v162, v163
    v_cvt_pk_bf16_f32 v103, v170, v171
    v_fma_f32 v140, v179, v156, -v140
    v_fma_f32 v141, v179, v157, -v141
    v_fma_f32 v142, v179, v158, -v142
    v_fma_f32 v143, v179, v159, -v143
    v_fma_f32 v144, v179, v160, -v144
    v_fma_f32 v145, v179, v161, -v145
    v_fma_f32 v146, v179, v162, -v146
    v_fma_f32 v147, v179, v163, -v147
    v_fma_f32 v148, v179, v164, -v148
    v_fma_f32 v149, v179, v165, -v149
    v_fma_f32 v150, v179, v166, -v150
    v_fma_f32 v151, v179, v167, -v151
    v_fma_f32 v152, v179, v168, -v152
    v_fma_f32 v153, v179, v169, -v153
    v_fma_f32 v154, v179, v170, -v154
    v_fma_f32 v155, v179, v171, -v155
    v_cvt_pk_bf16_f32 v68, v140, v141
    v_cvt_pk_bf16_f32 v104, v148, v149
    v_cvt_pk_bf16_f32 v69, v142, v143
    v_cvt_pk_bf16_f32 v105, v150, v151
    v_cvt_pk_bf16_f32 v70, v144, v145
    v_cvt_pk_bf16_f32 v106, v152, v153
    v_cvt_pk_bf16_f32 v71, v146, v147
    v_cvt_pk_bf16_f32 v107, v154, v155
    s_cmp_lg_u32 s36, 0
    s_cbranch_scc1 K1_nofix
    v_cmp_eq_u32 vcc, 0, v7
    s_nop 0
    s_and_saveexec_b64 s[40:41], vcc
    v_mov_b32 v72, 0xbf003f00
    v_mov_b32 v36, 0x3f003f00
    v_mov_b32 v73, 0xbf003f00
    v_mov_b32 v37, 0x3f003f00
    v_mov_b32 v74, 0xbf003f00
    v_mov_b32 v38, 0x3f003f00
    v_mov_b32 v75, 0xbf003f00
    v_mov_b32 v39, 0x3f003f00
    v_mov_b32 v76, 0xbf003f00
    v_mov_b32 v40, 0x3f003f00
    v_mov_b32 v77, 0xbf003f00
    v_mov_b32 v41, 0x3f003f00
    v_mov_b32 v78, 0xbf003f00
    v_mov_b32 v42, 0x3f003f00
    v_mov_b32 v79, 0xbf003f00
    v_mov_b32 v43, 0x3f003f00
    v_mov_b32 v80, 0xbf003f00
    v_mov_b32 v44, 0x3f003f00
    v_mov_b32 v81, 0xbf003f00
    v_mov_b32 v45, 0x3f003f00
    v_mov_b32 v82, 0xbf003f00
    v_mov_b32 v46, 0x3f003f00
    v_mov_b32 v83, 0xbf003f00
    v_mov_b32 v47, 0x3f003f00
    v_mov_b32 v84, 0xbf003f00
    v_mov_b32 v48, 0x3f003f00
    v_mov_b32 v85, 0xbf003f00
    v_mov_b32 v49, 0x3f003f00
    v_mov_b32 v86, 0xbf003f00
    v_mov_b32 v50, 0x3f003f00
    v_mov_b32 v87, 0xbf003f00
    v_mov_b32 v51, 0x3f003f00
    v_mov_b32 v88, 0xbf003f00
    v_mov_b32 v52, 0x3f003f00
    v_mov_b32 v89, 0xbf003f00
    v_mov_b32 v53, 0x3f003f00
    v_mov_b32 v90, 0xbf003f00
    v_mov_b32 v54, 0x3f003f00
    v_mov_b32 v91, 0xbf003f00
    v_mov_b32 v55, 0x3f003f00
    v_mov_b32 v92, 0xbf003f00
    v_mov_b32 v56, 0x3f003f00
    v_mov_b32 v93, 0xbf003f00
    v_mov_b32 v57, 0x3f003f00
    v_mov_b32 v94, 0xbf003f00
    v_mov_b32 v58, 0x3f003f00
    v_mov_b32 v95, 0xbf003f00
    v_mov_b32 v59, 0x3f003f00
    v_mov_b32 v96, 0xbf003f00
    v_mov_b32 v60, 0x3f003f00
    v_mov_b32 v97, 0xbf003f00
    v_mov_b32 v61, 0x3f003f00
    v_mov_b32 v98, 0xbf003f00
    v_mov_b32 v62, 0x3f003f00
    v_mov_b32 v99, 0xbf003f00
    v_mov_b32 v63, 0x3f003f00
    v_mov_b32 v100, 0xbf003f00
    v_mov_b32 v64, 0x3f003f00
    v_mov_b32 v101, 0xbf003f00
    v_mov_b32 v65, 0x3f003f00
    v_mov_b32 v102, 0xbf003f00
    v_mov_b32 v66, 0x3f003f00
    v_mov_b32 v103, 0xbf003f00
    v_mov_b32 v67, 0x3f003f00
    v_mov_b32 v104, 0xbf003f00
    v_mov_b32 v68, 0x3f003f00
    v_mov_b32 v105, 0xbf003f00
    v_mov_b32 v69, 0x3f003f00
    v_mov_b32 v106, 0xbf003f00
    v_mov_b32 v70, 0x3f003f00
    v_mov_b32 v107, 0xbf003f00
    v_mov_b32 v71, 0x3f003f00
    s_mov_b64 exec, s[40:41]
K1_nofix:
    v_lshrrev_b32 v140, 1, v7
    v_cvt_f32_u32 v140, v140
    v_and_b32 v144, 1, v7
    v_cvt_f32_u32 v144, v144
    v_mul_f32 v144, 0x3e800000, v144
    v_lshl_add_u32 v145, v8, 8, s16
    v_cvt_f32_u32 v145, v145
    v_mul_f32 v145, 0x3a000000, v145
    v_add_f32 v141, 0x41000000, v140
    v_add_f32 v142, 0x41800000, v140
    v_add_f32 v143, 0x41c00000, v140
    v_add_f32 v146, 0x3d000000, v145
    v_add_f32 v147, 0x3d800000, v145
    v_add_f32 v148, 0x3dc00000, v145
    v_bfe_u32 v149, v7, 1, 1
    s_mov_b32 s58, 0x80008000
    v_mul_lo_u32 v149, v149, s58
    v_fma_f32 v156, v140, v145, v144
    v_fma_f32 v157, v140, v146, v144
    v_fma_f32 v158, v140, v147, v144
    v_fma_f32 v159, v140, v148, v144
    v_cos_f32 v160, v156
    v_sin_f32 v164, v156
    v_cos_f32 v161, v157
    v_sin_f32 v165, v157
    v_cos_f32 v162, v158
    v_sin_f32 v166, v158
    v_cos_f32 v163, v159
    v_sin_f32 v167, v159
    v_cvt_pk_bf16_f32 v108, v160, v164
    v_cvt_pk_bf16_f32 v109, v161, v165
    v_cvt_pk_bf16_f32 v110, v162, v166
    v_cvt_pk_bf16_f32 v111, v163, v167
    v_xor_b32 v112, v108, v149
    v_xor_b32 v113, v109, v149
    v_xor_b32 v114, v110, v149
    v_xor_b32 v115, v111, v149
    v_fma_f32 v168, v141, v145, v144
    v_fma_f32 v169, v141, v146, v144
    v_fma_f32 v170, v141, v147, v144
    v_fma_f32 v171, v141, v148, v144
    v_cos_f32 v172, v168
    v_sin_f32 v176, v168
    v_cos_f32 v173, v169
    v_sin_f32 v177, v169
    v_cos_f32 v174, v170
    v_sin_f32 v178, v170
    v_cos_f32 v175, v171
    v_sin_f32 v179, v171
    v_cvt_pk_bf16_f32 v116, v172, v176
    v_cvt_pk_bf16_f32 v117, v173, v177
    v_cvt_pk_bf16_f32 v118, v174, v178
    v_cvt_pk_bf16_f32 v119, v175, v179
    v_xor_b32 v120, v116, v149
    v_xor_b32 v121, v117, v149
    v_xor_b32 v122, v118, v149
    v_xor_b32 v123, v119, v149
    v_fma_f32 v156, v142, v145, v144
    v_fma_f32 v157, v142, v146, v144
    v_fma_f32 v158, v142, v147, v144
    v_fma_f32 v159, v142, v148, v144
    v_cos_f32 v160, v156
    v_sin_f32 v164, v156
    v_cos_f32 v161, v157
    v_sin_f32 v165, v157
    v_cos_f32 v162, v158
    v_sin_f32 v166, v158
    v_cos_f32 v163, v159
    v_sin_f32 v167, v159
    v_cvt_pk_bf16_f32 v124, v160, v164
    v_cvt_pk_bf16_f32 v125, v161, v165
    v_cvt_pk_bf16_f32 v126, v162, v166
    v_cvt_pk_bf16_f32 v127, v163, v167
    v_xor_b32 v128, v124, v149
    v_xor_b32 v129, v125, v149
    v_xor_b32 v130, v126, v149
    v_xor_b32 v131, v127, v149
    v_fma_f32 v168, v143, v145, v144
    v_fma_f32 v169, v143, v146, v144
    v_fma_f32 v170, v143, v147, v144
    v_fma_f32 v171, v143, v148, v144
    v_cos_f32 v172, v168
    v_sin_f32 v176, v168
    v_cos_f32 v173, v169
    v_sin_f32 v177, v169
    v_cos_f32 v174, v170
    v_sin_f32 v178, v170
    v_cos_f32 v175, v171
    v_sin_f32 v179, v171
    v_cvt_pk_bf16_f32 v132, v172, v176
    v_cvt_pk_bf16_f32 v133, v173, v177
    v_cvt_pk_bf16_f32 v134, v174, v178
    v_cvt_pk_bf16_f32 v135, v175, v179
    v_xor_b32 v136, v132, v149
    v_xor_b32 v137, v133, v149
    v_xor_b32 v138, v134, v149
    v_xor_b32 v139, v135, v149
    s_cmp_lt_u32 s3, 128
    s_cselect_b32 s59, s15, 0
    s_cmp_lg_u32 s59, 3
    s_cbranch_scc1 K1_np1
    s_lshl_b32 s56, s3, 6
    s_add_u32 s56, s56, 10560
    s_mov_b32 s28, s44
    s_mov_b32 s29, s45
    s_mov_b32 s30, 1183744
    s_mov_b32 s31, 0x20000
    s_mov_b32 s48, s46
    s_mov_b32 s49, s47
    s_mov_b32 s50, 1183744
    s_mov_b32 s51, 0x20000
    s_add_u32 s52, s10, 54525952
    s_addc_u32 s53, s11, 0
    s_mov_b32 s54, 2443776
    s_mov_b32 s55, 0x20000
    v_add_u32 v216, s56, v0
    v_mul_u32_u24 v215, 56680, v216
    v_lshrrev_b32 v215, 21, v215
    v_mul_u32_u24 v217, 37, v215
    v_sub_u32 v212, v216, v217
    v_lshrrev_b32 v213, 4, v215
    v_and_b32 v216, 3, v215
    v_lshl_add_u32 v216, v216, 8, v213
    v_bfe_u32 v217, v215, 2, 1
    v_lshl_add_u32 v216, v217, 5, v216
    v_bfe_u32 v217, v215, 3, 1
    v_lshl_add_u32 v216, v217, 10, v216
    v_mul_u32_u24 v214, 578, v216
    v_and_b32 v214, -16, v214
    v_lshl_add_u32 v214, v212, 4, v214
    v_bfe_u32 v216, v215, 2, 2
    v_lshrrev_b32 v217, 8, v215
    v_lshl_add_u32 v216, v217, 2, v216
    v_mul_u32_u24 v216, 148, v216
    v_and_b32 v217, 3, v215
    v_lshl_add_u32 v216, v217, 4, v216
    v_and_b32 v217, 15, v213
    v_add_lshl_u32 v216, v216, v217, 4
    v_cmp_eq_u32 vcc, 36, v212
    s_nop 1
    v_cndmask_b32 v212, 2.0, v216, vcc
    v_and_b32 v213, 7, v213
    s_lshl_b32 s6, s56, 4
    s_mov_b32 s12, 0x05040100
    s_mov_b32 s13, 0x07060302
    s_mov_b32 s7, 2424832
    v_lshlrev_b32 v215, 4, v0
    s_waitcnt vmcnt(0)
    s_mov_b32 s57, 0
    buffer_load_dwordx4 v[220:223], v214, s[28:31], s57 offen
    buffer_load_dwordx4 v[224:227], v214, s[48:51], s57 offen
    s_add_u32 s57, s57, 36992
    buffer_load_dwordx4 v[228:231], v214, s[28:31], s57 offen
    buffer_load_dwordx4 v[232:235], v214, s[48:51], s57 offen
    s_add_u32 s57, s57, 36992
    buffer_load_dwordx4 v[236:239], v214, s[28:31], s57 offen
    buffer_load_dwordx4 v[240:243], v214, s[48:51], s57 offen
    s_add_u32 s57, s57, 36992
    buffer_load_dwordx4 v[244:247], v214, s[28:31], s57 offen
    buffer_load_dwordx4 v[248:251], v214, s[48:51], s57 offen
    s_branch K1_np2
K1_np1:
    s_waitcnt vmcnt(0)
K1_np2:
    v_lshlrev_b32 v140, 16, v12
    v_and_b32 v141, 0xffff0000, v12
    v_lshlrev_b32 v142, 16, v13
    v_and_b32 v143, 0xffff0000, v13
    v_lshlrev_b32 v144, 16, v14
    v_and_b32 v145, 0xffff0000, v14
    v_lshlrev_b32 v146, 16, v15
    v_and_b32 v147, 0xffff0000, v15
    v_lshlrev_b32 v148, 16, v16
    v_and_b32 v149, 0xffff0000, v16
    v_lshlrev_b32 v150, 16, v17
    v_and_b32 v151, 0xffff0000, v17
    v_lshlrev_b32 v152, 16, v18
    v_and_b32 v153, 0xffff0000, v18
    v_lshlrev_b32 v154, 16, v19
    v_and_b32 v155, 0xffff0000, v19
    v_lshlrev_b32 v156, 16, v20
    v_and_b32 v157, 0xffff0000, v20
    v_lshlrev_b32 v158, 16, v21
    v_and_b32 v159, 0xffff0000, v21
    v_lshlrev_b32 v160, 16, v22
    v_and_b32 v161, 0xffff0000, v22
    v_lshlrev_b32 v162, 16, v23
    v_and_b32 v163, 0xffff0000, v23
    v_lshlrev_b32 v164, 16, v24
    v_and_b32 v165, 0xffff0000, v24
    v_lshlrev_b32 v166, 16, v25
    v_and_b32 v167, 0xffff0000, v25
    v_lshlrev_b32 v168, 16, v26
    v_and_b32 v169, 0xffff0000, v26
    v_lshlrev_b32 v170, 16, v27
    v_and_b32 v171, 0xffff0000, v27
    v_lshlrev_b32 v172, 16, v28
    v_and_b32 v173, 0xffff0000, v28
    v_lshlrev_b32 v174, 16, v29
    v_and_b32 v175, 0xffff0000, v29
    v_lshlrev_b32 v176, 16, v30
    v_and_b32 v177, 0xffff0000, v30
    v_lshlrev_b32 v178, 16, v31
    v_and_b32 v179, 0xffff0000, v31
    v_lshlrev_b32 v180, 16, v32
    v_and_b32 v181, 0xffff0000, v32
    v_lshlrev_b32 v182, 16, v33
    v_and_b32 v183, 0xffff0000, v33
    v_lshlrev_b32 v184, 16, v34
    v_and_b32 v185, 0xffff0000, v34
    v_lshlrev_b32 v186, 16, v35
    v_and_b32 v187, 0xffff0000, v35
    v_add_f32 v188, v140, v141
    v_mul_f32 v189, v140, v140
    v_add_f32 v190, v142, v143
    v_mul_f32 v191, v141, v141
    v_fmac_f32 v189, v142, v142
    v_fmac_f32 v191, v143, v143
    v_add_f32 v188, v188, v144
    v_fmac_f32 v189, v144, v144
    v_add_f32 v190, v190, v145
    v_fmac_f32 v191, v145, v145
    v_add_f32 v188, v188, v146
    v_fmac_f32 v189, v146, v146
    v_add_f32 v190, v190, v147
    v_fmac_f32 v191, v147, v147
    v_add_f32 v188, v188, v148
    v_fmac_f32 v189, v148, v148
    v_add_f32 v190, v190, v149
    v_fmac_f32 v191, v149, v149
    v_add_f32 v188, v188, v150
    v_fmac_f32 v189, v150, v150
    v_add_f32 v190, v190, v151
    v_fmac_f32 v191, v151, v151
    v_add_f32 v188, v188, v152
    v_fmac_f32 v189, v152, v152
    v_add_f32 v190, v190, v153
    v_fmac_f32 v191, v153, v153
    v_add_f32 v188, v188, v154
    v_fmac_f32 v189, v154, v154
    v_add_f32 v190, v190, v155
    v_fmac_f32 v191, v155, v155
    v_add_f32 v188, v188, v156
    v_fmac_f32 v189, v156, v156
    v_add_f32 v190, v190, v157
    v_fmac_f32 v191, v157, v157
    v_add_f32 v188, v188, v158
    v_fmac_f32 v189, v158, v158
    v_add_f32 v190, v190, v159
    v_fmac_f32 v191, v159, v159
    v_add_f32 v188, v188, v160
    v_fmac_f32 v189, v160, v160
    v_add_f32 v190, v190, v161
    v_fmac_f32 v191, v161, v161
    v_add_f32 v188, v188, v162
    v_fmac_f32 v189, v162, v162
    v_add_f32 v190, v190, v163
    v_fmac_f32 v191, v163, v163
    v_add_f32 v188, v188, v164
    v_fmac_f32 v189, v164, v164
    v_add_f32 v190, v190, v165
    v_fmac_f32 v191, v165, v165
    v_add_f32 v188, v188, v166
    v_fmac_f32 v189, v166, v166
    v_add_f32 v190, v190, v167
    v_fmac_f32 v191, v167, v167
    v_add_f32 v188, v188, v168
    v_fmac_f32 v189, v168, v168
    v_add_f32 v190, v190, v169
    v_fmac_f32 v191, v169, v169
    v_add_f32 v188, v188, v170
    v_fmac_f32 v189, v170, v170
    v_add_f32 v190, v190, v171
    v_fmac_f32 v191, v171, v171
    v_add_f32 v188, v188, v172
    v_fmac_f32 v189, v172, v172
    v_add_f32 v190, v190, v173
    v_fmac_f32 v191, v173, v173
    v_add_f32 v188, v188, v174
    v_fmac_f32 v189, v174, v174
    v_add_f32 v190, v190, v175
    v_fmac_f32 v191, v175, v175
    v_add_f32 v188, v188, v176
    v_fmac_f32 v189, v176, v176
    v_add_f32 v190, v190, v177
    v_fmac_f32 v191, v177, v177
    v_add_f32 v188, v188, v178
    v_fmac_f32 v189, v178, v178
    v_add_f32 v190, v190, v179
    v_fmac_f32 v191, v179, v179
    v_add_f32 v188, v188, v180
    v_fmac_f32 v189, v180, v180
    v_add_f32 v190, v190, v181
    v_fmac_f32 v191, v181, v181
    v_add_f32 v188, v188, v182
    v_fmac_f32 v189, v182, v182
    v_add_f32 v190, v190, v183
    v_fmac_f32 v191, v183, v183
    v_add_f32 v188, v188, v184
    v_fmac_f32 v189, v184, v184
    v_add_f32 v190, v190, v185
    v_fmac_f32 v191, v185, v185
    v_add_f32 v188, v188, v186
    v_fmac_f32 v189, v186, v186
    v_add_f32 v190, v190, v187
    v_fmac_f32 v191, v187, v187
    v_add_f32 v188, v188, v190
    v_add_f32 v189, v189, v191
    v_lshlrev_b32 v4, 3, v0
    ds_write_b64 v4, v[188:189] offset:36864
    v_mul_u32_u24 v4, 96, v2
    s_waitcnt lgkmcnt(0)
    s_barrier
    ds_read_b128 v[12:15], v4 offset:36864
    ds_read_b128 v[16:19], v4 offset:36880
    ds_read_b128 v[20:23], v4 offset:36896
    ds_read_b128 v[24:27], v4 offset:36912
    ds_read_b128 v[28:31], v4 offset:36928
    ds_read_b128 v[32:35], v4 offset:36944
    s_waitcnt lgkmcnt(0)
    v_add_f32 v12, v12, v14
    v_add_f32 v13, v13, v15
    v_add_f32 v12, v12, v16
    v_add_f32 v13, v13, v17
    v_add_f32 v12, v12, v18
    v_add_f32 v13, v13, v19
    v_add_f32 v12, v12, v20
    v_add_f32 v13, v13, v21
    v_add_f32 v12, v12, v22
    v_add_f32 v13, v13, v23
    v_add_f32 v12, v12, v24
    v_add_f32 v13, v13, v25
    v_add_f32 v12, v12, v26
    v_add_f32 v13, v13, v27
    v_add_f32 v12, v12, v28
    v_add_f32 v13, v13, v29
    v_add_f32 v12, v12, v30
    v_add_f32 v13, v13, v31
    v_add_f32 v12, v12, v32
    v_add_f32 v13, v13, v33
    v_add_f32 v12, v12, v34
    v_add_f32 v13, v13, v35
    v_mul_f32 v12, 0x3ae38e39, v12
    v_mul_f32 v13, 0x3ae38e39, v13
    v_fma_f32 v13, -v12, v12, v13
    v_max_f32 v13, 0, v13
    v_add_f32 v13, 0x3727c5ac, v13
    v_rsq_f32 v14, v13
    s_nop 0
    v_mul_f32 v15, v12, v14
    v_fma_f32 v140, v140, v14, -v15
    v_fma_f32 v141, v141, v14, -v15
    v_fma_f32 v142, v142, v14, -v15
    v_fma_f32 v143, v143, v14, -v15
    v_fma_f32 v144, v144, v14, -v15
    v_fma_f32 v145, v145, v14, -v15
    v_fma_f32 v146, v146, v14, -v15
    v_fma_f32 v147, v147, v14, -v15
    v_fma_f32 v148, v148, v14, -v15
    v_fma_f32 v149, v149, v14, -v15
    v_fma_f32 v150, v150, v14, -v15
    v_fma_f32 v151, v151, v14, -v15
    v_fma_f32 v152, v152, v14, -v15
    v_fma_f32 v153, v153, v14, -v15
    v_fma_f32 v154, v154, v14, -v15
    v_fma_f32 v155, v155, v14, -v15
    v_fma_f32 v156, v156, v14, -v15
    v_fma_f32 v157, v157, v14, -v15
    v_fma_f32 v158, v158, v14, -v15
    v_fma_f32 v159, v159, v14, -v15
    v_fma_f32 v160, v160, v14, -v15
    v_fma_f32 v161, v161, v14, -v15
    v_fma_f32 v162, v162, v14, -v15
    v_fma_f32 v163, v163, v14, -v15
    v_fma_f32 v164, v164, v14, -v15
    v_fma_f32 v165, v165, v14, -v15
    v_fma_f32 v166, v166, v14, -v15
    v_fma_f32 v167, v167, v14, -v15
    v_fma_f32 v168, v168, v14, -v15
    v_fma_f32 v169, v169, v14, -v15
    v_fma_f32 v170, v170, v14, -v15
    v_fma_f32 v171, v171, v14, -v15
    v_fma_f32 v172, v172, v14, -v15
    v_fma_f32 v173, v173, v14, -v15
    v_fma_f32 v174, v174, v14, -v15
    v_fma_f32 v175, v175, v14, -v15
    v_fma_f32 v176, v176, v14, -v15
    v_fma_f32 v177, v177, v14, -v15
    v_fma_f32 v178, v178, v14, -v15
    v_fma_f32 v179, v179, v14, -v15
    v_fma_f32 v180, v180, v14, -v15
    v_fma_f32 v181, v181, v14, -v15
    v_fma_f32 v182, v182, v14, -v15
    v_fma_f32 v183, v183, v14, -v15
    v_fma_f32 v184, v184, v14, -v15
    v_fma_f32 v185, v185, v14, -v15
    v_fma_f32 v186, v186, v14, -v15
    v_fma_f32 v187, v187, v14, -v15
    v_lshlrev_b32 v5, 4, v0
    v_mov_b32 v6, 0
    s_cmp_ge_u32 s15, 3
    s_cbranch_scc0 K1_mod
    s_cmp_lg_u32 s59, 3
    s_cbranch_scc1 K1_nomod
    s_waitcnt vmcnt(0)
    v_perm_b32 v12, v224, v220, s12
    v_perm_b32 v13, v232, v228, s12
    v_perm_b32 v14, v240, v236, s12
    v_perm_b32 v15, v248, v244, s12
    buffer_store_dwordx4 v[12:15], v215, s[52:55], s6 offen sc1
    s_add_u32 s6, s6, 303104
    v_perm_b32 v16, v224, v220, s13
    v_perm_b32 v17, v232, v228, s13
    v_perm_b32 v18, v240, v236, s13
    v_perm_b32 v19, v248, v244, s13
    buffer_store_dwordx4 v[16:19], v215, s[52:55], s6 offen sc1
    s_add_u32 s6, s6, 303104
    v_cmp_eq_u32 vcc, 1, v213
    s_nop 1
    v_cndmask_b32 v196, v12, v16, vcc
    v_cndmask_b32 v197, v13, v17, vcc
    v_cndmask_b32 v198, v14, v18, vcc
    v_cndmask_b32 v199, v15, v19, vcc
    v_perm_b32 v20, v225, v221, s12
    v_perm_b32 v21, v233, v229, s12
    v_perm_b32 v22, v241, v237, s12
    v_perm_b32 v23, v249, v245, s12
    buffer_store_dwordx4 v[20:23], v215, s[52:55], s6 offen sc1
    s_add_u32 s6, s6, 303104
    v_cmp_eq_u32 vcc, 2, v213
    s_nop 1
    v_cndmask_b32 v196, v196, v20, vcc
    v_cndmask_b32 v197, v197, v21, vcc
    v_cndmask_b32 v198, v198, v22, vcc
    v_cndmask_b32 v199, v199, v23, vcc
    v_perm_b32 v24, v225, v221, s13
    v_perm_b32 v25, v233, v229, s13
    v_perm_b32 v26, v241, v237, s13
    v_perm_b32 v27, v249, v245, s13
    buffer_store_dwordx4 v[24:27], v215, s[52:55], s6 offen sc1
    s_add_u32 s6, s6, 303104
    v_cmp_eq_u32 vcc, 3, v213
    s_nop 1
    v_cndmask_b32 v196, v196, v24, vcc
    v_cndmask_b32 v197, v197, v25, vcc
    v_cndmask_b32 v198, v198, v26, vcc
    v_cndmask_b32 v199, v199, v27, vcc
    v_perm_b32 v28, v226, v222, s12
    v_perm_b32 v29, v234, v230, s12
    v_perm_b32 v30, v242, v238, s12
    v_perm_b32 v31, v250, v246, s12
    buffer_store_dwordx4 v[28:31], v215, s[52:55], s6 offen sc1
    s_add_u32 s6, s6, 303104
    v_cmp_eq_u32 vcc, 4, v213
    s_nop 1
    v_cndmask_b32 v196, v196, v28, vcc
    v_cndmask_b32 v197, v197, v29, vcc
    v_cndmask_b32 v198, v198, v30, vcc
    v_cndmask_b32 v199, v199, v31, vcc
    v_perm_b32 v32, v226, v222, s13
    v_perm_b32 v33, v234, v230, s13
    v_perm_b32 v34, v242, v238, s13
    v_perm_b32 v35, v250, v246, s13
    buffer_store_dwordx4 v[32:35], v215, s[52:55], s6 offen sc1
    s_add_u32 s6, s6, 303104
    v_cmp_eq_u32 vcc, 5, v213
    s_nop 1
    v_cndmask_b32 v196, v196, v32, vcc
    v_cndmask_b32 v197, v197, v33, vcc
    v_cndmask_b32 v198, v198, v34, vcc
    v_cndmask_b32 v199, v199, v35, vcc
    v_perm_b32 v188, v227, v223, s12
    v_perm_b32 v189, v235, v231, s12
    v_perm_b32 v190, v243, v239, s12
    v_perm_b32 v191, v251, v247, s12
    buffer_store_dwordx4 v[188:191], v215, s[52:55], s6 offen sc1
    s_add_u32 s6, s6, 303104
    v_cmp_eq_u32 vcc, 6, v213
    s_nop 1
    v_cndmask_b32 v196, v196, v188, vcc
    v_cndmask_b32 v197, v197, v189, vcc
    v_cndmask_b32 v198, v198, v190, vcc
    v_cndmask_b32 v199, v199, v191, vcc
    v_perm_b32 v192, v227, v223, s13
    v_perm_b32 v193, v235, v231, s13
    v_perm_b32 v194, v243, v239, s13
    v_perm_b32 v195, v251, v247, s13
    buffer_store_dwordx4 v[192:195], v215, s[52:55], s6 offen sc1
    v_cmp_eq_u32 vcc, 7, v213
    s_nop 1
    v_cndmask_b32 v196, v196, v192, vcc
    v_cndmask_b32 v197, v197, v193, vcc
    v_cndmask_b32 v198, v198, v194, vcc
    v_cndmask_b32 v199, v199, v195, vcc
    v_alignbit_b32 v196, v196, v196, 16
    v_xor_b32 v196, 0x80000000, v196
    v_alignbit_b32 v197, v197, v197, 16
    v_xor_b32 v197, 0x80000000, v197
    v_alignbit_b32 v198, v198, v198, 16
    v_xor_b32 v198, 0x80000000, v198
    v_alignbit_b32 v199, v199, v199, 16
    v_xor_b32 v199, 0x80000000, v199
    buffer_store_dwordx4 v[196:199], v212, s[52:55], s7 offen
    s_branch K1_nomod
K1_mod:
    v_and_b32 v6, 63, v0
    v_min_u32 v6, 35, v6
    v_lshlrev_b32 v6, 2, v6
    s_mov_b32 s43, 0x100000
K1_poll:
    global_load_dword v12, v6, s[8:9] sc1
    s_sub_u32 s43, s43, 1
    s_cbranch_scc1 K1_polled
    s_waitcnt vmcnt(0)
    v_cmp_eq_u32 vcc, 0, v12
    s_cbranch_vccnz K1_poll
K1_polled:
    v_cmp_gt_u32 vcc, 144, v0
    s_nop 0
    s_and_saveexec_b64 s[40:41], vcc
    s_movk_i32 s42, 4608
    s_movk_i32 s43, 9216
    buffer_load_dwordx4 v[188:191], v5, s[24:27], 0 offen offset:0 sc1
    buffer_load_dwordx4 v[192:195], v5, s[24:27], 0 offen offset:2304 sc1
    buffer_load_dwordx4 v[196:199], v5, s[24:27], s42 offen offset:0 sc1
    buffer_load_dwordx4 v[200:203], v5, s[24:27], s42 offen offset:2304 sc1
    s_waitcnt vmcnt(0)
    v_add_f32 v188, v188, v196
    v_add_f32 v189, v189, v197
    v_add_f32 v190, v190, v198
    v_add_f32 v191, v191, v199
    v_add_f32 v192, v192, v200
    v_add_f32 v193, v193, v201
    v_add_f32 v194, v194, v202
    v_add_f32 v195, v195, v203
    v_cvt_pk_bf16_f32 v196, v192, v193
    v_cvt_pk_bf16_f32 v197, v194, v195
    v_lshlrev_b32 v192, 16, v196
    v_and_b32 v193, 0xffff0000, v196
    v_lshlrev_b32 v194, 16, v197
    v_and_b32 v195, 0xffff0000, v197
    v_add_f32 v192, 1.0, v192
    v_add_f32 v193, 1.0, v193
    v_add_f32 v194, 1.0, v194
    v_add_f32 v195, 1.0, v195
    v_cvt_pk_bf16_f32 v188, v188, v192
    v_cvt_pk_bf16_f32 v189, v189, v193
    v_cvt_pk_bf16_f32 v190, v190, v194
    v_cvt_pk_bf16_f32 v191, v191, v195
    ds_write_b128 v5, v[188:191] offset:39936
    s_mov_b64 exec, s[40:41]
K1_nomod:
    v_lshlrev_b32 v5, 5, v3
    s_waitcnt lgkmcnt(0)
    s_barrier
    ds_read_b128 v[188:191], v5 offset:39936
    ds_read_b128 v[192:195], v5 offset:39952
    ds_read_b128 v[196:199], v5 offset:41088
    ds_read_b128 v[200:203], v5 offset:41104
    s_waitcnt lgkmcnt(0)
    v_and_b32 v17, 0xffff0000, v188
    v_lshlrev_b32 v18, 16, v188
    v_fma_f32 v140, v140, v17, v18
    v_and_b32 v17, 0xffff0000, v189
    v_lshlrev_b32 v18, 16, v189
    v_fma_f32 v141, v141, v17, v18
    v_and_b32 v17, 0xffff0000, v190
    v_lshlrev_b32 v18, 16, v190
    v_fma_f32 v142, v142, v17, v18
    v_and_b32 v17, 0xffff0000, v191
    v_lshlrev_b32 v18, 16, v191
    v_fma_f32 v143, v143, v17, v18
    v_and_b32 v17, 0xffff0000, v192
    v_lshlrev_b32 v18, 16, v192
    v_fma_f32 v144, v144, v17, v18
    v_and_b32 v17, 0xffff0000, v193
    v_lshlrev_b32 v18, 16, v193
    v_fma_f32 v145, v145, v17, v18
    v_and_b32 v17, 0xffff0000, v194
    v_lshlrev_b32 v18, 16, v194
    v_fma_f32 v146, v146, v17, v18
    v_and_b32 v17, 0xffff0000, v195
    v_lshlrev_b32 v18, 16, v195
    v_fma_f32 v147, v147, v17, v18
    v_and_b32 v17, 0xffff0000, v196
    v_lshlrev_b32 v18, 16, v196
    v_fma_f32 v164, v164, v17, v18
    v_and_b32 v17, 0xffff0000, v197
    v_lshlrev_b32 v18, 16, v197
    v_fma_f32 v165, v165, v17, v18
    v_and_b32 v17, 0xffff0000, v198
    v_lshlrev_b32 v18, 16, v198
    v_fma_f32 v166, v166, v17, v18
    v_and_b32 v17, 0xffff0000, v199
    v_lshlrev_b32 v18, 16, v199
    v_fma_f32 v167, v167, v17, v18
    v_and_b32 v17, 0xffff0000, v200
    v_lshlrev_b32 v18, 16, v200
    v_fma_f32 v168, v168, v17, v18
    v_and_b32 v17, 0xffff0000, v201
    v_lshlrev_b32 v18, 16, v201
    v_fma_f32 v169, v169, v17, v18
    v_and_b32 v17, 0xffff0000, v202
    v_lshlrev_b32 v18, 16, v202
    v_fma_f32 v170, v170, v17, v18
    v_and_b32 v17, 0xffff0000, v203
    v_lshlrev_b32 v18, 16, v203
    v_fma_f32 v171, v171, v17, v18
    ds_read_b128 v[188:191], v5 offset:40320
    ds_read_b128 v[192:195], v5 offset:40336
    ds_read_b128 v[196:199], v5 offset:41472
    ds_read_b128 v[200:203], v5 offset:41488
    v_add_u32 v16, 0, v3
    v_mul_u32_u24 v17, 57, v16
    v_lshrrev_b32 v17, 9, v17
    v_mul_u32_u24 v17, 279, v17
    v_mul_u32_u24 v18, 9, v2
    v_add3_u32 v16, v16, v17, v18
    v_lshlrev_b32 v16, 4, v16
    v_add_f32 v17, v140, v164
    v_add_f32 v18, v141, v165
    v_cvt_pk_bf16_f32 v20, v17, v18
    v_sub_f32 v17, v140, v164
    v_sub_f32 v18, v141, v165
    v_cvt_pk_bf16_f32 v24, v17, v18
    v_add_f32 v17, v142, v166
    v_add_f32 v18, v143, v167
    v_cvt_pk_bf16_f32 v21, v17, v18
    v_sub_f32 v17, v142, v166
    v_sub_f32 v18, v143, v167
    v_cvt_pk_bf16_f32 v25, v17, v18
    v_add_f32 v17, v144, v168
    v_add_f32 v18, v145, v169
    v_cvt_pk_bf16_f32 v22, v17, v18
    v_sub_f32 v17, v144, v168
    v_sub_f32 v18, v145, v169
    v_cvt_pk_bf16_f32 v26, v17, v18
    v_add_f32 v17, v146, v170
    v_add_f32 v18, v147, v171
    v_cvt_pk_bf16_f32 v23, v17, v18
    v_sub_f32 v17, v146, v170
    v_sub_f32 v18, v147, v171
    v_cvt_pk_bf16_f32 v27, v17, v18
    ds_write_b128 v16, v[20:23]
    ds_write_b128 v16, v[24:27] offset:18432
    s_nop 1
    s_waitcnt lgkmcnt(0)
    v_and_b32 v17, 0xffff0000, v188
    v_lshlrev_b32 v18, 16, v188
    v_fma_f32 v148, v148, v17, v18
    v_and_b32 v17, 0xffff0000, v189
    v_lshlrev_b32 v18, 16, v189
    v_fma_f32 v149, v149, v17, v18
    v_and_b32 v17, 0xffff0000, v190
    v_lshlrev_b32 v18, 16, v190
    v_fma_f32 v150, v150, v17, v18
    v_and_b32 v17, 0xffff0000, v191
    v_lshlrev_b32 v18, 16, v191
    v_fma_f32 v151, v151, v17, v18
    v_and_b32 v17, 0xffff0000, v192
    v_lshlrev_b32 v18, 16, v192
    v_fma_f32 v152, v152, v17, v18
    v_and_b32 v17, 0xffff0000, v193
    v_lshlrev_b32 v18, 16, v193
    v_fma_f32 v153, v153, v17, v18
    v_and_b32 v17, 0xffff0000, v194
    v_lshlrev_b32 v18, 16, v194
    v_fma_f32 v154, v154, v17, v18
    v_and_b32 v17, 0xffff0000, v195
    v_lshlrev_b32 v18, 16, v195
    v_fma_f32 v155, v155, v17, v18
    v_and_b32 v17, 0xffff0000, v196
    v_lshlrev_b32 v18, 16, v196
    v_fma_f32 v172, v172, v17, v18
    v_and_b32 v17, 0xffff0000, v197
    v_lshlrev_b32 v18, 16, v197
    v_fma_f32 v173, v173, v17, v18
    v_and_b32 v17, 0xffff0000, v198
    v_lshlrev_b32 v18, 16, v198
    v_fma_f32 v174, v174, v17, v18
    v_and_b32 v17, 0xffff0000, v199
    v_lshlrev_b32 v18, 16, v199
    v_fma_f32 v175, v175, v17, v18
    v_and_b32 v17, 0xffff0000, v200
    v_lshlrev_b32 v18, 16, v200
    v_fma_f32 v176, v176, v17, v18
    v_and_b32 v17, 0xffff0000, v201
    v_lshlrev_b32 v18, 16, v201
    v_fma_f32 v177, v177, v17, v18
    v_and_b32 v17, 0xffff0000, v202
    v_lshlrev_b32 v18, 16, v202
    v_fma_f32 v178, v178, v17, v18
    v_and_b32 v17, 0xffff0000, v203
    v_lshlrev_b32 v18, 16, v203
    v_fma_f32 v179, v179, v17, v18
    ds_read_b128 v[188:191], v5 offset:40704
    ds_read_b128 v[192:195], v5 offset:40720
    ds_read_b128 v[196:199], v5 offset:41856
    ds_read_b128 v[200:203], v5 offset:41872
    v_add_u32 v16, 12, v3
    v_mul_u32_u24 v17, 57, v16
    v_lshrrev_b32 v17, 9, v17
    v_mul_u32_u24 v17, 279, v17
    v_mul_u32_u24 v18, 9, v2
    v_add3_u32 v16, v16, v17, v18
    v_lshlrev_b32 v16, 4, v16
    v_add_f32 v17, v148, v172
    v_add_f32 v18, v149, v173
    v_cvt_pk_bf16_f32 v20, v17, v18
    v_sub_f32 v17, v148, v172
    v_sub_f32 v18, v149, v173
    v_cvt_pk_bf16_f32 v24, v17, v18
    v_add_f32 v17, v150, v174
    v_add_f32 v18, v151, v175
    v_cvt_pk_bf16_f32 v21, v17, v18
    v_sub_f32 v17, v150, v174
    v_sub_f32 v18, v151, v175
    v_cvt_pk_bf16_f32 v25, v17, v18
    v_add_f32 v17, v152, v176
    v_add_f32 v18, v153, v177
    v_cvt_pk_bf16_f32 v22, v17, v18
    v_sub_f32 v17, v152, v176
    v_sub_f32 v18, v153, v177
    v_cvt_pk_bf16_f32 v26, v17, v18
    v_add_f32 v17, v154, v178
    v_add_f32 v18, v155, v179
    v_cvt_pk_bf16_f32 v23, v17, v18
    v_sub_f32 v17, v154, v178
    v_sub_f32 v18, v155, v179
    v_cvt_pk_bf16_f32 v27, v17, v18
    ds_write_b128 v16, v[20:23]
    ds_write_b128 v16, v[24:27] offset:18432
    s_nop 1
    s_waitcnt lgkmcnt(0)
    v_and_b32 v17, 0xffff0000, v188
    v_lshlrev_b32 v18, 16, v188
    v_fma_f32 v156, v156, v17, v18
    v_and_b32 v17, 0xffff0000, v189
    v_lshlrev_b32 v18, 16, v189
    v_fma_f32 v157, v157, v17, v18
    v_and_b32 v17, 0xffff0000, v190
    v_lshlrev_b32 v18, 16, v190
    v_fma_f32 v158, v158, v17, v18
    v_and_b32 v17, 0xffff0000, v191
    v_lshlrev_b32 v18, 16, v191
    v_fma_f32 v159, v159, v17, v18
    v_and_b32 v17, 0xffff0000, v192
    v_lshlrev_b32 v18, 16, v192
    v_fma_f32 v160, v160, v17, v18
    v_and_b32 v17, 0xffff0000, v193
    v_lshlrev_b32 v18, 16, v193
    v_fma_f32 v161, v161, v17, v18
    v_and_b32 v17, 0xffff0000, v194
    v_lshlrev_b32 v18, 16, v194
    v_fma_f32 v162, v162, v17, v18
    v_and_b32 v17, 0xffff0000, v195
    v_lshlrev_b32 v18, 16, v195
    v_fma_f32 v163, v163, v17, v18
    v_and_b32 v17, 0xffff0000, v196
    v_lshlrev_b32 v18, 16, v196
    v_fma_f32 v180, v180, v17, v18
    v_and_b32 v17, 0xffff0000, v197
    v_lshlrev_b32 v18, 16, v197
    v_fma_f32 v181, v181, v17, v18
    v_and_b32 v17, 0xffff0000, v198
    v_lshlrev_b32 v18, 16, v198
    v_fma_f32 v182, v182, v17, v18
    v_and_b32 v17, 0xffff0000, v199
    v_lshlrev_b32 v18, 16, v199
    v_fma_f32 v183, v183, v17, v18
    v_and_b32 v17, 0xffff0000, v200
    v_lshlrev_b32 v18, 16, v200
    v_fma_f32 v184, v184, v17, v18
    v_and_b32 v17, 0xffff0000, v201
    v_lshlrev_b32 v18, 16, v201
    v_fma_f32 v185, v185, v17, v18
    v_and_b32 v17, 0xffff0000, v202
    v_lshlrev_b32 v18, 16, v202
    v_fma_f32 v186, v186, v17, v18
    v_and_b32 v17, 0xffff0000, v203
    v_lshlrev_b32 v18, 16, v203
    v_fma_f32 v187, v187, v17, v18
    v_add_u32 v16, 24, v3
    v_mul_u32_u24 v17, 57, v16
    v_lshrrev_b32 v17, 9, v17
    v_mul_u32_u24 v17, 279, v17
    v_mul_u32_u24 v18, 9, v2
    v_add3_u32 v16, v16, v17, v18
    v_lshlrev_b32 v16, 4, v16
    v_add_f32 v17, v156, v180
    v_add_f32 v18, v157, v181
    v_cvt_pk_bf16_f32 v20, v17, v18
    v_sub_f32 v17, v156, v180
    v_sub_f32 v18, v157, v181
    v_cvt_pk_bf16_f32 v24, v17, v18
    v_add_f32 v17, v158, v182
    v_add_f32 v18, v159, v183
    v_cvt_pk_bf16_f32 v21, v17, v18
    v_sub_f32 v17, v158, v182
    v_sub_f32 v18, v159, v183
    v_cvt_pk_bf16_f32 v25, v17, v18
    v_add_f32 v17, v160, v184
    v_add_f32 v18, v161, v185
    v_cvt_pk_bf16_f32 v22, v17, v18
    v_sub_f32 v17, v160, v184
    v_sub_f32 v18, v161, v185
    v_cvt_pk_bf16_f32 v26, v17, v18
    v_add_f32 v17, v162, v186
    v_add_f32 v18, v163, v187
    v_cvt_pk_bf16_f32 v23, v17, v18
    v_sub_f32 v17, v162, v186
    v_sub_f32 v18, v163, v187
    v_cvt_pk_bf16_f32 v27, v17, v18
    ds_write_b128 v16, v[20:23]
    ds_write_b128 v16, v[24:27] offset:18432
    v_mul_u32_u24 v4, 288, v8
    v_mul_u32_u24 v5, 9, v7
    v_add_lshl_u32 v4, v4, v5, 4
    s_mul_i32 s38, s37, 18432
    v_add_u32 v4, s38, v4
    s_waitcnt lgkmcnt(0)
    s_barrier
    ds_read_b128 v[140:143], v4 offset:0
    ds_read_b128 v[144:147], v4 offset:2304
    ds_read_b128 v[148:151], v4 offset:16
    ds_read_b128 v[152:155], v4 offset:2320
    ds_read_b128 v[156:159], v4 offset:32
    ds_read_b128 v[160:163], v4 offset:2336
    ds_read_b128 v[164:167], v4 offset:48
    ds_read_b128 v[168:171], v4 offset:2352
    ds_read_b128 v[172:175], v4 offset:64
    ds_read_b128 v[176:179], v4 offset:2368
    ds_read_b128 v[180:183], v4 offset:80
    ds_read_b128 v[184:187], v4 offset:2384
    s_waitcnt lgkmcnt(10)
    v_mfma_f32_16x16x32_bf16 v[12:15], v[140:143], v[36:39], 0
    v_mfma_f32_16x16x32_bf16 v[20:23], v[140:143], v[72:75], 0
    v_mfma_f32_16x16x32_bf16 v[16:19], v[144:147], v[36:39], 0
    v_mfma_f32_16x16x32_bf16 v[24:27], v[144:147], v[72:75], 0
    ds_read_b128 v[188:191], v4 offset:96
    ds_read_b128 v[192:195], v4 offset:2400
    s_waitcnt lgkmcnt(10)
    v_mfma_f32_16x16x32_bf16 v[12:15], v[148:151], v[40:43], v[12:15]
    v_mfma_f32_16x16x32_bf16 v[20:23], v[148:151], v[76:79], v[20:23]
    v_mfma_f32_16x16x32_bf16 v[16:19], v[152:155], v[40:43], v[16:19]
    v_mfma_f32_16x16x32_bf16 v[24:27], v[152:155], v[76:79], v[24:27]
    ds_read_b128 v[196:199], v4 offset:112
    ds_read_b128 v[200:203], v4 offset:2416
    s_waitcnt lgkmcnt(10)
    v_mfma_f32_16x16x32_bf16 v[12:15], v[156:159], v[44:47], v[12:15]
    v_mfma_f32_16x16x32_bf16 v[20:23], v[156:159], v[80:83], v[20:23]
    v_mfma_f32_16x16x32_bf16 v[16:19], v[160:163], v[44:47], v[16:19]
    v_mfma_f32_16x16x32_bf16 v[24:27], v[160:163], v[80:83], v[24:27]
    ds_read_b128 v[204:207], v4 offset:128
    ds_read_b128 v[208:211], v4 offset:2432
    s_waitcnt lgkmcnt(10)
    v_mfma_f32_16x16x32_bf16 v[12:15], v[164:167], v[48:51], v[12:15]
    v_mfma_f32_16x16x32_bf16 v[20:23], v[164:167], v[84:87], v[20:23]
    v_mfma_f32_16x16x32_bf16 v[16:19], v[168:171], v[48:51], v[16:19]
    v_mfma_f32_16x16x32_bf16 v[24:27], v[168:171], v[84:87], v[24:27]
    s_waitcnt lgkmcnt(8)
    v_mfma_f32_16x16x32_bf16 v[12:15], v[172:175], v[52:55], v[12:15]
    v_mfma_f32_16x16x32_bf16 v[20:23], v[172:175], v[88:91], v[20:23]
    v_mfma_f32_16x16x32_bf16 v[16:19], v[176:179], v[52:55], v[16:19]
    v_mfma_f32_16x16x32_bf16 v[24:27], v[176:179], v[88:91], v[24:27]
    s_waitcnt lgkmcnt(6)
    v_mfma_f32_16x16x32_bf16 v[12:15], v[180:183], v[56:59], v[12:15]
    v_mfma_f32_16x16x32_bf16 v[20:23], v[180:183], v[92:95], v[20:23]
    v_mfma_f32_16x16x32_bf16 v[16:19], v[184:187], v[56:59], v[16:19]
    v_mfma_f32_16x16x32_bf16 v[24:27], v[184:187], v[92:95], v[24:27]
    s_waitcnt lgkmcnt(4)
    v_mfma_f32_16x16x32_bf16 v[12:15], v[188:191], v[60:63], v[12:15]
    v_mfma_f32_16x16x32_bf16 v[20:23], v[188:191], v[96:99], v[20:23]
    v_mfma_f32_16x16x32_bf16 v[16:19], v[192:195], v[60:63], v[16:19]
    v_mfma_f32_16x16x32_bf16 v[24:27], v[192:195], v[96:99], v[24:27]
    s_waitcnt lgkmcnt(2)
    v_mfma_f32_16x16x32_bf16 v[12:15], v[196:199], v[64:67], v[12:15]
    v_mfma_f32_16x16x32_bf16 v[20:23], v[196:199], v[100:103], v[20:23]
    v_mfma_f32_16x16x32_bf16 v[16:19], v[200:203], v[64:67], v[16:19]
    v_mfma_f32_16x16x32_bf16 v[24:27], v[200:203], v[100:103], v[24:27]
    s_waitcnt lgkmcnt(0)
    v_mfma_f32_16x16x32_bf16 v[12:15], v[204:207], v[68:71], v[12:15]
    v_mfma_f32_16x16x32_bf16 v[20:23], v[204:207], v[104:107], v[20:23]
    v_mfma_f32_16x16x32_bf16 v[16:19], v[208:211], v[68:71], v[16:19]
    v_mfma_f32_16x16x32_bf16 v[24:27], v[208:211], v[104:107], v[24:27]
    v_mul_u32_u24 v4, 147456, v8
    v_lshl_add_u32 v4, v7, 2, v4
    s_lshl_b32 s38, s36, 12
    s_lshl_b32 s39, s14, 6
    s_add_u32 s38, s38, s39
    v_add_u32 v6, s36, v7
    v_cmp_eq_u32 vcc, 0, v6
    v_mov_b32 v5, 0xffff
    s_nop 0
    v_cndmask_b32 v5, -1, v5, vcc
    v_cvt_pk_bf16_f32 v60, v12, v20
    v_cvt_pk_bf16_f32 v61, v13, v21
    v_cvt_pk_bf16_f32 v62, v14, v22
    v_cvt_pk_bf16_f32 v63, v15, v23
    v_cvt_pk_bf16_f32 v64, v16, v24
    v_cvt_pk_bf16_f32 v65, v17, v25
    v_cvt_pk_bf16_f32 v66, v18, v26
    v_cvt_pk_bf16_f32 v67, v19, v27
    v_and_b32 v36, v60, v5
    v_and_b32 v37, v61, v5
    v_and_b32 v38, v62, v5
    v_and_b32 v39, v63, v5
    v_and_b32 v40, v64, v5
    v_and_b32 v41, v65, v5
    v_and_b32 v42, v66, v5
    v_and_b32 v43, v67, v5
    v_mfma_f32_16x16x32_bf16 v[44:47], v[108:111], v[36:39], 0
    v_mfma_f32_16x16x32_bf16 v[48:51], v[116:119], v[36:39], 0
    v_mfma_f32_16x16x32_bf16 v[52:55], v[124:127], v[36:39], 0
    v_mfma_f32_16x16x32_bf16 v[56:59], v[132:135], v[36:39], 0
    v_mfma_f32_16x16x32_bf16 v[44:47], v[112:115], v[40:43], v[44:47]
    v_mfma_f32_16x16x32_bf16 v[48:51], v[120:123], v[40:43], v[48:51]
    v_mfma_f32_16x16x32_bf16 v[52:55], v[128:131], v[40:43], v[52:55]
    v_mfma_f32_16x16x32_bf16 v[56:59], v[136:139], v[40:43], v[56:59]
    s_nop 4
    v_cvt_pk_bf16_f32 v72, v44, v45
    s_add_u32 s39, s38, 0
    buffer_store_dword v72, v4, s[32:35], s39 offen
    v_cvt_pk_bf16_f32 v73, v46, v47
    s_add_u32 s39, s38, 73728
    buffer_store_dword v73, v4, s[32:35], s39 offen
    v_cvt_pk_bf16_f32 v74, v48, v49
    s_add_u32 s39, s38, 589824
    buffer_store_dword v74, v4, s[32:35], s39 offen
    v_cvt_pk_bf16_f32 v75, v50, v51
    s_add_u32 s39, s38, 663552
    buffer_store_dword v75, v4, s[32:35], s39 offen
    v_cvt_pk_bf16_f32 v76, v52, v53
    s_add_u32 s39, s38, 1179648
    buffer_store_dword v76, v4, s[32:35], s39 offen
    v_cvt_pk_bf16_f32 v77, v54, v55
    s_add_u32 s39, s38, 1253376
    buffer_store_dword v77, v4, s[32:35], s39 offen
    v_cvt_pk_bf16_f32 v78, v56, v57
    s_add_u32 s39, s38, 1769472
    buffer_store_dword v78, v4, s[32:35], s39 offen
    v_cvt_pk_bf16_f32 v79, v58, v59
    s_add_u32 s39, s38, 1843200
    buffer_store_dword v79, v4, s[32:35], s39 offen
    s_cmp_lg_u32 s36, 0
    s_cbranch_scc1 K1_fin
    v_lshrrev_b32 v60, 16, v60
    v_lshrrev_b32 v61, 16, v61
    v_lshrrev_b32 v62, 16, v62
    v_lshrrev_b32 v63, 16, v63
    v_lshrrev_b32 v64, 16, v64
    v_lshrrev_b32 v65, 16, v65
    v_lshrrev_b32 v66, 16, v66
    v_lshrrev_b32 v67, 16, v67
    v_mfma_f32_16x16x32_bf16 v[44:47], v[108:111], v[60:63], 0
    v_mfma_f32_16x16x32_bf16 v[48:51], v[116:119], v[60:63], 0
    v_mfma_f32_16x16x32_bf16 v[52:55], v[124:127], v[60:63], 0
    v_mfma_f32_16x16x32_bf16 v[56:59], v[132:135], v[60:63], 0
    v_mfma_f32_16x16x32_bf16 v[44:47], v[112:115], v[64:67], v[44:47]
    v_mfma_f32_16x16x32_bf16 v[48:51], v[120:123], v[64:67], v[48:51]
    v_mfma_f32_16x16x32_bf16 v[52:55], v[128:131], v[64:67], v[52:55]
    v_mfma_f32_16x16x32_bf16 v[56:59], v[136:139], v[64:67], v[56:59]
    v_lshlrev_b32 v4, 3, v8
    s_lshl_b32 s38, s14, 6
    v_cmp_eq_u32 vcc, 0, v7
    s_nop 0
    s_and_saveexec_b64 s[40:41], vcc
    v_cvt_pk_bf16_f32 v80, v44, v45
    s_add_u32 s39, s38, 2359296
    buffer_store_dword v80, v4, s[32:35], s39 offen
    v_cvt_pk_bf16_f32 v81, v46, v47
    s_add_u32 s39, s38, 2359300
    buffer_store_dword v81, v4, s[32:35], s39 offen
    v_cvt_pk_bf16_f32 v82, v48, v49
    s_add_u32 s39, s38, 2359328
    buffer_store_dword v82, v4, s[32:35], s39 offen
    v_cvt_pk_bf16_f32 v83, v50, v51
    s_add_u32 s39, s38, 2359332
    buffer_store_dword v83, v4, s[32:35], s39 offen
    v_cvt_pk_bf16_f32 v84, v52, v53
    s_add_u32 s39, s38, 2363392
    buffer_store_dword v84, v4, s[32:35], s39 offen
    v_cvt_pk_bf16_f32 v85, v54, v55
    s_add_u32 s39, s38, 2363396
    buffer_store_dword v85, v4, s[32:35], s39 offen
    v_cvt_pk_bf16_f32 v86, v56, v57
    s_add_u32 s39, s38, 2363424
    buffer_store_dword v86, v4, s[32:35], s39 offen
    v_cvt_pk_bf16_f32 v87, v58, v59
    s_add_u32 s39, s38, 2363428
    buffer_store_dword v87, v4, s[32:35], s39 offen
K1_fin:
K1_end:
    s_endpgm
.globl k2_kernel
.p2align 8
.type k2_kernel,@function
k2_kernel:
    s_cmp_ge_u32 s2, 578
    s_cbranch_scc1 K2_end
    s_load_dwordx2 s[8:9], s[0:1], 88
    s_lshr_b32 s14, s2, 3
    s_mul_i32 s12, s14, 57
    s_lshr_b32 s12, s12, 10
    s_mul_i32 s13, s12, 18
    s_sub_u32 s14, s14, s13
    s_and_b32 s13, s2, 7
    s_lshl2_add_u32 s18, s13, s12
    s_mul_i32 s13, s18, 18
    s_add_u32 s13, s13, s14
    s_lshl_b32 s16, s14, 11
    s_lshl_b32 s17, s18, 6
    s_add_u32 s16, s16, s17
    s_cmp_ge_u32 s14, 9
    s_cselect_b32 s19, -287, 0
    s_lshl_b32 s10, s14, 5
    s_add_u32 s19, s19, s10
    s_and_b32 s10, s18, 7
    s_add_u32 s19, s19, s10
    s_mul_i32 s18, s18, 592
    v_and_b32 v1, 15, v0
    v_lshrrev_b32 v2, 4, v0
    v_lshlrev_b32 v3, 4, v0
    v_lshrrev_b32 v6, 2, v1
    v_and_b32 v4, 3, v1
    v_lshl_add_u32 v4, v4, 2, v6
    v_lshl_add_u32 v6, v4, 1, s19
    v_mul_u32_u24 v5, 37, v2
    v_lshrrev_b32 v4, 3, v6
    v_add3_u32 v5, v5, v4, s18
    v_and_b32 v6, 7, v6
    v_mul_u32_u24 v6, 18944, v6
    v_add_lshl_u32 v4, v5, v6, 4
    s_cmp_lt_u32 s2, 576
    s_cbranch_scc1 K2_reg
    s_and_b32 s15, s2, 1
    s_mov_b32 s13, s2
    s_lshl_b32 s16, s15, 6
    s_add_u32 s16, s16, 36864
    s_mul_i32 s10, s15, 9472
    s_add_u32 s10, s10, 2424832
    v_add_u32 v4, s10, v3
K2_reg:
    s_lshl_b32 s3, s13, 12
    s_movk_i32 s10, 4736
    s_mov_b32 m0, 0
    v_cvt_f32_u32 v56, v1
    v_mul_f32 v56, 0x3d000000, v56
    v_add_f32 v57, 0x3c800000, v56
    v_lshlrev_b32 v58, 3, v2
    v_cvt_f32_u32 v58, v58
    v_mul_f32 v59, v58, v57
    v_mul_f32 v58, v58, v56
    s_waitcnt lgkmcnt(0)
    s_add_u32 s28, s8, 65536
    s_addc_u32 s29, s9, 0
    s_mov_b32 s30, 2367488
    s_mov_b32 s31, 0x20000
    s_add_u32 s20, s8, 54525952
    s_addc_u32 s21, s9, 0
    s_mov_b32 s22, 2443776
    s_mov_b32 s23, 0x20000
    buffer_load_dwordx4 v3, s[28:31], s3 offen offset:0 lds
    buffer_load_dwordx4 v3, s[28:31], s3 offen offset:1024 lds
    buffer_load_dwordx4 v3, s[28:31], s3 offen offset:2048 lds
    buffer_load_dwordx4 v3, s[28:31], s3 offen offset:3072 lds
    buffer_load_dwordx4 v[24:27], v4, s[20:23], 0 offen offset:0
    buffer_load_dwordx4 v[28:31], v4, s[20:23], 0 offen offset:2368
    buffer_load_dwordx4 v[32:35], v4, s[20:23], s10 offen offset:0
    buffer_load_dwordx4 v[36:39], v4, s[20:23], s10 offen offset:2368
    v_lshlrev_b32 v3, 2, v0
    v_fmamk_f32 v60, v56, 0x00000000, v58
    v_fmamk_f32 v61, v56, 0x40000000, v58
    v_fmamk_f32 v62, v56, 0x40800000, v58
    v_fmamk_f32 v63, v56, 0x40c00000, v58
    v_cos_f32 v64, v60
    v_sin_f32 v68, v60
    v_cos_f32 v65, v61
    v_sin_f32 v69, v61
    v_cos_f32 v66, v62
    v_sin_f32 v70, v62
    v_cos_f32 v67, v63
    v_sin_f32 v71, v63
    v_cvt_pk_bf16_f32 v88, v64, v68
    v_cvt_pk_bf16_f32 v96, -v68, v64
    v_cvt_pk_bf16_f32 v89, v65, v69
    v_cvt_pk_bf16_f32 v97, -v69, v65
    v_cvt_pk_bf16_f32 v90, v66, v70
    v_cvt_pk_bf16_f32 v98, -v70, v66
    v_cvt_pk_bf16_f32 v91, v67, v71
    v_cvt_pk_bf16_f32 v99, -v71, v67
    v_fmamk_f32 v60, v56, 0x3f800000, v58
    v_fmamk_f32 v61, v56, 0x40400000, v58
    v_fmamk_f32 v62, v56, 0x40a00000, v58
    v_fmamk_f32 v63, v56, 0x40e00000, v58
    v_cos_f32 v64, v60
    v_sin_f32 v68, v60
    v_cos_f32 v65, v61
    v_sin_f32 v69, v61
    v_cos_f32 v66, v62
    v_sin_f32 v70, v62
    v_cos_f32 v67, v63
    v_sin_f32 v71, v63
    v_cvt_pk_bf16_f32 v92, v64, v68
    v_cvt_pk_bf16_f32 v100, -v68, v64
    v_cvt_pk_bf16_f32 v93, v65, v69
    v_cvt_pk_bf16_f32 v101, -v69, v65
    v_cvt_pk_bf16_f32 v94, v66, v70
    v_cvt_pk_bf16_f32 v102, -v70, v66
    v_cvt_pk_bf16_f32 v95, v67, v71
    v_cvt_pk_bf16_f32 v103, -v71, v67
    v_fmamk_f32 v60, v57, 0x00000000, v59
    v_fmamk_f32 v61, v57, 0x40000000, v59
    v_fmamk_f32 v62, v57, 0x40800000, v59
    v_fmamk_f32 v63, v57, 0x40c00000, v59
    v_cos_f32 v64, v60
    v_sin_f32 v68, v60
    v_cos_f32 v65, v61
    v_sin_f32 v69, v61
    v_cos_f32 v66, v62
    v_sin_f32 v70, v62
    v_cos_f32 v67, v63
    v_sin_f32 v71, v63
    v_cvt_pk_bf16_f32 v104, v64, v68
    v_cvt_pk_bf16_f32 v112, -v68, v64
    v_cvt_pk_bf16_f32 v105, v65, v69
    v_cvt_pk_bf16_f32 v113, -v69, v65
    v_cvt_pk_bf16_f32 v106, v66, v70
    v_cvt_pk_bf16_f32 v114, -v70, v66
    v_cvt_pk_bf16_f32 v107, v67, v71
    v_cvt_pk_bf16_f32 v115, -v71, v67
    v_fmamk_f32 v60, v57, 0x3f800000, v59
    v_fmamk_f32 v61, v57, 0x40400000, v59
    v_fmamk_f32 v62, v57, 0x40a00000, v59
    v_fmamk_f32 v63, v57, 0x40e00000, v59
    v_cos_f32 v64, v60
    v_sin_f32 v68, v60
    v_cos_f32 v65, v61
    v_sin_f32 v69, v61
    v_cos_f32 v66, v62
    v_sin_f32 v70, v62
    v_cos_f32 v67, v63
    v_sin_f32 v71, v63
    v_cvt_pk_bf16_f32 v108, v64, v68
    v_cvt_pk_bf16_f32 v116, -v68, v64
    v_cvt_pk_bf16_f32 v109, v65, v69
    v_cvt_pk_bf16_f32 v117, -v69, v65
    v_cvt_pk_bf16_f32 v110, v66, v70
    v_cvt_pk_bf16_f32 v118, -v70, v66
    v_cvt_pk_bf16_f32 v111, v67, v71
    v_cvt_pk_bf16_f32 v119, -v71, v67
    v_xor_b32 v120, 0x80008000, v104
    v_xor_b32 v121, 0x80008000, v105
    v_xor_b32 v122, 0x80008000, v106
    v_xor_b32 v123, 0x80008000, v107
    v_xor_b32 v124, 0x80008000, v108
    v_xor_b32 v125, 0x80008000, v109
    v_xor_b32 v126, 0x80008000, v110
    v_xor_b32 v127, 0x80008000, v111
    v_xor_b32 v128, 0x80008000, v112
    v_xor_b32 v129, 0x80008000, v113
    v_xor_b32 v130, 0x80008000, v114
    v_xor_b32 v131, 0x80008000, v115
    v_xor_b32 v132, 0x80008000, v116
    v_xor_b32 v133, 0x80008000, v117
    v_xor_b32 v134, 0x80008000, v118
    v_xor_b32 v135, 0x80008000, v119
    s_add_u32 s32, s8, 2621440
    s_addc_u32 s33, s9, 0
    s_mov_b32 s34, 2367488
    s_mov_b32 s35, 0x20000
    v_mul_u32_u24 v5, 73984, v1
    v_lshl_add_u32 v5, v2, 4, v5
    s_waitcnt vmcnt(7)
    ds_read2st64_b32 v[8:9], v3 offset0:0 offset1:1
    ds_read2st64_b32 v[10:11], v3 offset0:2 offset1:3
    s_waitcnt vmcnt(6)
    ds_read2st64_b32 v[12:13], v3 offset0:4 offset1:5
    ds_read2st64_b32 v[14:15], v3 offset0:6 offset1:7
    s_waitcnt vmcnt(5)
    ds_read2st64_b32 v[16:17], v3 offset0:8 offset1:9
    ds_read2st64_b32 v[18:19], v3 offset0:10 offset1:11
    s_waitcnt vmcnt(4)
    ds_read2st64_b32 v[20:21], v3 offset0:12 offset1:13
    ds_read2st64_b32 v[22:23], v3 offset0:14 offset1:15
    s_waitcnt lgkmcnt(6)
    v_mfma_f32_16x16x32_bf16 v[56:59], v[88:91], v[8:11], 0
    v_mfma_f32_16x16x32_bf16 v[64:67], v[96:99], v[8:11], 0
    v_mfma_f32_16x16x32_bf16 v[72:75], v[104:107], v[8:11], 0
    v_mfma_f32_16x16x32_bf16 v[80:83], v[112:115], v[8:11], 0
    s_waitcnt lgkmcnt(4)
    v_mfma_f32_16x16x32_bf16 v[60:63], v[92:95], v[12:15], 0
    v_mfma_f32_16x16x32_bf16 v[68:71], v[100:103], v[12:15], 0
    v_mfma_f32_16x16x32_bf16 v[76:79], v[108:111], v[12:15], 0
    v_mfma_f32_16x16x32_bf16 v[84:87], v[116:119], v[12:15], 0
    s_waitcnt lgkmcnt(2)
    v_mfma_f32_16x16x32_bf16 v[56:59], v[88:91], v[16:19], v[56:59]
    v_mfma_f32_16x16x32_bf16 v[64:67], v[96:99], v[16:19], v[64:67]
    v_mfma_f32_16x16x32_bf16 v[72:75], v[120:123], v[16:19], v[72:75]
    v_mfma_f32_16x16x32_bf16 v[80:83], v[128:131], v[16:19], v[80:83]
    s_waitcnt lgkmcnt(0)
    v_mfma_f32_16x16x32_bf16 v[60:63], v[92:95], v[20:23], v[60:63]
    v_mfma_f32_16x16x32_bf16 v[68:71], v[100:103], v[20:23], v[68:71]
    v_mfma_f32_16x16x32_bf16 v[76:79], v[124:127], v[20:23], v[76:79]
    v_mfma_f32_16x16x32_bf16 v[84:87], v[132:135], v[20:23], v[84:87]
    s_waitcnt vmcnt(0)
    v_lshlrev_b32 v40, 16, v24
    v_and_b32 v24, 0xffff0000, v24
    v_lshlrev_b32 v41, 16, v25
    v_and_b32 v25, 0xffff0000, v25
    v_lshlrev_b32 v42, 16, v26
    v_and_b32 v26, 0xffff0000, v26
    v_lshlrev_b32 v43, 16, v27
    v_and_b32 v27, 0xffff0000, v27
    v_lshlrev_b32 v44, 16, v28
    v_and_b32 v28, 0xffff0000, v28
    v_lshlrev_b32 v45, 16, v29
    v_and_b32 v29, 0xffff0000, v29
    v_lshlrev_b32 v46, 16, v30
    v_and_b32 v30, 0xffff0000, v30
    v_lshlrev_b32 v47, 16, v31
    v_and_b32 v31, 0xffff0000, v31
    v_lshlrev_b32 v48, 16, v32
    v_and_b32 v32, 0xffff0000, v32
    v_lshlrev_b32 v49, 16, v33
    v_and_b32 v33, 0xffff0000, v33
    v_lshlrev_b32 v50, 16, v34
    v_and_b32 v34, 0xffff0000, v34
    v_lshlrev_b32 v51, 16, v35
    v_and_b32 v35, 0xffff0000, v35
    v_lshlrev_b32 v52, 16, v36
    v_and_b32 v36, 0xffff0000, v36
    v_lshlrev_b32 v53, 16, v37
    v_and_b32 v37, 0xffff0000, v37
    v_lshlrev_b32 v54, 16, v38
    v_and_b32 v38, 0xffff0000, v38
    v_lshlrev_b32 v55, 16, v39
    v_and_b32 v39, 0xffff0000, v39
    v_add_f32 v1, v56, v60
    v_add_f32 v2, v64, v68
    v_mul_f32 v3, v1, v40
    v_mul_f32 v4, v1, v24
    v_fma_f32 v3, -v2, v24, v3
    v_fmac_f32 v4, v2, v40
    v_cvt_pk_bf16_f32 v8, v3, -v4
    v_add_f32 v1, v57, v61
    v_add_f32 v2, v65, v69
    v_mul_f32 v3, v1, v41
    v_mul_f32 v4, v1, v25
    v_fma_f32 v3, -v2, v25, v3
    v_fmac_f32 v4, v2, v41
    v_cvt_pk_bf16_f32 v9, v3, -v4
    v_add_f32 v1, v58, v62
    v_add_f32 v2, v66, v70
    v_mul_f32 v3, v1, v42
    v_mul_f32 v4, v1, v26
    v_fma_f32 v3, -v2, v26, v3
    v_fmac_f32 v4, v2, v42
    v_cvt_pk_bf16_f32 v10, v3, -v4
    v_add_f32 v1, v59, v63
    v_add_f32 v2, v67, v71
    v_mul_f32 v3, v1, v43
    v_mul_f32 v4, v1, v27
    v_fma_f32 v3, -v2, v27, v3
    v_fmac_f32 v4, v2, v43
    v_cvt_pk_bf16_f32 v11, v3, -v4
    v_sub_f32 v1, v56, v60
    v_sub_f32 v2, v64, v68
    v_mul_f32 v3, v1, v48
    v_mul_f32 v4, v1, v32
    v_fma_f32 v3, -v2, v32, v3
    v_fmac_f32 v4, v2, v48
    v_cvt_pk_bf16_f32 v16, v3, -v4
    v_sub_f32 v1, v57, v61
    v_sub_f32 v2, v65, v69
    v_mul_f32 v3, v1, v49
    v_mul_f32 v4, v1, v33
    v_fma_f32 v3, -v2, v33, v3
    v_fmac_f32 v4, v2, v49
    v_cvt_pk_bf16_f32 v17, v3, -v4
    v_sub_f32 v1, v58, v62
    v_sub_f32 v2, v66, v70
    v_mul_f32 v3, v1, v50
    v_mul_f32 v4, v1, v34
    v_fma_f32 v3, -v2, v34, v3
    v_fmac_f32 v4, v2, v50
    v_cvt_pk_bf16_f32 v18, v3, -v4
    v_sub_f32 v1, v59, v63
    v_sub_f32 v2, v67, v71
    v_mul_f32 v3, v1, v51
    v_mul_f32 v4, v1, v35
    v_fma_f32 v3, -v2, v35, v3
    v_fmac_f32 v4, v2, v51
    v_cvt_pk_bf16_f32 v19, v3, -v4
    v_add_f32 v1, v72, v76
    v_add_f32 v2, v80, v84
    v_mul_f32 v3, v1, v44
    v_mul_f32 v4, v1, v28
    v_fma_f32 v3, -v2, v28, v3
    v_fmac_f32 v4, v2, v44
    v_cvt_pk_bf16_f32 v12, v3, -v4
    v_add_f32 v1, v73, v77
    v_add_f32 v2, v81, v85
    v_mul_f32 v3, v1, v45
    v_mul_f32 v4, v1, v29
    v_fma_f32 v3, -v2, v29, v3
    v_fmac_f32 v4, v2, v45
    v_cvt_pk_bf16_f32 v13, v3, -v4
    v_add_f32 v1, v74, v78
    v_add_f32 v2, v82, v86
    v_mul_f32 v3, v1, v46
    v_mul_f32 v4, v1, v30
    v_fma_f32 v3, -v2, v30, v3
    v_fmac_f32 v4, v2, v46
    v_cvt_pk_bf16_f32 v14, v3, -v4
    v_add_f32 v1, v75, v79
    v_add_f32 v2, v83, v87
    v_mul_f32 v3, v1, v47
    v_mul_f32 v4, v1, v31
    v_fma_f32 v3, -v2, v31, v3
    v_fmac_f32 v4, v2, v47
    v_cvt_pk_bf16_f32 v15, v3, -v4
    v_sub_f32 v1, v72, v76
    v_sub_f32 v2, v80, v84
    v_mul_f32 v3, v1, v52
    v_mul_f32 v4, v1, v36
    v_fma_f32 v3, -v2, v36, v3
    v_fmac_f32 v4, v2, v52
    v_cvt_pk_bf16_f32 v20, v3, -v4
    v_sub_f32 v1, v73, v77
    v_sub_f32 v2, v81, v85
    v_mul_f32 v3, v1, v53
    v_mul_f32 v4, v1, v37
    v_fma_f32 v3, -v2, v37, v3
    v_fmac_f32 v4, v2, v53
    v_cvt_pk_bf16_f32 v21, v3, -v4
    v_sub_f32 v1, v74, v78
    v_sub_f32 v2, v82, v86
    v_mul_f32 v3, v1, v54
    v_mul_f32 v4, v1, v38
    v_fma_f32 v3, -v2, v38, v3
    v_fmac_f32 v4, v2, v54
    v_cvt_pk_bf16_f32 v22, v3, -v4
    v_sub_f32 v1, v75, v79
    v_sub_f32 v2, v83, v87
    v_mul_f32 v3, v1, v55
    v_mul_f32 v4, v1, v39
    v_fma_f32 v3, -v2, v39, v3
    v_fmac_f32 v4, v2, v55
    v_cvt_pk_bf16_f32 v23, v3, -v4
    v_mfma_f32_16x16x32_bf16 v[56:59], v[8:11], v[88:91], 0
    v_mfma_f32_16x16x32_bf16 v[64:67], v[8:11], v[96:99], 0
    v_mfma_f32_16x16x32_bf16 v[72:75], v[8:11], v[104:107], 0
    v_mfma_f32_16x16x32_bf16 v[80:83], v[8:11], v[112:115], 0
    v_mfma_f32_16x16x32_bf16 v[60:63], v[12:15], v[92:95], 0
    v_mfma_f32_16x16x32_bf16 v[68:71], v[12:15], v[100:103], 0
    v_mfma_f32_16x16x32_bf16 v[76:79], v[12:15], v[108:111], 0
    v_mfma_f32_16x16x32_bf16 v[84:87], v[12:15], v[116:119], 0
    v_mfma_f32_16x16x32_bf16 v[56:59], v[16:19], v[88:91], v[56:59]
    v_mfma_f32_16x16x32_bf16 v[64:67], v[16:19], v[96:99], v[64:67]
    v_mfma_f32_16x16x32_bf16 v[72:75], v[16:19], v[120:123], v[72:75]
    v_mfma_f32_16x16x32_bf16 v[80:83], v[16:19], v[128:131], v[80:83]
    v_mfma_f32_16x16x32_bf16 v[60:63], v[20:23], v[92:95], v[60:63]
    v_mfma_f32_16x16x32_bf16 v[68:71], v[20:23], v[100:103], v[68:71]
    v_mfma_f32_16x16x32_bf16 v[76:79], v[20:23], v[124:127], v[76:79]
    v_mfma_f32_16x16x32_bf16 v[84:87], v[20:23], v[132:135], v[84:87]
    s_nop 4
    v_add_f32 v1, v56, v60
    v_add_f32 v2, v64, v68
    v_cvt_pk_bf16_f32 v40, v1, v2
    v_add_f32 v1, v57, v61
    v_add_f32 v2, v65, v69
    v_cvt_pk_bf16_f32 v41, v1, v2
    v_add_f32 v1, v58, v62
    v_add_f32 v2, v66, v70
    v_cvt_pk_bf16_f32 v42, v1, v2
    v_add_f32 v1, v59, v63
    v_add_f32 v2, v67, v71
    v_cvt_pk_bf16_f32 v43, v1, v2
    s_add_u32 s17, s16, 0
    buffer_store_dwordx4 v[40:43], v5, s[32:35], s17 offen
    v_sub_f32 v1, v56, v60
    v_sub_f32 v2, v64, v68
    v_cvt_pk_bf16_f32 v44, v1, v2
    v_sub_f32 v1, v57, v61
    v_sub_f32 v2, v65, v69
    v_cvt_pk_bf16_f32 v45, v1, v2
    v_sub_f32 v1, v58, v62
    v_sub_f32 v2, v66, v70
    v_cvt_pk_bf16_f32 v46, v1, v2
    v_sub_f32 v1, v59, v63
    v_sub_f32 v2, v67, v71
    v_cvt_pk_bf16_f32 v47, v1, v2
    s_add_u32 s17, s16, 1183744
    buffer_store_dwordx4 v[44:47], v5, s[32:35], s17 offen
    v_add_f32 v1, v72, v76
    v_add_f32 v2, v80, v84
    v_cvt_pk_bf16_f32 v48, v1, v2
    v_add_f32 v1, v73, v77
    v_add_f32 v2, v81, v85
    v_cvt_pk_bf16_f32 v49, v1, v2
    v_add_f32 v1, v74, v78
    v_add_f32 v2, v82, v86
    v_cvt_pk_bf16_f32 v50, v1, v2
    v_add_f32 v1, v75, v79
    v_add_f32 v2, v83, v87
    v_cvt_pk_bf16_f32 v51, v1, v2
    s_add_u32 s17, s16, 36992
    buffer_store_dwordx4 v[48:51], v5, s[32:35], s17 offen
    v_sub_f32 v1, v72, v76
    v_sub_f32 v2, v80, v84
    v_cvt_pk_bf16_f32 v52, v1, v2
    v_sub_f32 v1, v73, v77
    v_sub_f32 v2, v81, v85
    v_cvt_pk_bf16_f32 v53, v1, v2
    v_sub_f32 v1, v74, v78
    v_sub_f32 v2, v82, v86
    v_cvt_pk_bf16_f32 v54, v1, v2
    v_sub_f32 v1, v75, v79
    v_sub_f32 v2, v83, v87
    v_cvt_pk_bf16_f32 v55, v1, v2
    s_add_u32 s17, s16, 1220736
    buffer_store_dwordx4 v[52:55], v5, s[32:35], s17 offen
    s_endpgm
K2_end:
    s_endpgm
.globl k3_kernel
.p2align 8
.type k3_kernel,@function
k3_kernel:
    s_cmp_ge_u32 s2, 128
    s_cbranch_scc1 K3_touch
    s_load_dwordx2 s[4:5], s[0:1], 0
    s_load_dwordx2 s[8:9], s[0:1], 88
    v_lshrrev_b32 v6, 6, v0
    s_and_b32 s16, s2, 7
    s_lshr_b32 s17, s2, 4
    v_readfirstlane_b32 s15, v6
    s_lshl_b32 s16, s16, 3
    s_add_u32 s16, s16, s17
    s_bfe_u32 s17, s2, 0x10003
    v_and_b32 v3, 63, v0
    v_and_b32 v1, 15, v0
    v_lshrrev_b32 v2, 4, v3
    v_lshlrev_b32 v4, 4, v3
    s_lshl_b32 s19, s15, 10
    s_mul_i32 s37, s16, 36992
    s_lshl_b32 s38, s15, 11
    s_add_u32 s38, s38, s37
    s_add_u32 s36, s38, 18432
    v_mul_u32_u24 v5, 73728, v1
    v_lshl_add_u32 v5, v2, 3, v5
    s_lshl_b32 s39, s17, 10
    s_add_u32 s18, s39, s16
    s_mul_i32 s39, s18, 1152
    s_lshl_b32 s40, s15, 5
    s_add_u32 s39, s39, s40
    s_lshl_b32 s41, s15, 6
    v_lshlrev_b32 v7, 2, v2
    s_add_u32 s37, s37, 36864
    s_waitcnt lgkmcnt(0)
    s_add_u32 s32, s8, 2621440
    s_addc_u32 s33, s9, 0
    s_mov_b32 s34, 2367488
    s_mov_b32 s35, 0x20000
    s_add_u32 m0, s19, 0
    s_nop 0
    buffer_load_dwordx4 v4, s[32:35], s38 offen offset:0 lds
    s_add_u32 m0, s19, 17408
    s_nop 0
    buffer_load_dwordx4 v4, s[32:35], s38 offen offset:1024 lds
    s_add_u32 m0, s19, 9216
    s_nop 0
    buffer_load_dwordx4 v4, s[32:35], s36 offen offset:0 lds
    s_add_u32 m0, s19, 26624
    s_nop 0
    buffer_load_dwordx4 v4, s[32:35], s36 offen offset:1024 lds
    s_cmp_lg_u32 s15, 0
    s_cbranch_scc1 K3_nony
    buffer_load_dword v24, v7, s[32:35], s37 offen offset:0
    buffer_load_dword v25, v7, s[32:35], s37 offen offset:16
    buffer_load_dword v26, v7, s[32:35], s37 offen offset:32
    buffer_load_dword v27, v7, s[32:35], s37 offen offset:48
    buffer_load_dword v28, v7, s[32:35], s37 offen offset:64
    buffer_load_dword v29, v7, s[32:35], s37 offen offset:80
    buffer_load_dword v30, v7, s[32:35], s37 offen offset:96
    buffer_load_dword v31, v7, s[32:35], s37 offen offset:112
K3_nony:
    s_mov_b32 s20, s4
    s_mov_b32 s21, s5
    s_mov_b32 s22, 2359296
    s_mov_b32 s23, 0x20000
    s_add_u32 s24, s8, 2304
    s_addc_u32 s25, s9, 0
    s_mov_b32 s26, 4608
    s_mov_b32 s27, 0x20000
    s_add_u32 s44, s8, 5242880
    s_addc_u32 s45, s9, 0
    s_mov_b32 s46, 2359296
    s_mov_b32 s47, 0x20000
    s_add_u32 s48, s8, 50331648
    s_addc_u32 s49, s9, 0
    s_mov_b32 s50, 2359296
    s_mov_b32 s51, 0x20000
    s_lshl_b32 s42, s15, 4
    v_add_u32 v160, s42, v1
    v_cvt_f32_u32 v160, v160
    v_lshlrev_b32 v161, 3, v2
    v_cvt_f32_u32 v161, v161
    s_mov_b32 s58, 0x44100000
    v_mul_f32 v40, v160, v161
    v_fmamk_f32 v41, v160, 0x3f800000, v40
    v_fmamk_f32 v42, v160, 0x42000000, v40
    v_fmamk_f32 v43, v160, 0x42040000, v40
    v_mul_f32 v44, 0x42000000, v160
    v_mul_f32 v130, 0x3ae38e39, v40
    v_mul_f32 v131, 0x3ae38e39, v41
    v_mul_f32 v132, 0x3ae38e39, v42
    v_mul_f32 v133, 0x3ae38e39, v43
    v_mul_f32 v134, 0x3ae38e39, v44
    v_floor_f32 v130, v130
    v_floor_f32 v131, v131
    v_floor_f32 v132, v132
    v_floor_f32 v133, v133
    v_floor_f32 v134, v134
    v_fma_f32 v40, -v130, s58, v40
    v_fma_f32 v41, -v131, s58, v41
    v_fma_f32 v42, -v132, s58, v42
    v_fma_f32 v43, -v133, s58, v43
    v_fma_f32 v44, -v134, s58, v44
    v_mul_f32 v40, 0x3ae38e39, v40
    v_mul_f32 v41, 0x3ae38e39, v41
    v_mul_f32 v42, 0x3ae38e39, v42
    v_mul_f32 v43, 0x3ae38e39, v43
    v_mul_f32 v44, 0x3ae38e39, v44
    v_mul_f32 v45, 0x3ae38e39, v160
    v_cos_f32 v46, v45
    v_cos_f32 v47, v44
    v_cos_f32 v128, v40
    v_sin_f32_e64 v136, v40
    v_cos_f32 v129, v41
    v_sin_f32_e64 v137, v41
    v_cos_f32 v144, v42
    v_sin_f32_e64 v152, v42
    v_cos_f32 v145, v43
    v_sin_f32_e64 v153, v43
    v_add_f32 v46, v46, v46
    v_add_f32 v47, v47, v47
    v_fma_f32 v130, v46, v129, -v128
    v_fma_f32 v138, v46, v137, -v136
    v_fma_f32 v146, v46, v145, -v144
    v_fma_f32 v154, v46, v153, -v152
    v_fma_f32 v131, v46, v130, -v129
    v_fma_f32 v139, v46, v138, -v137
    v_fma_f32 v147, v46, v146, -v145
    v_fma_f32 v155, v46, v154, -v153
    v_fma_f32 v132, v46, v131, -v130
    v_fma_f32 v140, v46, v139, -v138
    v_fma_f32 v148, v46, v147, -v146
    v_fma_f32 v156, v46, v155, -v154
    v_fma_f32 v133, v46, v132, -v131
    v_fma_f32 v141, v46, v140, -v139
    v_fma_f32 v149, v46, v148, -v147
    v_fma_f32 v157, v46, v156, -v155
    v_fma_f32 v134, v46, v133, -v132
    v_fma_f32 v142, v46, v141, -v140
    v_fma_f32 v150, v46, v149, -v148
    v_fma_f32 v158, v46, v157, -v156
    v_fma_f32 v135, v46, v134, -v133
    v_fma_f32 v143, v46, v142, -v141
    v_fma_f32 v151, v46, v150, -v149
    v_fma_f32 v159, v46, v158, -v157
    v_cvt_pk_bf16_f32 v56, v128, v136
    v_cvt_pk_bf16_f32 v92, v129, v137
    v_cvt_pk_bf16_f32 v57, v130, v138
    v_cvt_pk_bf16_f32 v93, v131, v139
    v_cvt_pk_bf16_f32 v58, v132, v140
    v_cvt_pk_bf16_f32 v94, v133, v141
    v_cvt_pk_bf16_f32 v59, v134, v142
    v_cvt_pk_bf16_f32 v95, v135, v143
    v_cvt_pk_bf16_f32 v60, v144, v152
    v_cvt_pk_bf16_f32 v96, v145, v153
    v_cvt_pk_bf16_f32 v61, v146, v154
    v_cvt_pk_bf16_f32 v97, v147, v155
    v_cvt_pk_bf16_f32 v62, v148, v156
    v_cvt_pk_bf16_f32 v98, v149, v157
    v_cvt_pk_bf16_f32 v63, v150, v158
    v_cvt_pk_bf16_f32 v99, v151, v159
    v_fma_f32 v128, v47, v144, -v128
    v_fma_f32 v129, v47, v145, -v129
    v_fma_f32 v130, v47, v146, -v130
    v_fma_f32 v131, v47, v147, -v131
    v_fma_f32 v132, v47, v148, -v132
    v_fma_f32 v133, v47, v149, -v133
    v_fma_f32 v134, v47, v150, -v134
    v_fma_f32 v135, v47, v151, -v135
    v_fma_f32 v136, v47, v152, -v136
    v_fma_f32 v137, v47, v153, -v137
    v_fma_f32 v138, v47, v154, -v138
    v_fma_f32 v139, v47, v155, -v139
    v_fma_f32 v140, v47, v156, -v140
    v_fma_f32 v141, v47, v157, -v141
    v_fma_f32 v142, v47, v158, -v142
    v_fma_f32 v143, v47, v159, -v143
    v_cvt_pk_bf16_f32 v64, v128, v136
    v_cvt_pk_bf16_f32 v100, v129, v137
    v_cvt_pk_bf16_f32 v65, v130, v138
    v_cvt_pk_bf16_f32 v101, v131, v139
    v_cvt_pk_bf16_f32 v66, v132, v140
    v_cvt_pk_bf16_f32 v102, v133, v141
    v_cvt_pk_bf16_f32 v67, v134, v142
    v_cvt_pk_bf16_f32 v103, v135, v143
    v_fma_f32 v144, v47, v128, -v144
    v_fma_f32 v145, v47, v129, -v145
    v_fma_f32 v146, v47, v130, -v146
    v_fma_f32 v147, v47, v131, -v147
    v_fma_f32 v148, v47, v132, -v148
    v_fma_f32 v149, v47, v133, -v149
    v_fma_f32 v150, v47, v134, -v150
    v_fma_f32 v151, v47, v135, -v151
    v_fma_f32 v152, v47, v136, -v152
    v_fma_f32 v153, v47, v137, -v153
    v_fma_f32 v154, v47, v138, -v154
    v_fma_f32 v155, v47, v139, -v155
    v_fma_f32 v156, v47, v140, -v156
    v_fma_f32 v157, v47, v141, -v157
    v_fma_f32 v158, v47, v142, -v158
    v_fma_f32 v159, v47, v143, -v159
    v_cvt_pk_bf16_f32 v68, v144, v152
    v_cvt_pk_bf16_f32 v104, v145, v153
    v_cvt_pk_bf16_f32 v69, v146, v154
    v_cvt_pk_bf16_f32 v105, v147, v155
    v_cvt_pk_bf16_f32 v70, v148, v156
    v_cvt_pk_bf16_f32 v106, v149, v157
    v_cvt_pk_bf16_f32 v71, v150, v158
    v_cvt_pk_bf16_f32 v107, v151, v159
    v_fma_f32 v128, v47, v144, -v128
    v_fma_f32 v129, v47, v145, -v129
    v_fma_f32 v130, v47, v146, -v130
    v_fma_f32 v131, v47, v147, -v131
    v_fma_f32 v132, v47, v148, -v132
    v_fma_f32 v133, v47, v149, -v133
    v_fma_f32 v134, v47, v150, -v134
    v_fma_f32 v135, v47, v151, -v135
    v_fma_f32 v136, v47, v152, -v136
    v_fma_f32 v137, v47, v153, -v137
    v_fma_f32 v138, v47, v154, -v138
    v_fma_f32 v139, v47, v155, -v139
    v_fma_f32 v140, v47, v156, -v140
    v_fma_f32 v141, v47, v157, -v141
    v_fma_f32 v142, v47, v158, -v142
    v_fma_f32 v143, v47, v159, -v143
    v_cvt_pk_bf16_f32 v72, v128, v136
    v_cvt_pk_bf16_f32 v108, v129, v137
    v_cvt_pk_bf16_f32 v73, v130, v138
    v_cvt_pk_bf16_f32 v109, v131, v139
    v_cvt_pk_bf16_f32 v74, v132, v140
    v_cvt_pk_bf16_f32 v110, v133, v141
    v_cvt_pk_bf16_f32 v75, v134, v142
    v_cvt_pk_bf16_f32 v111, v135, v143
    v_fma_f32 v144, v47, v128, -v144
    v_fma_f32 v145, v47, v129, -v145
    v_fma_f32 v146, v47, v130, -v146
    v_fma_f32 v147, v47, v131, -v147
    v_fma_f32 v148, v47, v132, -v148
    v_fma_f32 v149, v47, v133, -v149
    v_fma_f32 v150, v47, v134, -v150
    v_fma_f32 v151, v47, v135, -v151
    v_fma_f32 v152, v47, v136, -v152
    v_fma_f32 v153, v47, v137, -v153
    v_fma_f32 v154, v47, v138, -v154
    v_fma_f32 v155, v47, v139, -v155
    v_fma_f32 v156, v47, v140, -v156
    v_fma_f32 v157, v47, v141, -v157
    v_fma_f32 v158, v47, v142, -v158
    v_fma_f32 v159, v47, v143, -v159
    v_cvt_pk_bf16_f32 v76, v144, v152
    v_cvt_pk_bf16_f32 v112, v145, v153
    v_cvt_pk_bf16_f32 v77, v146, v154
    v_cvt_pk_bf16_f32 v113, v147, v155
    v_cvt_pk_bf16_f32 v78, v148, v156
    v_cvt_pk_bf16_f32 v114, v149, v157
    v_cvt_pk_bf16_f32 v79, v150, v158
    v_cvt_pk_bf16_f32 v115, v151, v159
    v_fma_f32 v128, v47, v144, -v128
    v_fma_f32 v129, v47, v145, -v129
    v_fma_f32 v130, v47, v146, -v130
    v_fma_f32 v131, v47, v147, -v131
    v_fma_f32 v132, v47, v148, -v132
    v_fma_f32 v133, v47, v149, -v133
    v_fma_f32 v134, v47, v150, -v134
    v_fma_f32 v135, v47, v151, -v135
    v_fma_f32 v136, v47, v152, -v136
    v_fma_f32 v137, v47, v153, -v137
    v_fma_f32 v138, v47, v154, -v138
    v_fma_f32 v139, v47, v155, -v139
    v_fma_f32 v140, v47, v156, -v140
    v_fma_f32 v141, v47, v157, -v141
    v_fma_f32 v142, v47, v158, -v142
    v_fma_f32 v143, v47, v159, -v143
    v_cvt_pk_bf16_f32 v80, v128, v136
    v_cvt_pk_bf16_f32 v116, v129, v137
    v_cvt_pk_bf16_f32 v81, v130, v138
    v_cvt_pk_bf16_f32 v117, v131, v139
    v_cvt_pk_bf16_f32 v82, v132, v140
    v_cvt_pk_bf16_f32 v118, v133, v141
    v_cvt_pk_bf16_f32 v83, v134, v142
    v_cvt_pk_bf16_f32 v119, v135, v143
    v_fma_f32 v144, v47, v128, -v144
    v_fma_f32 v145, v47, v129, -v145
    v_fma_f32 v146, v47, v130, -v146
    v_fma_f32 v147, v47, v131, -v147
    v_fma_f32 v148, v47, v132, -v148
    v_fma_f32 v149, v47, v133, -v149
    v_fma_f32 v150, v47, v134, -v150
    v_fma_f32 v151, v47, v135, -v151
    v_fma_f32 v152, v47, v136, -v152
    v_fma_f32 v153, v47, v137, -v153
    v_fma_f32 v154, v47, v138, -v154
    v_fma_f32 v155, v47, v139, -v155
    v_fma_f32 v156, v47, v140, -v156
    v_fma_f32 v157, v47, v141, -v157
    v_fma_f32 v158, v47, v142, -v158
    v_fma_f32 v159, v47, v143, -v159
    v_cvt_pk_bf16_f32 v84, v144, v152
    v_cvt_pk_bf16_f32 v120, v145, v153
    v_cvt_pk_bf16_f32 v85, v146, v154
    v_cvt_pk_bf16_f32 v121, v147, v155
    v_cvt_pk_bf16_f32 v86, v148, v156
    v_cvt_pk_bf16_f32 v122, v149, v157
    v_cvt_pk_bf16_f32 v87, v150, v158
    v_cvt_pk_bf16_f32 v123, v151, v159
    v_fma_f32 v128, v47, v144, -v128
    v_fma_f32 v129, v47, v145, -v129
    v_fma_f32 v130, v47, v146, -v130
    v_fma_f32 v131, v47, v147, -v131
    v_fma_f32 v132, v47, v148, -v132
    v_fma_f32 v133, v47, v149, -v133
    v_fma_f32 v134, v47, v150, -v134
    v_fma_f32 v135, v47, v151, -v135
    v_fma_f32 v136, v47, v152, -v136
    v_fma_f32 v137, v47, v153, -v137
    v_fma_f32 v138, v47, v154, -v138
    v_fma_f32 v139, v47, v155, -v139
    v_fma_f32 v140, v47, v156, -v140
    v_fma_f32 v141, v47, v157, -v141
    v_fma_f32 v142, v47, v158, -v142
    v_fma_f32 v143, v47, v159, -v143
    v_cvt_pk_bf16_f32 v88, v128, v136
    v_cvt_pk_bf16_f32 v124, v129, v137
    v_cvt_pk_bf16_f32 v89, v130, v138
    v_cvt_pk_bf16_f32 v125, v131, v139
    v_cvt_pk_bf16_f32 v90, v132, v140
    v_cvt_pk_bf16_f32 v126, v133, v141
    v_cvt_pk_bf16_f32 v91, v134, v142
    v_cvt_pk_bf16_f32 v127, v135, v143
    v_lshl_add_u32 v160, v1, 6, s18
    v_cvt_f32_u32 v160, v160
    v_mul_f32 v160, 0x3a000000, v160
    v_cvt_f32_u32 v161, v2
    v_mul_f32 v161, v161, v160
    v_fmamk_f32 v128, v160, 0x00000000, v161
    v_fmamk_f32 v129, v160, 0x40800000, v161
    v_fmamk_f32 v130, v160, 0x41000000, v161
    v_fmamk_f32 v131, v160, 0x41400000, v161
    v_fmamk_f32 v132, v160, 0x41800000, v161
    v_fmamk_f32 v133, v160, 0x41a00000, v161
    v_fmamk_f32 v134, v160, 0x41c00000, v161
    v_fmamk_f32 v135, v160, 0x41e00000, v161
    v_cos_f32 v136, v128
    v_sin_f32 v144, v128
    v_cos_f32 v137, v129
    v_sin_f32 v145, v129
    v_cos_f32 v138, v130
    v_sin_f32 v146, v130
    v_cos_f32 v139, v131
    v_sin_f32 v147, v131
    v_cos_f32 v140, v132
    v_sin_f32 v148, v132
    v_cos_f32 v141, v133
    v_sin_f32 v149, v133
    v_cos_f32 v142, v134
    v_sin_f32 v150, v134
    v_cos_f32 v143, v135
    v_sin_f32 v151, v135
    v_cvt_pk_bf16_f32 v40, v136, v144
    v_cvt_pk_bf16_f32 v48, -v144, v136
    v_cvt_pk_bf16_f32 v41, v137, v145
    v_cvt_pk_bf16_f32 v49, -v145, v137
    v_cvt_pk_bf16_f32 v42, v138, v146
    v_cvt_pk_bf16_f32 v50, -v146, v138
    v_cvt_pk_bf16_f32 v43, v139, v147
    v_cvt_pk_bf16_f32 v51, -v147, v139
    v_cvt_pk_bf16_f32 v44, v140, v148
    v_cvt_pk_bf16_f32 v52, -v148, v140
    v_cvt_pk_bf16_f32 v45, v141, v149
    v_cvt_pk_bf16_f32 v53, -v149, v141
    v_cvt_pk_bf16_f32 v46, v142, v150
    v_cvt_pk_bf16_f32 v54, -v150, v142
    v_cvt_pk_bf16_f32 v47, v143, v151
    v_cvt_pk_bf16_f32 v55, -v151, v143
    v_lshlrev_b32 v6, 31, v1
    v_xor_b32 v6, 0x3f803f80, v6
    v_cmp_gt_u32 vcc, 16, v3
    s_nop 1
    v_cndmask_b32 v56, v56, v6, vcc
    v_add_u32 v6, s15, v1
    v_cmp_eq_u32 vcc, 0, v6
    v_and_b32 v7, 48, v3
    v_bfe_u32 v6, v3, 2, 2
    v_or_b32 v7, v7, v6
    v_and_b32 v6, 3, v3
    v_lshl_or_b32 v7, v6, 2, v7
    v_lshlrev_b32 v7, 4, v7
    v_lshrrev_b32 v7, 2, v7
    v_add_u32 v7, s19, v7
    v_add_u32 v6, s19, v4
    s_waitcnt vmcnt(0)
    ds_read2st64_b32 v[16:17], v7 offset0:36 offset1:37
    ds_read2st64_b32 v[18:19], v7 offset0:38 offset1:39
    ds_read2st64_b32 v[20:21], v7 offset0:108 offset1:109
    ds_read2st64_b32 v[22:23], v7 offset0:110 offset1:111
    ds_read2st64_b32 v[8:9], v7 offset0:0 offset1:1
    ds_read2st64_b32 v[10:11], v7 offset0:2 offset1:3
    ds_read2st64_b32 v[12:13], v7 offset0:72 offset1:73
    ds_read2st64_b32 v[14:15], v7 offset0:74 offset1:75
    s_waitcnt lgkmcnt(0)
    v_cndmask_b32 v24, v8, v24, vcc
    v_cndmask_b32 v25, v9, v25, vcc
    v_cndmask_b32 v26, v10, v26, vcc
    v_cndmask_b32 v27, v11, v27, vcc
    v_cndmask_b32 v28, v12, v28, vcc
    v_cndmask_b32 v29, v13, v29, vcc
    v_cndmask_b32 v30, v14, v30, vcc
    v_cndmask_b32 v31, v15, v31, vcc
    v_mfma_f32_16x16x32_bf16 v[136:139], v[16:19], v[40:43], 0
    v_mfma_f32_16x16x32_bf16 v[140:143], v[16:19], v[48:51], 0
    v_mfma_f32_16x16x32_bf16 v[128:131], v[8:11], v[40:43], 0
    v_mfma_f32_16x16x32_bf16 v[132:135], v[24:27], v[48:51], 0
    v_mfma_f32_16x16x32_bf16 v[136:139], v[20:23], v[44:47], v[136:139]
    v_mfma_f32_16x16x32_bf16 v[140:143], v[20:23], v[52:55], v[140:143]
    v_mfma_f32_16x16x32_bf16 v[128:131], v[12:15], v[44:47], v[128:131]
    v_mfma_f32_16x16x32_bf16 v[132:135], v[28:31], v[52:55], v[132:135]
    v_lshlrev_b32 v7, 4, v2
    buffer_load_dwordx2 v[32:33], v5, s[20:23], s39 offen offset:0
    buffer_load_dwordx2 v[34:35], v5, s[20:23], s39 offen offset:576
    buffer_load_dwordx2 v[36:37], v5, s[20:23], s39 offen offset:288
    buffer_load_dwordx2 v[38:39], v5, s[20:23], s39 offen offset:864
    buffer_load_dwordx4 v[8:11], v7, s[24:27], s41 offen offset:2304
    buffer_load_dwordx4 v[12:15], v7, s[24:27], s41 offen offset:3456
    buffer_load_dwordx4 v[16:19], v7, s[24:27], s41 offen offset:2880
    buffer_load_dwordx4 v[20:23], v7, s[24:27], s41 offen offset:4032
    v_cvt_pk_bf16_f32 v152, v136, v140
    v_cvt_pk_bf16_f32 v153, v137, v141
    v_cvt_pk_bf16_f32 v154, v138, v142
    v_cvt_pk_bf16_f32 v155, v139, v143
    ds_write_b128 v6, v[152:155] offset:9216
    v_cvt_pk_bf16_f32 v156, v140, -v136
    v_cvt_pk_bf16_f32 v157, -v141, v137
    v_cvt_pk_bf16_f32 v158, v142, -v138
    v_cvt_pk_bf16_f32 v159, -v143, v139
    ds_write_b128 v6, v[156:159] offset:27648
    v_cvt_pk_bf16_f32 v144, v128, v132
    v_cvt_pk_bf16_f32 v145, v129, v133
    v_cvt_pk_bf16_f32 v146, v130, v134
    v_cvt_pk_bf16_f32 v147, v131, v135
    ds_write_b128 v6, v[144:147] offset:0
    v_mov_b32 v148, v144
    v_xor_b32 v149, 0x80008000, v145
    v_mov_b32 v150, v146
    v_xor_b32 v151, 0x80008000, v147
    ds_write_b128 v6, v[148:151] offset:18432
    s_waitcnt lgkmcnt(0)
    s_barrier
    ds_read_b128 v[128:131], v4 offset:0
    ds_read_b128 v[132:135], v4 offset:18432
    ds_read_b128 v[136:139], v4 offset:9216
    ds_read_b128 v[140:143], v4 offset:27648
    ds_read_b128 v[144:147], v4 offset:1024
    ds_read_b128 v[148:151], v4 offset:19456
    ds_read_b128 v[152:155], v4 offset:10240
    ds_read_b128 v[156:159], v4 offset:28672
    s_waitcnt lgkmcnt(7)
    v_mfma_f32_16x16x32_bf16 v[40:43], v[56:59], v[128:131], 0
    ds_read_b128 v[128:131], v4 offset:2048
    s_waitcnt lgkmcnt(7)
    v_mfma_f32_16x16x32_bf16 v[48:51], v[56:59], v[132:135], 0
    ds_read_b128 v[132:135], v4 offset:20480
    s_waitcnt lgkmcnt(7)
    v_mfma_f32_16x16x32_bf16 v[44:47], v[92:95], v[136:139], 0
    ds_read_b128 v[136:139], v4 offset:11264
    s_waitcnt lgkmcnt(7)
    v_mfma_f32_16x16x32_bf16 v[52:55], v[92:95], v[140:143], 0
    ds_read_b128 v[140:143], v4 offset:29696
    s_waitcnt lgkmcnt(7)
    v_mfma_f32_16x16x32_bf16 v[40:43], v[60:63], v[144:147], v[40:43]
    ds_read_b128 v[144:147], v4 offset:3072
    s_waitcnt lgkmcnt(7)
    v_mfma_f32_16x16x32_bf16 v[48:51], v[60:63], v[148:151], v[48:51]
    ds_read_b128 v[148:151], v4 offset:21504
    s_waitcnt lgkmcnt(7)
    v_mfma_f32_16x16x32_bf16 v[44:47], v[96:99], v[152:155], v[44:47]
    ds_read_b128 v[152:155], v4 offset:12288
    s_waitcnt lgkmcnt(7)
    v_mfma_f32_16x16x32_bf16 v[52:55], v[96:99], v[156:159], v[52:55]
    ds_read_b128 v[156:159], v4 offset:30720
    s_waitcnt lgkmcnt(7)
    v_mfma_f32_16x16x32_bf16 v[40:43], v[64:67], v[128:131], v[40:43]
    ds_read_b128 v[128:131], v4 offset:4096
    s_waitcnt lgkmcnt(7)
    v_mfma_f32_16x16x32_bf16 v[48:51], v[64:67], v[132:135], v[48:51]
    ds_read_b128 v[132:135], v4 offset:22528
    s_waitcnt lgkmcnt(7)
    v_mfma_f32_16x16x32_bf16 v[44:47], v[100:103], v[136:139], v[44:47]
    ds_read_b128 v[136:139], v4 offset:13312
    s_waitcnt lgkmcnt(7)
    v_mfma_f32_16x16x32_bf16 v[52:55], v[100:103], v[140:143], v[52:55]
    ds_read_b128 v[140:143], v4 offset:31744
    s_waitcnt lgkmcnt(7)
    v_mfma_f32_16x16x32_bf16 v[40:43], v[68:71], v[144:147], v[40:43]
    ds_read_b128 v[144:147], v4 offset:5120
    s_waitcnt lgkmcnt(7)
    v_mfma_f32_16x16x32_bf16 v[48:51], v[68:71], v[148:151], v[48:51]
    ds_read_b128 v[148:151], v4 offset:23552
    s_waitcnt lgkmcnt(7)
    v_mfma_f32_16x16x32_bf16 v[44:47], v[104:107], v[152:155], v[44:47]
    ds_read_b128 v[152:155], v4 offset:14336
    s_waitcnt lgkmcnt(7)
    v_mfma_f32_16x16x32_bf16 v[52:55], v[104:107], v[156:159], v[52:55]
    ds_read_b128 v[156:159], v4 offset:32768
    s_waitcnt lgkmcnt(7)
    v_mfma_f32_16x16x32_bf16 v[40:43], v[72:75], v[128:131], v[40:43]
    ds_read_b128 v[128:131], v4 offset:6144
    s_waitcnt lgkmcnt(7)
    v_mfma_f32_16x16x32_bf16 v[48:51], v[72:75], v[132:135], v[48:51]
    ds_read_b128 v[132:135], v4 offset:24576
    buffer_load_dwordx4 v[56:59], v7, s[24:27], s41 offen offset:0
    buffer_load_dwordx4 v[60:63], v7, s[24:27], s41 offen offset:1152
    buffer_load_dwordx4 v[64:67], v7, s[24:27], s41 offen offset:576
    buffer_load_dwordx4 v[68:71], v7, s[24:27], s41 offen offset:1728
    s_waitcnt lgkmcnt(7)
    v_mfma_f32_16x16x32_bf16 v[44:47], v[108:111], v[136:139], v[44:47]
    ds_read_b128 v[136:139], v4 offset:15360
    s_waitcnt lgkmcnt(7)
    v_mfma_f32_16x16x32_bf16 v[52:55], v[108:111], v[140:143], v[52:55]
    ds_read_b128 v[140:143], v4 offset:33792
    s_waitcnt lgkmcnt(7)
    v_mfma_f32_16x16x32_bf16 v[40:43], v[76:79], v[144:147], v[40:43]
    ds_read_b128 v[144:147], v4 offset:7168
    s_waitcnt lgkmcnt(7)
    v_mfma_f32_16x16x32_bf16 v[48:51], v[76:79], v[148:151], v[48:51]
    ds_read_b128 v[148:151], v4 offset:25600
    s_waitcnt lgkmcnt(7)
    v_mfma_f32_16x16x32_bf16 v[44:47], v[112:115], v[152:155], v[44:47]
    ds_read_b128 v[152:155], v4 offset:16384
    s_waitcnt lgkmcnt(7)
    v_mfma_f32_16x16x32_bf16 v[52:55], v[112:115], v[156:159], v[52:55]
    ds_read_b128 v[156:159], v4 offset:34816
    s_waitcnt lgkmcnt(7)
    v_mfma_f32_16x16x32_bf16 v[40:43], v[80:83], v[128:131], v[40:43]
    ds_read_b128 v[128:131], v4 offset:8192
    s_waitcnt vmcnt(4)
    v_lshlrev_b32 v8, 16, v8
    v_mul_f32 v8, 0x35e38e39, v8
    v_lshlrev_b32 v9, 16, v9
    v_mul_f32 v9, 0x35e38e39, v9
    v_lshlrev_b32 v10, 16, v10
    v_mul_f32 v10, 0x35e38e39, v10
    v_lshlrev_b32 v11, 16, v11
    v_mul_f32 v11, 0x35e38e39, v11
    v_lshlrev_b32 v12, 16, v12
    v_mul_f32 v12, 0x35e38e39, v12
    v_lshlrev_b32 v13, 16, v13
    v_mul_f32 v13, 0x35e38e39, v13
    v_lshlrev_b32 v14, 16, v14
    v_mul_f32 v14, 0x35e38e39, v14
    v_lshlrev_b32 v15, 16, v15
    v_mul_f32 v15, 0x35e38e39, v15
    v_lshlrev_b32 v16, 16, v16
    v_mul_f32 v16, 0x35e38e39, v16
    v_lshlrev_b32 v17, 16, v17
    v_mul_f32 v17, 0x35e38e39, v17
    v_lshlrev_b32 v18, 16, v18
    v_mul_f32 v18, 0x35e38e39, v18
    v_lshlrev_b32 v19, 16, v19
    v_mul_f32 v19, 0x35e38e39, v19
    v_lshlrev_b32 v20, 16, v20
    v_mul_f32 v20, 0x35e38e39, v20
    v_lshlrev_b32 v21, 16, v21
    v_mul_f32 v21, 0x35e38e39, v21
    v_lshlrev_b32 v22, 16, v22
    v_mul_f32 v22, 0x35e38e39, v22
    v_lshlrev_b32 v23, 16, v23
    v_mul_f32 v23, 0x35e38e39, v23
    v_lshlrev_b32 v92, 16, v32
    v_and_b32 v93, 0xffff0000, v32
    v_lshlrev_b32 v94, 16, v33
    v_and_b32 v95, 0xffff0000, v33
    v_lshlrev_b32 v96, 16, v34
    v_and_b32 v97, 0xffff0000, v34
    v_lshlrev_b32 v98, 16, v35
    v_and_b32 v99, 0xffff0000, v35
    v_lshlrev_b32 v100, 16, v36
    v_and_b32 v101, 0xffff0000, v36
    v_lshlrev_b32 v102, 16, v37
    v_and_b32 v103, 0xffff0000, v37
    v_lshlrev_b32 v104, 16, v38
    v_and_b32 v105, 0xffff0000, v38
    v_lshlrev_b32 v106, 16, v39
    v_and_b32 v107, 0xffff0000, v39
    s_waitcnt lgkmcnt(7)
    v_mfma_f32_16x16x32_bf16 v[48:51], v[80:83], v[132:135], v[48:51]
    ds_read_b128 v[132:135], v4 offset:26624
    s_waitcnt lgkmcnt(7)
    v_mfma_f32_16x16x32_bf16 v[44:47], v[116:119], v[136:139], v[44:47]
    ds_read_b128 v[136:139], v4 offset:17408
    s_waitcnt lgkmcnt(7)
    v_mfma_f32_16x16x32_bf16 v[52:55], v[116:119], v[140:143], v[52:55]
    ds_read_b128 v[140:143], v4 offset:35840
    s_waitcnt lgkmcnt(7)
    v_mfma_f32_16x16x32_bf16 v[40:43], v[84:87], v[144:147], v[40:43]
    s_waitcnt lgkmcnt(6)
    v_mfma_f32_16x16x32_bf16 v[48:51], v[84:87], v[148:151], v[48:51]
    s_waitcnt lgkmcnt(5)
    v_mfma_f32_16x16x32_bf16 v[44:47], v[120:123], v[152:155], v[44:47]
    s_waitcnt lgkmcnt(4)
    v_mfma_f32_16x16x32_bf16 v[52:55], v[120:123], v[156:159], v[52:55]
    s_waitcnt lgkmcnt(3)
    v_mfma_f32_16x16x32_bf16 v[40:43], v[88:91], v[128:131], v[40:43]
    s_waitcnt lgkmcnt(2)
    v_mfma_f32_16x16x32_bf16 v[48:51], v[88:91], v[132:135], v[48:51]
    s_waitcnt lgkmcnt(1)
    v_mfma_f32_16x16x32_bf16 v[44:47], v[124:127], v[136:139], v[44:47]
    s_waitcnt lgkmcnt(0)
    v_mfma_f32_16x16x32_bf16 v[52:55], v[124:127], v[140:143], v[52:55]
    s_lshl_b32 s42, s16, 1
    s_add_u32 s42, s42, s17
    s_mul_i32 s42, s42, 18432
    s_lshl_b32 s43, s15, 10
    s_add_u32 s42, s42, s43
    s_add_u32 s43, s42, 9216
    v_mul_u32_u24 v5, 80, v1
    v_lshl_add_u32 v7, s15, 3, v5
    v_add_f32 v72, v40, v44
    v_add_f32 v73, v41, v45
    v_add_f32 v74, v42, v46
    v_add_f32 v75, v43, v47
    v_sub_f32 v76, v40, v44
    v_sub_f32 v77, v41, v45
    v_sub_f32 v78, v42, v46
    v_sub_f32 v79, v43, v47
    v_add_f32 v80, v48, v52
    v_add_f32 v81, v49, v53
    v_add_f32 v82, v50, v54
    v_add_f32 v83, v51, v55
    v_sub_f32 v84, v48, v52
    v_sub_f32 v85, v49, v53
    v_sub_f32 v86, v50, v54
    v_sub_f32 v87, v51, v55
    v_fma_f32 v72, v72, v8, v92
    v_fma_f32 v73, v73, v9, v93
    v_fma_f32 v74, v74, v10, v94
    v_fma_f32 v75, v75, v11, v95
    v_fma_f32 v76, v76, v12, v96
    v_fma_f32 v77, v77, v13, v97
    v_fma_f32 v78, v78, v14, v98
    v_fma_f32 v79, v79, v15, v99
    v_fma_f32 v80, v80, v16, v100
    v_fma_f32 v81, v81, v17, v101
    v_fma_f32 v82, v82, v18, v102
    v_fma_f32 v83, v83, v19, v103
    v_fma_f32 v84, v84, v20, v104
    v_fma_f32 v85, v85, v21, v105
    v_fma_f32 v86, v86, v22, v106
    v_fma_f32 v87, v87, v23, v107
    v_add_f32 v24, v72, v73
    v_mul_f32 v25, v72, v72
    v_fmac_f32 v25, v73, v73
    v_add_f32 v24, v24, v74
    v_fmac_f32 v25, v74, v74
    v_add_f32 v24, v24, v75
    v_fmac_f32 v25, v75, v75
    v_add_f32 v24, v24, v76
    v_fmac_f32 v25, v76, v76
    v_add_f32 v24, v24, v77
    v_fmac_f32 v25, v77, v77
    v_add_f32 v24, v24, v78
    v_fmac_f32 v25, v78, v78
    v_add_f32 v24, v24, v79
    v_fmac_f32 v25, v79, v79
    v_add_f32 v24, v24, v80
    v_fmac_f32 v25, v80, v80
    v_add_f32 v24, v24, v81
    v_fmac_f32 v25, v81, v81
    v_add_f32 v24, v24, v82
    v_fmac_f32 v25, v82, v82
    v_add_f32 v24, v24, v83
    v_fmac_f32 v25, v83, v83
    v_add_f32 v24, v24, v84
    v_fmac_f32 v25, v84, v84
    v_add_f32 v24, v24, v85
    v_fmac_f32 v25, v85, v85
    v_add_f32 v24, v24, v86
    v_fmac_f32 v25, v86, v86
    v_add_f32 v24, v24, v87
    v_fmac_f32 v25, v87, v87
    v_mov_b32 v26, v24
    v_mov_b32 v27, v25
    s_nop 0
    v_permlane32_swap_b32 v24, v26
    v_permlane32_swap_b32 v25, v27
    v_add_f32 v24, v24, v26
    v_add_f32 v25, v25, v27
    v_mov_b32 v26, v24
    v_mov_b32 v27, v25
    s_nop 0
    v_permlane16_swap_b32 v24, v26
    v_permlane16_swap_b32 v25, v27
    v_add_f32 v24, v24, v26
    v_add_f32 v25, v25, v27
    ds_write_b64 v7, v[24:25] offset:36864
    v_cvt_pk_bf16_f32 v128, v72, v73
    v_cvt_pk_bf16_f32 v129, v74, v75
    v_cvt_pk_bf16_f32 v130, v76, v77
    v_cvt_pk_bf16_f32 v131, v78, v79
    buffer_store_dwordx4 v[128:131], v4, s[44:47], s42 offen sc1
    v_cvt_pk_bf16_f32 v132, v80, v81
    v_cvt_pk_bf16_f32 v133, v82, v83
    v_cvt_pk_bf16_f32 v134, v84, v85
    v_cvt_pk_bf16_f32 v135, v86, v87
    buffer_store_dwordx4 v[132:135], v4, s[44:47], s43 offen sc1
    s_waitcnt vmcnt(2)
    v_lshlrev_b32 v8, 16, v56
    v_and_b32 v56, 0xffff0000, v56
    v_lshlrev_b32 v9, 16, v57
    v_and_b32 v57, 0xffff0000, v57
    v_lshlrev_b32 v10, 16, v58
    v_and_b32 v58, 0xffff0000, v58
    v_lshlrev_b32 v11, 16, v59
    v_and_b32 v59, 0xffff0000, v59
    v_lshlrev_b32 v12, 16, v60
    v_and_b32 v60, 0xffff0000, v60
    v_lshlrev_b32 v13, 16, v61
    v_and_b32 v61, 0xffff0000, v61
    v_lshlrev_b32 v14, 16, v62
    v_and_b32 v62, 0xffff0000, v62
    v_lshlrev_b32 v15, 16, v63
    v_and_b32 v63, 0xffff0000, v63
    v_lshlrev_b32 v16, 16, v64
    v_and_b32 v64, 0xffff0000, v64
    v_lshlrev_b32 v17, 16, v65
    v_and_b32 v65, 0xffff0000, v65
    v_lshlrev_b32 v18, 16, v66
    v_and_b32 v66, 0xffff0000, v66
    v_lshlrev_b32 v19, 16, v67
    v_and_b32 v67, 0xffff0000, v67
    v_lshlrev_b32 v20, 16, v68
    v_and_b32 v68, 0xffff0000, v68
    v_lshlrev_b32 v21, 16, v69
    v_and_b32 v69, 0xffff0000, v69
    v_lshlrev_b32 v22, 16, v70
    v_and_b32 v70, 0xffff0000, v70
    v_lshlrev_b32 v23, 16, v71
    v_and_b32 v71, 0xffff0000, v71
    s_waitcnt lgkmcnt(0)
    s_barrier
    ds_read_b128 v[144:147], v5 offset:36864
    ds_read_b128 v[148:151], v5 offset:36880
    ds_read_b128 v[152:155], v5 offset:36896
    ds_read_b128 v[156:159], v5 offset:36912
    ds_read_b64 v[160:161], v5 offset:36928
    s_waitcnt lgkmcnt(0)
    v_add_f32 v144, v144, v146
    v_add_f32 v145, v145, v147
    v_add_f32 v144, v144, v148
    v_add_f32 v145, v145, v149
    v_add_f32 v144, v144, v150
    v_add_f32 v145, v145, v151
    v_add_f32 v144, v144, v152
    v_add_f32 v145, v145, v153
    v_add_f32 v144, v144, v154
    v_add_f32 v145, v145, v155
    v_add_f32 v144, v144, v156
    v_add_f32 v145, v145, v157
    v_add_f32 v144, v144, v158
    v_add_f32 v145, v145, v159
    v_add_f32 v144, v144, v160
    v_add_f32 v145, v145, v161
    v_mul_f32 v144, 0x3ae38e39, v144
    v_mul_f32 v145, 0x3ae38e39, v145
    v_fma_f32 v145, -v144, v144, v145
    v_max_f32 v145, 0, v145
    v_add_f32 v145, 0x3727c5ac, v145
    v_rsq_f32 v146, v145
    s_nop 0
    v_mul_f32 v147, v144, v146
    v_fma_f32 v72, v72, v146, -v147
    v_fma_f32 v73, v73, v146, -v147
    v_fma_f32 v74, v74, v146, -v147
    v_fma_f32 v75, v75, v146, -v147
    v_fma_f32 v76, v76, v146, -v147
    v_fma_f32 v77, v77, v146, -v147
    v_fma_f32 v78, v78, v146, -v147
    v_fma_f32 v79, v79, v146, -v147
    v_fma_f32 v80, v80, v146, -v147
    v_fma_f32 v81, v81, v146, -v147
    v_fma_f32 v82, v82, v146, -v147
    v_fma_f32 v83, v83, v146, -v147
    v_fma_f32 v84, v84, v146, -v147
    v_fma_f32 v85, v85, v146, -v147
    v_fma_f32 v86, v86, v146, -v147
    v_fma_f32 v87, v87, v146, -v147
    v_fma_f32 v72, v72, v56, v8
    v_fma_f32 v73, v73, v57, v9
    v_fma_f32 v74, v74, v58, v10
    v_fma_f32 v75, v75, v59, v11
    v_fma_f32 v76, v76, v60, v12
    v_fma_f32 v77, v77, v61, v13
    v_fma_f32 v78, v78, v62, v14
    v_fma_f32 v79, v79, v63, v15
    v_fma_f32 v80, v80, v64, v16
    v_fma_f32 v81, v81, v65, v17
    v_fma_f32 v82, v82, v66, v18
    v_fma_f32 v83, v83, v67, v19
    v_fma_f32 v84, v84, v68, v20
    v_fma_f32 v85, v85, v69, v21
    v_fma_f32 v86, v86, v70, v22
    v_fma_f32 v87, v87, v71, v23
    v_cvt_pk_bf16_f32 v136, v72, v73
    v_cvt_pk_bf16_f32 v137, v74, v75
    v_cvt_pk_bf16_f32 v138, v76, v77
    v_cvt_pk_bf16_f32 v139, v78, v79
    buffer_store_dwordx4 v[136:139], v4, s[48:51], s42 offen sc1
    v_cvt_pk_bf16_f32 v140, v80, v81
    v_cvt_pk_bf16_f32 v141, v82, v83
    v_cvt_pk_bf16_f32 v142, v84, v85
    v_cvt_pk_bf16_f32 v143, v86, v87
    buffer_store_dwordx4 v[140:143], v4, s[48:51], s43 offen sc1
    s_endpgm
K3_touch:
    s_cmp_ge_u32 s2, 256
    s_cbranch_scc1 K3_tend
    s_load_dwordx4 s[4:7], s[0:1], 32
    s_load_dwordx2 s[10:11], s[0:1], 48
    s_and_b32 s3, s2, 7
    s_bfe_u32 s8, s2, 0x40003
    s_lshl4_add_u32 s9, s3, s8
    s_mul_i32 s9, s9, 41472
    s_mul_i32 s3, s3, 1152
    v_lshlrev_b32 v5, 7, v0
    s_mul_i32 s8, s8, 331776
    s_add_u32 s3, s3, s8
    v_mul_u32_u24 v2, 7282, v0
    v_lshrrev_b32 v2, 16, v2
    v_mul_u32_u24 v3, 9, v2
    v_sub_u32 v3, v0, v3
    v_mul_u32_u24 v1, 9216, v2
    v_lshl_add_u32 v1, v3, 7, v1
    v_mov_b32 v4, 99
    v_lshrrev_b32 v4, v3, v4
    v_and_b32 v4, 1, v4
    v_cmp_eq_u32 vcc, 1, v4
    s_nop 1
    v_cndmask_b32 v5, 2.0, v5, vcc
    v_mov_b32 v4, 511
    v_lshrrev_b32 v3, v3, v4
    v_and_b32 v3, 1, v3
    v_cmp_eq_u32 vcc, 1, v3
    s_nop 1
    v_cndmask_b32 v1, 2.0, v1, vcc
    v_cmp_gt_u32 vcc, 324, v0
    s_nop 0
    s_and_saveexec_b64 s[40:41], vcc
    s_cbranch_execz K3_tend
    s_waitcnt lgkmcnt(0)
    s_mov_b32 s12, s4
    s_mov_b32 s13, s5
    s_mov_b32 s14, 5308416
    s_mov_b32 s15, 0x20000
    s_mov_b32 s16, s6
    s_mov_b32 s17, s7
    s_mov_b32 s18, 5308416
    s_mov_b32 s19, 0x20000
    s_mov_b32 s20, s10
    s_mov_b32 s21, s11
    s_mov_b32 s22, 5308416
    s_mov_b32 s23, 0x20000
    buffer_load_dword v4, v5, s[20:23], s9 offen
    s_waitcnt vmcnt(0)
    buffer_load_dword v2, v1, s[12:15], s3 offen
    buffer_load_dword v3, v1, s[16:19], s3 offen
    s_waitcnt vmcnt(0)
K3_tend:
    s_endpgm
.globl k4_kernel
.p2align 8
.type k4_kernel,@function
k4_kernel:
    s_cmp_ge_u32 s2, 256
    s_cbranch_scc1 K4_end
    s_load_dwordx4 s[4:7], s[0:1], 32
    s_load_dwordx2 s[8:9], s[0:1], 48
    s_load_dwordx2 s[10:11], s[0:1], 88
    s_load_dwordx2 s[60:61], s[0:1], 72
    v_lshrrev_b32 v9, 6, v0
    v_and_b32 v4, 63, v0
    s_and_b32 s12, s2, 7
    v_readfirstlane_b32 s15, v9
    s_lshl_b32 s12, s12, 1
    s_bfe_u32 s13, s2, 0x10003
    s_add_u32 s12, s12, s13
    s_lshr_b32 s14, s2, 4
    s_and_b32 s16, s15, 3
    s_lshr_b32 s17, s15, 2
    s_lshl_b32 s18, s15, 10
    s_lshr_b32 s40, s16, 1
    s_and_b32 s41, s16, 1
    s_mul_i32 s42, s40, 2654208
    s_mul_i32 s43, s41, 73728
    s_add_u32 s36, s42, s43
    s_mul_i32 s44, s12, 576
    s_add_u32 s36, s36, s44
    s_lshl_b32 s45, s13, 6
    s_add_u32 s36, s36, s45
    s_mul_i32 s42, s41, 2654208
    s_mul_i32 s43, s40, 147456
    s_add_u32 s37, s42, s43
    s_add_u32 s37, s37, s44
    s_xor_b32 s45, s13, 1
    s_lshl_b32 s45, s45, 9
    s_add_u32 s37, s37, s45
    s_and_b32 s19, s2, 7
    s_mul_i32 s39, s19, 663552
    s_mul_i32 s42, s16, 9216
    s_add_u32 s38, s39, s42
    s_mul_i32 s42, s13, 640
    s_add_u32 s38, s38, s42
    s_xor_b32 s42, s13, s17
    s_mul_i32 s42, s42, 36864
    s_add_u32 s52, s38, s42
    s_add_u32 s52, s52, 294912
    s_mul_i32 s42, s17, 36864
    s_add_u32 s38, s38, s42
    s_mul_i32 s42, s13, 368640
    s_sub_u32 s43, 368640, s42
    s_add_u32 s50, s38, s42
    s_add_u32 s51, s38, s43
    s_lshl_b32 s38, s13, 6
    s_add_u32 s39, s39, s38
    s_add_u32 s39, s39, 512
    s_mul_i32 s38, s15, 18432
    s_add_u32 s38, s38, s39
    s_add_u32 s53, s38, s42
    s_add_u32 s58, s38, s43
    s_lshl_b32 s38, s13, 1
    s_xor_b32 s38, s38, s16
    s_mul_i32 s38, s38, 18432
    s_add_u32 s39, s39, s38
    s_add_u32 s39, s39, 294912
    s_lshl_b32 s42, s16, 11
    s_mul_i32 s43, s13, 73728
    s_add_u32 s88, s42, s43
    s_sub_u32 s89, s42, s43
    s_add_u32 s89, s89, 73728
    s_lshl_b32 s42, s17, 10
    s_add_u32 s95, s88, s42
    s_add_u32 s95, s95, 65536
    s_lshl_b32 s42, s17, 13
    s_add_u32 s88, s88, s42
    s_lshl_b32 s46, s14, 2
    s_add_u32 s46, s46, s16
    s_mul_i32 s47, s46, 36864
    s_mul_i32 s42, s17, 18432
    s_add_u32 s46, s47, s42
    s_mul_i32 s42, s13, 1024
    s_add_u32 s94, s46, s42
    s_add_u32 s94, s94, 8192
    s_mul_i32 s42, s13, 10
    s_add_u32 s42, s42, s17
    s_lshl_b32 s42, s42, 10
    s_add_u32 s47, s47, s42
    v_lshrrev_b32 v9, 3, v4
    v_bfe_u32 v5, v4, 4, 2
    v_lshlrev_b32 v5, 1, v5
    v_and_b32 v6, 7, v4
    v_xor_b32 v5, v5, v6
    v_lshlrev_b32 v5, 4, v5
    v_mul_u32_u24 v1, 9216, v9
    v_add_u32 v1, v1, v5
    v_mul_u32_u24 v3, 1152, v9
    v_add_u32 v3, v3, v5
    v_lshrrev_b32 v9, 2, v4
    v_mul_u32_u24 v2, 9216, v9
    v_bfe_u32 v5, v4, 4, 1
    v_lshlrev_b32 v5, 1, v5
    v_and_b32 v6, 3, v4
    v_xor_b32 v5, v5, v6
    v_lshl_add_u32 v2, v5, 4, v2
    v_bfe_u32 v5, v4, 3, 2
    s_lshl_b32 s42, s17, 1
    v_xor_b32 v5, s42, v5
    v_lshlrev_b32 v5, 5, v5
    v_lshl_add_u32 v5, v9, 7, v5
    v_lshl_add_u32 v17, v6, 3, v5
    v_xor_b32 v18, 32, v17
    v_add_u32 v19, 49152, v17
    v_add_u32 v20, 49152, v18
    v_bfe_u32 v5, v4, 4, 1
    v_xor_b32 v5, s17, v5
    v_lshlrev_b32 v5, 5, v5
    v_lshl_add_u32 v5, v9, 6, v5
    v_lshl_add_u32 v21, v6, 3, v5
    v_add_u32 v22, 49152, v21
    v_lshlrev_b32 v4, 4, v4
    s_lshl_b32 s42, s16, 10
    s_add_u32 s42, s42, 90112
    v_add_u32 v5, s42, v4
    v_add_u32 v10, 65536, v5
    s_lshl_b32 s42, s16, 11
    s_add_u32 s42, s42, 90112
    v_add_u32 v7, s42, v4
    s_lshl_b32 s43, s17, 13
    v_add_u32 v6, s43, v7
    s_lshl_b32 s43, s17, 3
    s_add_u32 s43, s43, 65536
    v_add_u32 v8, s43, v7
    s_waitcnt lgkmcnt(0)
    s_cmp_eq_u32 s17, 0
    s_cselect_b32 s4, s4, s6
    s_cselect_b32 s5, s5, s7
    s_mov_b32 s20, s4
    s_mov_b32 s21, s5
    s_mov_b32 s22, 5308416
    s_mov_b32 s23, 0x20000
    s_mov_b32 s24, s8
    s_mov_b32 s25, s9
    s_mov_b32 s26, 5308416
    s_mov_b32 s27, 0x20000
    s_add_u32 s28, s10, 50331648
    s_addc_u32 s29, s11, 0
    s_mov_b32 s30, 2359296
    s_mov_b32 s31, 0x20000
    s_mov_b64 s[62:63], s[10:11]
    s_mul_i32 s42, s19, 2359296
    s_add_u32 s10, s10, s42
    s_addc_u32 s11, s11, 0
    s_add_u32 s32, s10, 8388608
    s_addc_u32 s33, s11, 0
    s_mov_b32 s34, 2359296
    s_mov_b32 s35, 0x20000
    s_lshl_b32 s42, s14, 3
    s_add_u32 s42, s42, s19
    s_mul_i32 s42, s42, 147456
    s_add_u32 s10, s62, s42
    s_addc_u32 s11, s63, 0
    s_add_u32 s84, s10, 28311552
    s_addc_u32 s85, s11, 0
    s_mov_b32 s86, 147456
    s_mov_b32 s87, 0x20000
    v_lshrrev_b32 v11, 4, v4
    v_min_u32 v11, 8, v11
    v_mul_u32_u24 v11, 9216, v11
    v_min_u32 v12, 161, v0
    v_lshlrev_b32 v12, 7, v12
    s_lshl_b32 s42, s14, 2
    s_add_u32 s42, s42, s16
    s_mul_i32 s42, s42, 82944
    s_add_u32 s54, s42, s44
    s_add_u32 s55, s54, s45
    s_lshl_b32 s42, s13, 6
    s_add_u32 s54, s54, s42
    s_lshl_b32 s42, s12, 4
    s_add_u32 s42, s42, s14
    s_mul_i32 s59, s42, 20736
    s_getpc_b64 s[56:57]
K4_pc:
    v_lshlrev_b32 v168, 7, v0
    v_min_u32 v168, K4_end-K4_pc, v168
    global_load_dword v168, v168, s[56:57]
    s_add_u32 m0, s18, 90112
    s_add_u32 s48, s46, 0
    buffer_load_dwordx4 v4, s[28:31], s48 offen lds
    s_add_u32 m0, s18, 0
    s_add_u32 s48, s36, 0
    buffer_load_dwordx4 v1, s[20:23], s48 offen lds
    s_add_u32 m0, s18, 98304
    s_add_u32 s48, s46, 1024
    buffer_load_dwordx4 v4, s[28:31], s48 offen lds
    s_add_u32 m0, s18, 8192
    s_add_u32 s48, s36, 147456
    buffer_load_dwordx4 v1, s[20:23], s48 offen lds
    s_add_u32 m0, s18, 106496
    s_add_u32 s48, s46, 2048
    buffer_load_dwordx4 v4, s[28:31], s48 offen lds
    s_add_u32 m0, s18, 16384
    s_add_u32 s48, s36, 294912
    buffer_load_dwordx4 v1, s[20:23], s48 offen lds
    s_add_u32 m0, s18, 114688
    s_add_u32 s48, s46, 3072
    buffer_load_dwordx4 v4, s[28:31], s48 offen lds
    s_add_u32 m0, s18, 24576
    s_add_u32 s48, s36, 442368
    buffer_load_dwordx4 v1, s[20:23], s48 offen lds
    s_add_u32 m0, s18, 122880
    s_add_u32 s48, s46, 4096
    buffer_load_dwordx4 v4, s[28:31], s48 offen lds
    s_add_u32 m0, s18, 32768
    s_add_u32 s48, s36, 589824
    buffer_load_dwordx4 v1, s[20:23], s48 offen lds
    s_add_u32 m0, s18, 131072
    s_add_u32 s48, s46, 5120
    buffer_load_dwordx4 v4, s[28:31], s48 offen lds
    s_add_u32 m0, s18, 40960
    s_add_u32 s48, s36, 737280
    buffer_load_dwordx4 v1, s[20:23], s48 offen lds
    s_add_u32 m0, s18, 139264
    s_add_u32 s48, s46, 6144
    buffer_load_dwordx4 v4, s[28:31], s48 offen lds
    s_add_u32 m0, s18, 49152
    s_add_u32 s48, s36, 884736
    buffer_load_dwordx4 v1, s[20:23], s48 offen lds
    v_add_u32 v9, 65536, v7
    s_waitcnt vmcnt(8)
    s_barrier
    ds_read_b128 v[24:27], v5 offset:0
    ds_read_b128 v[28:31], v5 offset:4096
    ds_read_b64_tr_b16 v[216:217], v17 offset:0
    ds_read_b64_tr_b16 v[218:219], v17 offset:2048
    ds_read_b64_tr_b16 v[220:221], v18 offset:0
    ds_read_b64_tr_b16 v[222:223], v18 offset:2048
    ds_read_b64_tr_b16 v[224:225], v17 offset:4096
    ds_read_b64_tr_b16 v[226:227], v17 offset:6144
    ds_read_b64_tr_b16 v[228:229], v18 offset:4096
    ds_read_b64_tr_b16 v[230:231], v18 offset:6144
    s_waitcnt lgkmcnt(6)
    v_mfma_f32_16x16x32_bf16 v[168:171], v[216:219], v[24:27], 0
    ds_read_b128 v[32:35], v5 offset:8192
    ds_read_b128 v[36:39], v5 offset:12288
    v_mfma_f32_16x16x32_bf16 v[172:175], v[216:219], v[28:31], 0
    ds_read_b64_tr_b16 v[232:233], v17 offset:8192
    ds_read_b64_tr_b16 v[234:235], v17 offset:10240
    s_add_u32 m0, s18, 147456
    s_add_u32 s48, s46, 7168
    buffer_load_dwordx4 v4, s[28:31], s48 offen lds
    s_waitcnt lgkmcnt(8)
    v_mfma_f32_16x16x32_bf16 v[176:179], v[220:223], v[24:27], 0
    ds_read_b64_tr_b16 v[236:237], v18 offset:8192
    v_mfma_f32_16x16x32_bf16 v[180:183], v[220:223], v[28:31], 0
    ds_read_b64_tr_b16 v[238:239], v18 offset:10240
    s_add_u32 m0, s18, 57344
    s_add_u32 s48, s36, 1032192
    buffer_load_dwordx4 v1, s[20:23], s48 offen lds
    s_waitcnt lgkmcnt(8)
    v_mfma_f32_16x16x32_bf16 v[184:187], v[224:227], v[24:27], 0
    ds_read_b64_tr_b16 v[240:241], v17 offset:12288
    v_mfma_f32_16x16x32_bf16 v[188:191], v[224:227], v[28:31], 0
    ds_read_b64_tr_b16 v[242:243], v17 offset:14336
    s_add_u32 m0, s18, 65536
    s_add_u32 s48, s36, 1179648
    buffer_load_dwordx4 v1, s[20:23], s48 offen lds
    s_waitcnt lgkmcnt(8)
    v_mfma_f32_16x16x32_bf16 v[192:195], v[228:231], v[24:27], 0
    ds_read_b64_tr_b16 v[244:245], v18 offset:12288
    v_mfma_f32_16x16x32_bf16 v[196:199], v[228:231], v[28:31], 0
    ds_read_b64_tr_b16 v[246:247], v18 offset:14336
    s_waitcnt lgkmcnt(6)
    v_mfma_f32_16x16x32_bf16 v[168:171], v[232:235], v[32:35], v[168:171]
    ds_read_b128 v[40:43], v5 offset:16384
    ds_read_b128 v[44:47], v5 offset:20480
    v_mfma_f32_16x16x32_bf16 v[172:175], v[232:235], v[36:39], v[172:175]
    ds_read_b64_tr_b16 v[216:217], v17 offset:16384
    ds_read_b64_tr_b16 v[218:219], v17 offset:18432
    s_add_u32 m0, s18, 155648
    s_add_u32 s48, s46, 8192
    buffer_load_dwordx4 v4, s[28:31], s48 offen lds
    s_waitcnt lgkmcnt(8)
    v_mfma_f32_16x16x32_bf16 v[176:179], v[236:239], v[32:35], v[176:179]
    ds_read_b64_tr_b16 v[220:221], v18 offset:16384
    v_mfma_f32_16x16x32_bf16 v[180:183], v[236:239], v[36:39], v[180:183]
    ds_read_b64_tr_b16 v[222:223], v18 offset:18432
    s_add_u32 m0, s18, 73728
    s_add_u32 s48, s36, 1327104
    buffer_load_dwordx4 v1, s[20:23], s48 offen lds
    s_waitcnt lgkmcnt(8)
    v_mfma_f32_16x16x32_bf16 v[184:187], v[240:243], v[32:35], v[184:187]
    ds_read_b64_tr_b16 v[224:225], v17 offset:20480
    v_mfma_f32_16x16x32_bf16 v[188:191], v[240:243], v[36:39], v[188:191]
    ds_read_b64_tr_b16 v[226:227], v17 offset:22528
    s_waitcnt lgkmcnt(8)
    v_mfma_f32_16x16x32_bf16 v[192:195], v[244:247], v[32:35], v[192:195]
    ds_read_b64_tr_b16 v[228:229], v18 offset:20480
    v_mfma_f32_16x16x32_bf16 v[196:199], v[244:247], v[36:39], v[196:199]
    ds_read_b64_tr_b16 v[230:231], v18 offset:22528
    s_waitcnt vmcnt(7)
    s_barrier
    s_waitcnt lgkmcnt(6)
    v_mfma_f32_16x16x32_bf16 v[168:171], v[216:219], v[40:43], v[168:171]
    ds_read_b128 v[48:51], v5 offset:24576
    ds_read_b128 v[52:55], v5 offset:28672
    v_mfma_f32_16x16x32_bf16 v[172:175], v[216:219], v[44:47], v[172:175]
    ds_read_b64_tr_b16 v[232:233], v17 offset:24576
    ds_read_b64_tr_b16 v[234:235], v17 offset:26624
    s_add_u32 m0, s18, 90112
    s_add_u32 s48, s46, 9216
    buffer_load_dwordx4 v4, s[28:31], s48 offen lds
    s_waitcnt lgkmcnt(8)
    v_mfma_f32_16x16x32_bf16 v[176:179], v[220:223], v[40:43], v[176:179]
    ds_read_b64_tr_b16 v[236:237], v18 offset:24576
    v_mfma_f32_16x16x32_bf16 v[180:183], v[220:223], v[44:47], v[180:183]
    ds_read_b64_tr_b16 v[238:239], v18 offset:26624
    s_add_u32 m0, s18, 81920
    s_add_u32 s48, s36, 1474560
    buffer_load_dwordx4 v1, s[20:23], s48 offen lds
    s_waitcnt lgkmcnt(8)
    v_mfma_f32_16x16x32_bf16 v[184:187], v[224:227], v[40:43], v[184:187]
    ds_read_b64_tr_b16 v[240:241], v17 offset:28672
    v_mfma_f32_16x16x32_bf16 v[188:191], v[224:227], v[44:47], v[188:191]
    ds_read_b64_tr_b16 v[242:243], v17 offset:30720
    s_waitcnt lgkmcnt(8)
    v_mfma_f32_16x16x32_bf16 v[192:195], v[228:231], v[40:43], v[192:195]
    ds_read_b64_tr_b16 v[244:245], v18 offset:28672
    v_mfma_f32_16x16x32_bf16 v[196:199], v[228:231], v[44:47], v[196:199]
    ds_read_b64_tr_b16 v[246:247], v18 offset:30720
    s_waitcnt lgkmcnt(6)
    v_mfma_f32_16x16x32_bf16 v[168:171], v[232:235], v[48:51], v[168:171]
    ds_read_b128 v[56:59], v5 offset:32768
    ds_read_b128 v[60:63], v5 offset:36864
    v_mfma_f32_16x16x32_bf16 v[172:175], v[232:235], v[52:55], v[172:175]
    ds_read_b64_tr_b16 v[216:217], v17 offset:32768
    ds_read_b64_tr_b16 v[218:219], v17 offset:34816
    s_add_u32 m0, s18, 98304
    s_add_u32 s48, s46, 10240
    buffer_load_dwordx4 v4, s[28:31], s48 offen lds
    s_waitcnt lgkmcnt(8)
    v_mfma_f32_16x16x32_bf16 v[176:179], v[236:239], v[48:51], v[176:179]
    ds_read_b64_tr_b16 v[220:221], v18 offset:32768
    v_mfma_f32_16x16x32_bf16 v[180:183], v[236:239], v[52:55], v[180:183]
    ds_read_b64_tr_b16 v[222:223], v18 offset:34816
    s_add_u32 m0, s18, 0
    s_add_u32 s48, s36, 1622016
    buffer_load_dwordx4 v1, s[20:23], s48 offen lds
    s_waitcnt lgkmcnt(8)
    v_mfma_f32_16x16x32_bf16 v[184:187], v[240:243], v[48:51], v[184:187]
    ds_read_b64_tr_b16 v[224:225], v17 offset:36864
    v_mfma_f32_16x16x32_bf16 v[188:191], v[240:243], v[52:55], v[188:191]
    ds_read_b64_tr_b16 v[226:227], v17 offset:38912
    s_waitcnt lgkmcnt(8)
    v_mfma_f32_16x16x32_bf16 v[192:195], v[244:247], v[48:51], v[192:195]
    ds_read_b64_tr_b16 v[228:229], v18 offset:36864
    v_mfma_f32_16x16x32_bf16 v[196:199], v[244:247], v[52:55], v[196:199]
    ds_read_b64_tr_b16 v[230:231], v18 offset:38912
    s_waitcnt lgkmcnt(6)
    v_mfma_f32_16x16x32_bf16 v[168:171], v[216:219], v[56:59], v[168:171]
    ds_read_b128 v[64:67], v5 offset:40960
    ds_read_b128 v[68:71], v5 offset:45056
    v_mfma_f32_16x16x32_bf16 v[172:175], v[216:219], v[60:63], v[172:175]
    ds_read_b64_tr_b16 v[232:233], v17 offset:40960
    ds_read_b64_tr_b16 v[234:235], v17 offset:43008
    s_add_u32 m0, s18, 8192
    s_add_u32 s48, s36, 1769472
    buffer_load_dwordx4 v1, s[20:23], s48 offen lds
    s_waitcnt lgkmcnt(8)
    v_mfma_f32_16x16x32_bf16 v[176:179], v[220:223], v[56:59], v[176:179]
    ds_read_b64_tr_b16 v[236:237], v18 offset:40960
    v_mfma_f32_16x16x32_bf16 v[180:183], v[220:223], v[60:63], v[180:183]
    ds_read_b64_tr_b16 v[238:239], v18 offset:43008
    s_waitcnt lgkmcnt(8)
    v_mfma_f32_16x16x32_bf16 v[184:187], v[224:227], v[56:59], v[184:187]
    ds_read_b64_tr_b16 v[240:241], v17 offset:45056
    v_mfma_f32_16x16x32_bf16 v[188:191], v[224:227], v[60:63], v[188:191]
    ds_read_b64_tr_b16 v[242:243], v17 offset:47104
    s_waitcnt lgkmcnt(8)
    v_mfma_f32_16x16x32_bf16 v[192:195], v[228:231], v[56:59], v[192:195]
    ds_read_b64_tr_b16 v[244:245], v18 offset:45056
    v_mfma_f32_16x16x32_bf16 v[196:199], v[228:231], v[60:63], v[196:199]
    ds_read_b64_tr_b16 v[246:247], v18 offset:47104
    s_waitcnt vmcnt(6)
    s_barrier
    s_waitcnt lgkmcnt(6)
    v_mfma_f32_16x16x32_bf16 v[168:171], v[232:235], v[64:67], v[168:171]
    ds_read_b128 v[72:75], v5 offset:49152
    ds_read_b128 v[76:79], v5 offset:53248
    v_mfma_f32_16x16x32_bf16 v[172:175], v[232:235], v[68:71], v[172:175]
    ds_read_b64_tr_b16 v[216:217], v19 offset:0
    ds_read_b64_tr_b16 v[218:219], v19 offset:2048
    s_add_u32 m0, s18, 106496
    s_add_u32 s48, s46, 11264
    buffer_load_dwordx4 v4, s[28:31], s48 offen lds
    s_waitcnt lgkmcnt(8)
    v_mfma_f32_16x16x32_bf16 v[176:179], v[236:239], v[64:67], v[176:179]
    ds_read_b64_tr_b16 v[220:221], v20 offset:0
    v_mfma_f32_16x16x32_bf16 v[180:183], v[236:239], v[68:71], v[180:183]
    ds_read_b64_tr_b16 v[222:223], v20 offset:2048
    s_add_u32 m0, s18, 16384
    s_add_u32 s48, s36, 1916928
    buffer_load_dwordx4 v1, s[20:23], s48 offen lds
    s_waitcnt lgkmcnt(8)
    v_mfma_f32_16x16x32_bf16 v[184:187], v[240:243], v[64:67], v[184:187]
    ds_read_b64_tr_b16 v[224:225], v19 offset:4096
    v_mfma_f32_16x16x32_bf16 v[188:191], v[240:243], v[68:71], v[188:191]
    ds_read_b64_tr_b16 v[226:227], v19 offset:6144
    s_add_u32 m0, s18, 114688
    s_add_u32 s48, s46, 12288
    buffer_load_dwordx4 v4, s[28:31], s48 offen lds
    s_waitcnt lgkmcnt(8)
    v_mfma_f32_16x16x32_bf16 v[192:195], v[244:247], v[64:67], v[192:195]
    ds_read_b64_tr_b16 v[228:229], v20 offset:4096
    v_mfma_f32_16x16x32_bf16 v[196:199], v[244:247], v[68:71], v[196:199]
    ds_read_b64_tr_b16 v[230:231], v20 offset:6144
    s_waitcnt lgkmcnt(6)
    v_mfma_f32_16x16x32_bf16 v[168:171], v[216:219], v[72:75], v[168:171]
    ds_read_b128 v[80:83], v5 offset:57344
    ds_read_b128 v[84:87], v5 offset:61440
    v_mfma_f32_16x16x32_bf16 v[172:175], v[216:219], v[76:79], v[172:175]
    ds_read_b64_tr_b16 v[232:233], v19 offset:8192
    ds_read_b64_tr_b16 v[234:235], v19 offset:10240
    s_add_u32 m0, s18, 122880
    s_add_u32 s48, s46, 13312
    buffer_load_dwordx4 v4, s[28:31], s48 offen lds
    s_waitcnt lgkmcnt(8)
    v_mfma_f32_16x16x32_bf16 v[176:179], v[220:223], v[72:75], v[176:179]
    ds_read_b64_tr_b16 v[236:237], v20 offset:8192
    v_mfma_f32_16x16x32_bf16 v[180:183], v[220:223], v[76:79], v[180:183]
    ds_read_b64_tr_b16 v[238:239], v20 offset:10240
    s_add_u32 m0, s18, 24576
    s_add_u32 s48, s36, 2064384
    buffer_load_dwordx4 v1, s[20:23], s48 offen lds
    s_waitcnt lgkmcnt(8)
    v_mfma_f32_16x16x32_bf16 v[184:187], v[224:227], v[72:75], v[184:187]
    ds_read_b64_tr_b16 v[240:241], v19 offset:12288
    v_mfma_f32_16x16x32_bf16 v[188:191], v[224:227], v[76:79], v[188:191]
    ds_read_b64_tr_b16 v[242:243], v19 offset:14336
    s_waitcnt lgkmcnt(8)
    v_mfma_f32_16x16x32_bf16 v[192:195], v[228:231], v[72:75], v[192:195]
    ds_read_b64_tr_b16 v[244:245], v20 offset:12288
    v_mfma_f32_16x16x32_bf16 v[196:199], v[228:231], v[76:79], v[196:199]
    ds_read_b64_tr_b16 v[246:247], v20 offset:14336
    s_waitcnt lgkmcnt(6)
    v_mfma_f32_16x16x32_bf16 v[168:171], v[232:235], v[80:83], v[168:171]
    ds_read_b128 v[88:91], v10 offset:0
    ds_read_b128 v[92:95], v10 offset:4096
    v_mfma_f32_16x16x32_bf16 v[172:175], v[232:235], v[84:87], v[172:175]
    ds_read_b64_tr_b16 v[216:217], v19 offset:16384
    ds_read_b64_tr_b16 v[218:219], v19 offset:18432
    s_add_u32 m0, s18, 32768
    s_add_u32 s48, s36, 2211840
    buffer_load_dwordx4 v1, s[20:23], s48 offen lds
    s_waitcnt lgkmcnt(8)
    v_mfma_f32_16x16x32_bf16 v[176:179], v[236:239], v[80:83], v[176:179]
    ds_read_b64_tr_b16 v[220:221], v20 offset:16384
    v_mfma_f32_16x16x32_bf16 v[180:183], v[236:239], v[84:87], v[180:183]
    ds_read_b64_tr_b16 v[222:223], v20 offset:18432
    s_waitcnt lgkmcnt(8)
    v_mfma_f32_16x16x32_bf16 v[184:187], v[240:243], v[80:83], v[184:187]
    ds_read_b64_tr_b16 v[224:225], v19 offset:20480
    v_mfma_f32_16x16x32_bf16 v[188:191], v[240:243], v[84:87], v[188:191]
    ds_read_b64_tr_b16 v[226:227], v19 offset:22528
    s_waitcnt lgkmcnt(8)
    v_mfma_f32_16x16x32_bf16 v[192:195], v[244:247], v[80:83], v[192:195]
    ds_read_b64_tr_b16 v[228:229], v20 offset:20480
    v_mfma_f32_16x16x32_bf16 v[196:199], v[244:247], v[84:87], v[196:199]
    ds_read_b64_tr_b16 v[230:231], v20 offset:22528
    s_waitcnt vmcnt(5)
    s_barrier
    s_waitcnt lgkmcnt(6)
    v_mfma_f32_16x16x32_bf16 v[168:171], v[216:219], v[88:91], v[168:171]
    ds_read_b128 v[96:99], v5 offset:0
    ds_read_b128 v[100:103], v5 offset:4096
    v_mfma_f32_16x16x32_bf16 v[172:175], v[216:219], v[92:95], v[172:175]
    ds_read_b64_tr_b16 v[232:233], v19 offset:24576
    ds_read_b64_tr_b16 v[234:235], v19 offset:26624
    s_add_u32 m0, s18, 131072
    s_add_u32 s48, s46, 14336
    buffer_load_dwordx4 v4, s[28:31], s48 offen lds
    s_waitcnt lgkmcnt(8)
    v_mfma_f32_16x16x32_bf16 v[176:179], v[220:223], v[88:91], v[176:179]
    ds_read_b64_tr_b16 v[236:237], v20 offset:24576
    v_mfma_f32_16x16x32_bf16 v[180:183], v[220:223], v[92:95], v[180:183]
    ds_read_b64_tr_b16 v[238:239], v20 offset:26624
    s_add_u32 m0, s18, 40960
    s_add_u32 s48, s36, 2359296
    buffer_load_dwordx4 v1, s[20:23], s48 offen lds
    s_waitcnt lgkmcnt(8)
    v_mfma_f32_16x16x32_bf16 v[184:187], v[224:227], v[88:91], v[184:187]
    ds_read_b64_tr_b16 v[240:241], v19 offset:28672
    v_mfma_f32_16x16x32_bf16 v[188:191], v[224:227], v[92:95], v[188:191]
    ds_read_b64_tr_b16 v[242:243], v19 offset:30720
    s_add_u32 m0, s18, 139264
    s_add_u32 s48, s46, 15360
    buffer_load_dwordx4 v4, s[28:31], s48 offen lds
    s_waitcnt lgkmcnt(8)
    v_mfma_f32_16x16x32_bf16 v[192:195], v[228:231], v[88:91], v[192:195]
    ds_read_b64_tr_b16 v[244:245], v20 offset:28672
    v_mfma_f32_16x16x32_bf16 v[196:199], v[228:231], v[92:95], v[196:199]
    ds_read_b64_tr_b16 v[246:247], v20 offset:30720
    s_waitcnt lgkmcnt(6)
    v_mfma_f32_16x16x32_bf16 v[168:171], v[232:235], v[96:99], v[168:171]
    ds_read_b128 v[104:107], v5 offset:8192
    ds_read_b128 v[108:111], v5 offset:12288
    v_mfma_f32_16x16x32_bf16 v[172:175], v[232:235], v[100:103], v[172:175]
    ds_read_b64_tr_b16 v[216:217], v19 offset:32768
    ds_read_b64_tr_b16 v[218:219], v19 offset:34816
    s_add_u32 m0, s18, 147456
    s_add_u32 s48, s46, 16384
    buffer_load_dwordx4 v4, s[28:31], s48 offen lds
    s_waitcnt lgkmcnt(8)
    v_mfma_f32_16x16x32_bf16 v[176:179], v[236:239], v[96:99], v[176:179]
    ds_read_b64_tr_b16 v[220:221], v20 offset:32768
    v_mfma_f32_16x16x32_bf16 v[180:183], v[236:239], v[100:103], v[180:183]
    ds_read_b64_tr_b16 v[222:223], v20 offset:34816
    s_add_u32 m0, s18, 49152
    s_add_u32 s48, s36, 2506752
    buffer_load_dwordx4 v1, s[20:23], s48 offen lds
    s_waitcnt lgkmcnt(8)
    v_mfma_f32_16x16x32_bf16 v[184:187], v[240:243], v[96:99], v[184:187]
    ds_read_b64_tr_b16 v[224:225], v19 offset:36864
    v_mfma_f32_16x16x32_bf16 v[188:191], v[240:243], v[100:103], v[188:191]
    ds_read_b64_tr_b16 v[226:227], v19 offset:38912
    s_waitcnt lgkmcnt(8)
    v_mfma_f32_16x16x32_bf16 v[192:195], v[244:247], v[96:99], v[192:195]
    ds_read_b64_tr_b16 v[228:229], v20 offset:36864
    v_mfma_f32_16x16x32_bf16 v[196:199], v[244:247], v[100:103], v[196:199]
    ds_read_b64_tr_b16 v[230:231], v20 offset:38912
    s_waitcnt lgkmcnt(6)
    v_mfma_f32_16x16x32_bf16 v[168:171], v[216:219], v[104:107], v[168:171]
    ds_read_b128 v[112:115], v5 offset:16384
    ds_read_b128 v[116:119], v5 offset:20480
    v_mfma_f32_16x16x32_bf16 v[172:175], v[216:219], v[108:111], v[172:175]
    ds_read_b64_tr_b16 v[232:233], v17 offset:0
    ds_read_b64_tr_b16 v[234:235], v17 offset:2048
    s_add_u32 m0, s18, 57344
    s_add_u32 s48, s36, 128
    buffer_load_dwordx4 v1, s[20:23], s48 offen lds
    s_waitcnt lgkmcnt(8)
    v_mfma_f32_16x16x32_bf16 v[176:179], v[220:223], v[104:107], v[176:179]
    ds_read_b64_tr_b16 v[236:237], v18 offset:0
    v_mfma_f32_16x16x32_bf16 v[180:183], v[220:223], v[108:111], v[180:183]
    ds_read_b64_tr_b16 v[238:239], v18 offset:2048
    s_waitcnt lgkmcnt(8)
    v_mfma_f32_16x16x32_bf16 v[184:187], v[224:227], v[104:107], v[184:187]
    ds_read_b64_tr_b16 v[240:241], v17 offset:4096
    v_mfma_f32_16x16x32_bf16 v[188:191], v[224:227], v[108:111], v[188:191]
    ds_read_b64_tr_b16 v[242:243], v17 offset:6144
    s_waitcnt lgkmcnt(8)
    v_mfma_f32_16x16x32_bf16 v[192:195], v[228:231], v[104:107], v[192:195]
    ds_read_b64_tr_b16 v[244:245], v18 offset:4096
    v_mfma_f32_16x16x32_bf16 v[196:199], v[228:231], v[108:111], v[196:199]
    ds_read_b64_tr_b16 v[246:247], v18 offset:6144
    s_waitcnt vmcnt(5)
    s_barrier
    s_waitcnt lgkmcnt(6)
    v_mfma_f32_16x16x32_bf16 v[168:171], v[232:235], v[112:115], v[168:171]
    ds_read_b128 v[120:123], v5 offset:24576
    ds_read_b128 v[124:127], v5 offset:28672
    v_mfma_f32_16x16x32_bf16 v[172:175], v[232:235], v[116:119], v[172:175]
    ds_read_b64_tr_b16 v[216:217], v17 offset:8192
    ds_read_b64_tr_b16 v[218:219], v17 offset:10240
    s_add_u32 m0, s18, 155648
    s_add_u32 s48, s46, 17408
    buffer_load_dwordx4 v4, s[28:31], s48 offen lds
    s_waitcnt lgkmcnt(8)
    v_mfma_f32_16x16x32_bf16 v[176:179], v[236:239], v[112:115], v[176:179]
    ds_read_b64_tr_b16 v[220:221], v18 offset:8192
    v_mfma_f32_16x16x32_bf16 v[180:183], v[236:239], v[116:119], v[180:183]
    ds_read_b64_tr_b16 v[222:223], v18 offset:10240
    s_add_u32 m0, s18, 65536
    s_add_u32 s48, s36, 147584
    buffer_load_dwordx4 v1, s[20:23], s48 offen lds
    s_waitcnt lgkmcnt(8)
    v_mfma_f32_16x16x32_bf16 v[184:187], v[240:243], v[112:115], v[184:187]
    ds_read_b64_tr_b16 v[224:225], v17 offset:12288
    v_mfma_f32_16x16x32_bf16 v[188:191], v[240:243], v[116:119], v[188:191]
    ds_read_b64_tr_b16 v[226:227], v17 offset:14336
    s_waitcnt lgkmcnt(8)
    v_mfma_f32_16x16x32_bf16 v[192:195], v[244:247], v[112:115], v[192:195]
    ds_read_b64_tr_b16 v[228:229], v18 offset:12288
    v_mfma_f32_16x16x32_bf16 v[196:199], v[244:247], v[116:119], v[196:199]
    ds_read_b64_tr_b16 v[230:231], v18 offset:14336
    s_waitcnt lgkmcnt(6)
    v_mfma_f32_16x16x32_bf16 v[168:171], v[216:219], v[120:123], v[168:171]
    ds_read_b128 v[128:131], v5 offset:32768
    ds_read_b128 v[132:135], v5 offset:36864
    v_mfma_f32_16x16x32_bf16 v[172:175], v[216:219], v[124:127], v[172:175]
    ds_read_b64_tr_b16 v[232:233], v17 offset:16384
    ds_read_b64_tr_b16 v[234:235], v17 offset:18432
    s_add_u32 m0, s18, 73728
    s_add_u32 s48, s36, 295040
    buffer_load_dwordx4 v1, s[20:23], s48 offen lds
    s_waitcnt lgkmcnt(8)
    v_mfma_f32_16x16x32_bf16 v[176:179], v[220:223], v[120:123], v[176:179]
    ds_read_b64_tr_b16 v[236:237], v18 offset:16384
    v_mfma_f32_16x16x32_bf16 v[180:183], v[220:223], v[124:127], v[180:183]
    ds_read_b64_tr_b16 v[238:239], v18 offset:18432
    s_waitcnt lgkmcnt(8)
    v_mfma_f32_16x16x32_bf16 v[184:187], v[224:227], v[120:123], v[184:187]
    ds_read_b64_tr_b16 v[240:241], v17 offset:20480
    v_mfma_f32_16x16x32_bf16 v[188:191], v[224:227], v[124:127], v[188:191]
    ds_read_b64_tr_b16 v[242:243], v17 offset:22528
    s_waitcnt lgkmcnt(8)
    v_mfma_f32_16x16x32_bf16 v[192:195], v[228:231], v[120:123], v[192:195]
    ds_read_b64_tr_b16 v[244:245], v18 offset:20480
    v_mfma_f32_16x16x32_bf16 v[196:199], v[228:231], v[124:127], v[196:199]
    ds_read_b64_tr_b16 v[246:247], v18 offset:22528
    s_waitcnt lgkmcnt(6)
    v_mfma_f32_16x16x32_bf16 v[168:171], v[232:235], v[128:131], v[168:171]
    ds_read_b128 v[136:139], v5 offset:40960
    ds_read_b128 v[140:143], v5 offset:45056
    v_mfma_f32_16x16x32_bf16 v[172:175], v[232:235], v[132:135], v[172:175]
    ds_read_b64_tr_b16 v[216:217], v17 offset:24576
    ds_read_b64_tr_b16 v[218:219], v17 offset:26624
    s_add_u32 m0, s18, 81920
    s_add_u32 s48, s36, 442496
    buffer_load_dwordx4 v1, s[20:23], s48 offen lds
    s_waitcnt lgkmcnt(8)
    v_mfma_f32_16x16x32_bf16 v[176:179], v[236:239], v[128:131], v[176:179]
    ds_read_b64_tr_b16 v[220:221], v18 offset:24576
    v_mfma_f32_16x16x32_bf16 v[180:183], v[236:239], v[132:135], v[180:183]
    ds_read_b64_tr_b16 v[222:223], v18 offset:26624
    s_waitcnt lgkmcnt(8)
    v_mfma_f32_16x16x32_bf16 v[184:187], v[240:243], v[128:131], v[184:187]
    ds_read_b64_tr_b16 v[224:225], v17 offset:28672
    v_mfma_f32_16x16x32_bf16 v[188:191], v[240:243], v[132:135], v[188:191]
    ds_read_b64_tr_b16 v[226:227], v17 offset:30720
    s_waitcnt lgkmcnt(8)
    v_mfma_f32_16x16x32_bf16 v[192:195], v[244:247], v[128:131], v[192:195]
    ds_read_b64_tr_b16 v[228:229], v18 offset:28672
    v_mfma_f32_16x16x32_bf16 v[196:199], v[244:247], v[132:135], v[196:199]
    ds_read_b64_tr_b16 v[230:231], v18 offset:30720
    s_waitcnt vmcnt(3)
    s_barrier
    s_waitcnt lgkmcnt(6)
    v_mfma_f32_16x16x32_bf16 v[168:171], v[216:219], v[136:139], v[168:171]
    ds_read_b128 v[144:147], v5 offset:49152
    ds_read_b128 v[148:151], v5 offset:53248
    v_mfma_f32_16x16x32_bf16 v[172:175], v[216:219], v[140:143], v[172:175]
    ds_read_b64_tr_b16 v[232:233], v17 offset:32768
    ds_read_b64_tr_b16 v[234:235], v17 offset:34816
    s_add_u32 m0, s18, 0
    s_add_u32 s48, s36, 589952
    buffer_load_dwordx4 v1, s[20:23], s48 offen lds
    s_waitcnt lgkmcnt(8)
    v_mfma_f32_16x16x32_bf16 v[176:179], v[220:223], v[136:139], v[176:179]
    ds_read_b64_tr_b16 v[236:237], v18 offset:32768
    v_mfma_f32_16x16x32_bf16 v[180:183], v[220:223], v[140:143], v[180:183]
    ds_read_b64_tr_b16 v[238:239], v18 offset:34816
    s_waitcnt lgkmcnt(8)
    v_mfma_f32_16x16x32_bf16 v[184:187], v[224:227], v[136:139], v[184:187]
    ds_read_b64_tr_b16 v[240:241], v17 offset:36864
    v_mfma_f32_16x16x32_bf16 v[188:191], v[224:227], v[140:143], v[188:191]
    ds_read_b64_tr_b16 v[242:243], v17 offset:38912
    s_waitcnt lgkmcnt(8)
    v_mfma_f32_16x16x32_bf16 v[192:195], v[228:231], v[136:139], v[192:195]
    ds_read_b64_tr_b16 v[244:245], v18 offset:36864
    v_mfma_f32_16x16x32_bf16 v[196:199], v[228:231], v[140:143], v[196:199]
    ds_read_b64_tr_b16 v[246:247], v18 offset:38912
    s_waitcnt lgkmcnt(6)
    v_mfma_f32_16x16x32_bf16 v[168:171], v[232:235], v[144:147], v[168:171]
    ds_read_b128 v[152:155], v5 offset:57344
    ds_read_b128 v[156:159], v5 offset:61440
    v_mfma_f32_16x16x32_bf16 v[172:175], v[232:235], v[148:151], v[172:175]
    ds_read_b64_tr_b16 v[216:217], v17 offset:40960
    ds_read_b64_tr_b16 v[218:219], v17 offset:43008
    s_add_u32 m0, s18, 8192
    s_add_u32 s48, s36, 737408
    buffer_load_dwordx4 v1, s[20:23], s48 offen lds
    s_waitcnt lgkmcnt(8)
    v_mfma_f32_16x16x32_bf16 v[176:179], v[236:239], v[144:147], v[176:179]
    ds_read_b64_tr_b16 v[220:221], v18 offset:40960
    v_mfma_f32_16x16x32_bf16 v[180:183], v[236:239], v[148:151], v[180:183]
    ds_read_b64_tr_b16 v[222:223], v18 offset:43008
    s_waitcnt lgkmcnt(8)
    v_mfma_f32_16x16x32_bf16 v[184:187], v[240:243], v[144:147], v[184:187]
    ds_read_b64_tr_b16 v[224:225], v17 offset:45056
    v_mfma_f32_16x16x32_bf16 v[188:191], v[240:243], v[148:151], v[188:191]
    ds_read_b64_tr_b16 v[226:227], v17 offset:47104
    s_waitcnt lgkmcnt(8)
    v_mfma_f32_16x16x32_bf16 v[192:195], v[244:247], v[144:147], v[192:195]
    ds_read_b64_tr_b16 v[228:229], v18 offset:45056
    v_mfma_f32_16x16x32_bf16 v[196:199], v[244:247], v[148:151], v[196:199]
    ds_read_b64_tr_b16 v[230:231], v18 offset:47104
    s_waitcnt lgkmcnt(6)
    v_mfma_f32_16x16x32_bf16 v[168:171], v[216:219], v[152:155], v[168:171]
    ds_read_b128 v[160:163], v10 offset:0
    ds_read_b128 v[164:167], v10 offset:4096
    v_mfma_f32_16x16x32_bf16 v[172:175], v[216:219], v[156:159], v[172:175]
    ds_read_b64_tr_b16 v[232:233], v19 offset:0
    ds_read_b64_tr_b16 v[234:235], v19 offset:2048
    s_add_u32 m0, s18, 16384
    s_add_u32 s48, s36, 884864
    buffer_load_dwordx4 v1, s[20:23], s48 offen lds
    s_waitcnt lgkmcnt(8)
    v_mfma_f32_16x16x32_bf16 v[176:179], v[220:223], v[152:155], v[176:179]
    ds_read_b64_tr_b16 v[236:237], v20 offset:0
    v_mfma_f32_16x16x32_bf16 v[180:183], v[220:223], v[156:159], v[180:183]
    ds_read_b64_tr_b16 v[238:239], v20 offset:2048
    s_waitcnt lgkmcnt(8)
    v_mfma_f32_16x16x32_bf16 v[184:187], v[224:227], v[152:155], v[184:187]
    ds_read_b64_tr_b16 v[240:241], v19 offset:4096
    v_mfma_f32_16x16x32_bf16 v[188:191], v[224:227], v[156:159], v[188:191]
    ds_read_b64_tr_b16 v[242:243], v19 offset:6144
    s_waitcnt lgkmcnt(8)
    v_mfma_f32_16x16x32_bf16 v[192:195], v[228:231], v[152:155], v[192:195]
    ds_read_b64_tr_b16 v[244:245], v20 offset:4096
    v_mfma_f32_16x16x32_bf16 v[196:199], v[228:231], v[156:159], v[196:199]
    ds_read_b64_tr_b16 v[246:247], v20 offset:6144
    s_waitcnt vmcnt(4)
    s_barrier
    s_waitcnt lgkmcnt(6)
    v_mfma_f32_16x16x32_bf16 v[168:171], v[232:235], v[160:163], v[168:171]
    ds_read_b64_tr_b16 v[216:217], v19 offset:8192
    v_mfma_f32_16x16x32_bf16 v[172:175], v[232:235], v[164:167], v[172:175]
    ds_read_b64_tr_b16 v[218:219], v19 offset:10240
    s_add_u32 m0, s18, 24576
    s_add_u32 s48, s36, 1032320
    buffer_load_dwordx4 v1, s[20:23], s48 offen lds
    s_waitcnt lgkmcnt(6)
    v_mfma_f32_16x16x32_bf16 v[176:179], v[236:239], v[160:163], v[176:179]
    ds_read_b64_tr_b16 v[220:221], v20 offset:8192
    v_mfma_f32_16x16x32_bf16 v[180:183], v[236:239], v[164:167], v[180:183]
    ds_read_b64_tr_b16 v[222:223], v20 offset:10240
    s_waitcnt lgkmcnt(6)
    v_mfma_f32_16x16x32_bf16 v[184:187], v[240:243], v[160:163], v[184:187]
    ds_read_b64_tr_b16 v[224:225], v19 offset:12288
    v_mfma_f32_16x16x32_bf16 v[188:191], v[240:243], v[164:167], v[188:191]
    ds_read_b64_tr_b16 v[226:227], v19 offset:14336
    s_waitcnt lgkmcnt(6)
    v_mfma_f32_16x16x32_bf16 v[192:195], v[244:247], v[160:163], v[192:195]
    ds_read_b64_tr_b16 v[228:229], v20 offset:12288
    v_mfma_f32_16x16x32_bf16 v[196:199], v[244:247], v[164:167], v[196:199]
    ds_read_b64_tr_b16 v[230:231], v20 offset:14336
    v_mul_f32 v168, v168, v184
    v_mul_f32 v169, v169, v185
    v_mul_f32 v170, v170, v186
    v_mul_f32 v171, v171, v187
    v_cvt_pk_bf16_f32 v232, v168, v169
    v_cvt_pk_bf16_f32 v233, v170, v171
    v_mul_f32 v176, v176, v192
    v_mul_f32 v177, v177, v193
    v_mul_f32 v178, v178, v194
    v_mul_f32 v179, v179, v195
    v_cvt_pk_bf16_f32 v234, v176, v177
    v_cvt_pk_bf16_f32 v235, v178, v179
    ds_write_b128 v6, v[232:235] offset:0
    s_add_u32 s49, s88, 0
    buffer_store_dwordx4 v[232:235], v4, s[84:87], s49 offen sc1
    v_mul_f32 v172, v172, v188
    v_mul_f32 v173, v173, v189
    v_mul_f32 v174, v174, v190
    v_mul_f32 v175, v175, v191
    v_cvt_pk_bf16_f32 v236, v172, v173
    v_cvt_pk_bf16_f32 v237, v174, v175
    v_mul_f32 v180, v180, v196
    v_mul_f32 v181, v181, v197
    v_mul_f32 v182, v182, v198
    v_mul_f32 v183, v183, v199
    v_cvt_pk_bf16_f32 v238, v180, v181
    v_cvt_pk_bf16_f32 v239, v182, v183
    ds_write_b128 v6, v[236:239] offset:1024
    s_add_u32 s49, s88, 1024
    buffer_store_dwordx4 v[236:239], v4, s[84:87], s49 offen sc1
    s_waitcnt lgkmcnt(8)
    v_mfma_f32_16x16x32_bf16 v[168:171], v[216:219], v[24:27], 0
    ds_read_b64_tr_b16 v[232:233], v19 offset:16384
    v_mfma_f32_16x16x32_bf16 v[172:175], v[216:219], v[28:31], 0
    ds_read_b64_tr_b16 v[234:235], v19 offset:18432
    s_add_u32 m0, s18, 32768
    s_add_u32 s48, s36, 1179776
    buffer_load_dwordx4 v1, s[20:23], s48 offen lds
    s_waitcnt lgkmcnt(8)
    v_mfma_f32_16x16x32_bf16 v[176:179], v[220:223], v[24:27], 0
    ds_read_b64_tr_b16 v[236:237], v20 offset:16384
    v_mfma_f32_16x16x32_bf16 v[180:183], v[220:223], v[28:31], 0
    ds_read_b64_tr_b16 v[238:239], v20 offset:18432
    s_waitcnt lgkmcnt(8)
    v_mfma_f32_16x16x32_bf16 v[184:187], v[224:227], v[24:27], 0
    ds_read_b64_tr_b16 v[240:241], v19 offset:20480
    v_mfma_f32_16x16x32_bf16 v[188:191], v[224:227], v[28:31], 0
    ds_read_b64_tr_b16 v[242:243], v19 offset:22528
    s_waitcnt lgkmcnt(8)
    v_mfma_f32_16x16x32_bf16 v[192:195], v[228:231], v[24:27], 0
    ds_read_b64_tr_b16 v[244:245], v20 offset:20480
    v_mfma_f32_16x16x32_bf16 v[196:199], v[228:231], v[28:31], 0
    ds_read_b64_tr_b16 v[246:247], v20 offset:22528
    s_waitcnt lgkmcnt(6)
    v_mfma_f32_16x16x32_bf16 v[168:171], v[232:235], v[32:35], v[168:171]
    ds_read_b64_tr_b16 v[216:217], v19 offset:24576
    v_mfma_f32_16x16x32_bf16 v[172:175], v[232:235], v[36:39], v[172:175]
    ds_read_b64_tr_b16 v[218:219], v19 offset:26624
    s_add_u32 m0, s18, 40960
    s_add_u32 s48, s36, 1327232
    buffer_load_dwordx4 v1, s[20:23], s48 offen lds
    s_waitcnt lgkmcnt(6)
    v_mfma_f32_16x16x32_bf16 v[176:179], v[236:239], v[32:35], v[176:179]
    ds_read_b64_tr_b16 v[220:221], v20 offset:24576
    v_mfma_f32_16x16x32_bf16 v[180:183], v[236:239], v[36:39], v[180:183]
    ds_read_b64_tr_b16 v[222:223], v20 offset:26624
    s_waitcnt lgkmcnt(6)
    v_mfma_f32_16x16x32_bf16 v[184:187], v[240:243], v[32:35], v[184:187]
    ds_read_b64_tr_b16 v[224:225], v19 offset:28672
    v_mfma_f32_16x16x32_bf16 v[188:191], v[240:243], v[36:39], v[188:191]
    ds_read_b64_tr_b16 v[226:227], v19 offset:30720
    s_waitcnt lgkmcnt(6)
    v_mfma_f32_16x16x32_bf16 v[192:195], v[244:247], v[32:35], v[192:195]
    ds_read_b64_tr_b16 v[228:229], v20 offset:28672
    v_mfma_f32_16x16x32_bf16 v[196:199], v[244:247], v[36:39], v[196:199]
    ds_read_b64_tr_b16 v[230:231], v20 offset:30720
    s_waitcnt vmcnt(6)
    s_barrier
    s_waitcnt lgkmcnt(6)
    v_mfma_f32_16x16x32_bf16 v[168:171], v[216:219], v[40:43], v[168:171]
    ds_read_b64_tr_b16 v[232:233], v19 offset:32768
    v_mfma_f32_16x16x32_bf16 v[172:175], v[216:219], v[44:47], v[172:175]
    ds_read_b64_tr_b16 v[234:235], v19 offset:34816
    s_add_u32 m0, s18, 49152
    s_add_u32 s48, s36, 1474688
    buffer_load_dwordx4 v1, s[20:23], s48 offen lds
    s_waitcnt lgkmcnt(6)
    v_mfma_f32_16x16x32_bf16 v[176:179], v[220:223], v[40:43], v[176:179]
    ds_read_b64_tr_b16 v[236:237], v20 offset:32768
    v_mfma_f32_16x16x32_bf16 v[180:183], v[220:223], v[44:47], v[180:183]
    ds_read_b64_tr_b16 v[238:239], v20 offset:34816
    s_waitcnt lgkmcnt(6)
    v_mfma_f32_16x16x32_bf16 v[184:187], v[224:227], v[40:43], v[184:187]
    ds_read_b64_tr_b16 v[240:241], v19 offset:36864
    v_mfma_f32_16x16x32_bf16 v[188:191], v[224:227], v[44:47], v[188:191]
    ds_read_b64_tr_b16 v[242:243], v19 offset:38912
    s_waitcnt lgkmcnt(6)
    v_mfma_f32_16x16x32_bf16 v[192:195], v[228:231], v[40:43], v[192:195]
    ds_read_b64_tr_b16 v[244:245], v20 offset:36864
    v_mfma_f32_16x16x32_bf16 v[196:199], v[228:231], v[44:47], v[196:199]
    ds_read_b64_tr_b16 v[246:247], v20 offset:38912
    s_waitcnt lgkmcnt(6)
    v_mfma_f32_16x16x32_bf16 v[168:171], v[232:235], v[48:51], v[168:171]
    ds_read_b64_tr_b16 v[216:217], v17 offset:0
    v_mfma_f32_16x16x32_bf16 v[172:175], v[232:235], v[52:55], v[172:175]
    ds_read_b64_tr_b16 v[218:219], v17 offset:2048
    s_add_u32 m0, s18, 57344
    s_add_u32 s48, s36, 1622144
    buffer_load_dwordx4 v1, s[20:23], s48 offen lds
    s_waitcnt lgkmcnt(6)
    v_mfma_f32_16x16x32_bf16 v[176:179], v[236:239], v[48:51], v[176:179]
    ds_read_b64_tr_b16 v[220:221], v18 offset:0
    v_mfma_f32_16x16x32_bf16 v[180:183], v[236:239], v[52:55], v[180:183]
    ds_read_b64_tr_b16 v[222:223], v18 offset:2048
    s_waitcnt lgkmcnt(6)
    v_mfma_f32_16x16x32_bf16 v[184:187], v[240:243], v[48:51], v[184:187]
    ds_read_b64_tr_b16 v[224:225], v17 offset:4096
    v_mfma_f32_16x16x32_bf16 v[188:191], v[240:243], v[52:55], v[188:191]
    ds_read_b64_tr_b16 v[226:227], v17 offset:6144
    s_waitcnt lgkmcnt(6)
    v_mfma_f32_16x16x32_bf16 v[192:195], v[244:247], v[48:51], v[192:195]
    ds_read_b64_tr_b16 v[228:229], v18 offset:4096
    v_mfma_f32_16x16x32_bf16 v[196:199], v[244:247], v[52:55], v[196:199]
    ds_read_b64_tr_b16 v[230:231], v18 offset:6144
    s_waitcnt lgkmcnt(6)
    v_mfma_f32_16x16x32_bf16 v[168:171], v[216:219], v[56:59], v[168:171]
    ds_read_b64_tr_b16 v[232:233], v17 offset:8192
    v_mfma_f32_16x16x32_bf16 v[172:175], v[216:219], v[60:63], v[172:175]
    ds_read_b64_tr_b16 v[234:235], v17 offset:10240
    s_add_u32 m0, s18, 65536
    s_add_u32 s48, s36, 1769600
    buffer_load_dwordx4 v1, s[20:23], s48 offen lds
    s_waitcnt lgkmcnt(6)
    v_mfma_f32_16x16x32_bf16 v[176:179], v[220:223], v[56:59], v[176:179]
    ds_read_b64_tr_b16 v[236:237], v18 offset:8192
    v_mfma_f32_16x16x32_bf16 v[180:183], v[220:223], v[60:63], v[180:183]
    ds_read_b64_tr_b16 v[238:239], v18 offset:10240
    s_waitcnt lgkmcnt(6)
    v_mfma_f32_16x16x32_bf16 v[184:187], v[224:227], v[56:59], v[184:187]
    ds_read_b64_tr_b16 v[240:241], v17 offset:12288
    v_mfma_f32_16x16x32_bf16 v[188:191], v[224:227], v[60:63], v[188:191]
    ds_read_b64_tr_b16 v[242:243], v17 offset:14336
    s_waitcnt lgkmcnt(6)
    v_mfma_f32_16x16x32_bf16 v[192:195], v[228:231], v[56:59], v[192:195]
    ds_read_b64_tr_b16 v[244:245], v18 offset:12288
    v_mfma_f32_16x16x32_bf16 v[196:199], v[228:231], v[60:63], v[196:199]
    ds_read_b64_tr_b16 v[246:247], v18 offset:14336
    s_waitcnt vmcnt(4)
    s_barrier
    s_waitcnt lgkmcnt(6)
    v_mfma_f32_16x16x32_bf16 v[168:171], v[232:235], v[64:67], v[168:171]
    ds_read_b64_tr_b16 v[216:217], v17 offset:16384
    v_mfma_f32_16x16x32_bf16 v[172:175], v[232:235], v[68:71], v[172:175]
    ds_read_b64_tr_b16 v[218:219], v17 offset:18432
    s_add_u32 m0, s18, 73728
    s_add_u32 s48, s36, 1917056
    buffer_load_dwordx4 v1, s[20:23], s48 offen lds
    s_waitcnt lgkmcnt(6)
    v_mfma_f32_16x16x32_bf16 v[176:179], v[236:239], v[64:67], v[176:179]
    ds_read_b64_tr_b16 v[220:221], v18 offset:16384
    v_mfma_f32_16x16x32_bf16 v[180:183], v[236:239], v[68:71], v[180:183]
    ds_read_b64_tr_b16 v[222:223], v18 offset:18432
    s_waitcnt lgkmcnt(6)
    v_mfma_f32_16x16x32_bf16 v[184:187], v[240:243], v[64:67], v[184:187]
    ds_read_b64_tr_b16 v[224:225], v17 offset:20480
    v_mfma_f32_16x16x32_bf16 v[188:191], v[240:243], v[68:71], v[188:191]
    ds_read_b64_tr_b16 v[226:227], v17 offset:22528
    s_waitcnt lgkmcnt(6)
    v_mfma_f32_16x16x32_bf16 v[192:195], v[244:247], v[64:67], v[192:195]
    ds_read_b64_tr_b16 v[228:229], v18 offset:20480
    v_mfma_f32_16x16x32_bf16 v[196:199], v[244:247], v[68:71], v[196:199]
    ds_read_b64_tr_b16 v[230:231], v18 offset:22528
    s_waitcnt lgkmcnt(6)
    v_mfma_f32_16x16x32_bf16 v[168:171], v[216:219], v[72:75], v[168:171]
    ds_read_b64_tr_b16 v[232:233], v17 offset:24576
    v_mfma_f32_16x16x32_bf16 v[172:175], v[216:219], v[76:79], v[172:175]
    ds_read_b64_tr_b16 v[234:235], v17 offset:26624
    s_add_u32 m0, s18, 81920
    s_add_u32 s48, s36, 2064512
    buffer_load_dwordx4 v1, s[20:23], s48 offen lds
    s_waitcnt lgkmcnt(6)
    v_mfma_f32_16x16x32_bf16 v[176:179], v[220:223], v[72:75], v[176:179]
    ds_read_b64_tr_b16 v[236:237], v18 offset:24576
    v_mfma_f32_16x16x32_bf16 v[180:183], v[220:223], v[76:79], v[180:183]
    ds_read_b64_tr_b16 v[238:239], v18 offset:26624
    v_mov_b32 v200, -1
    v_mov_b32 v201, -1
    v_mov_b32 v202, -1
    v_mov_b32 v203, -1
    s_add_u32 s49, s47, 6144
    buffer_store_dwordx4 v[200:203], v4, s[32:35], s49 offen sc1
    s_waitcnt lgkmcnt(6)
    v_mfma_f32_16x16x32_bf16 v[184:187], v[224:227], v[72:75], v[184:187]
    ds_read_b64_tr_b16 v[240:241], v17 offset:28672
    v_mfma_f32_16x16x32_bf16 v[188:191], v[224:227], v[76:79], v[188:191]
    ds_read_b64_tr_b16 v[242:243], v17 offset:30720
    s_waitcnt lgkmcnt(6)
    v_mfma_f32_16x16x32_bf16 v[192:195], v[228:231], v[72:75], v[192:195]
    ds_read_b64_tr_b16 v[244:245], v18 offset:28672
    v_mfma_f32_16x16x32_bf16 v[196:199], v[228:231], v[76:79], v[196:199]
    ds_read_b64_tr_b16 v[246:247], v18 offset:30720
    s_waitcnt lgkmcnt(6)
    v_mfma_f32_16x16x32_bf16 v[168:171], v[232:235], v[80:83], v[168:171]
    ds_read_b64_tr_b16 v[216:217], v17 offset:32768
    v_mfma_f32_16x16x32_bf16 v[172:175], v[232:235], v[84:87], v[172:175]
    ds_read_b64_tr_b16 v[218:219], v17 offset:34816
    s_add_u32 m0, s18, 0
    s_add_u32 s48, s36, 2211968
    buffer_load_dwordx4 v1, s[20:23], s48 offen lds
    s_waitcnt lgkmcnt(6)
    v_mfma_f32_16x16x32_bf16 v[176:179], v[236:239], v[80:83], v[176:179]
    ds_read_b64_tr_b16 v[220:221], v18 offset:32768
    v_mfma_f32_16x16x32_bf16 v[180:183], v[236:239], v[84:87], v[180:183]
    ds_read_b64_tr_b16 v[222:223], v18 offset:34816
    s_waitcnt lgkmcnt(6)
    v_mfma_f32_16x16x32_bf16 v[184:187], v[240:243], v[80:83], v[184:187]
    ds_read_b64_tr_b16 v[224:225], v17 offset:36864
    v_mfma_f32_16x16x32_bf16 v[188:191], v[240:243], v[84:87], v[188:191]
    ds_read_b64_tr_b16 v[226:227], v17 offset:38912
    s_waitcnt lgkmcnt(6)
    v_mfma_f32_16x16x32_bf16 v[192:195], v[244:247], v[80:83], v[192:195]
    ds_read_b64_tr_b16 v[228:229], v18 offset:36864
    v_mfma_f32_16x16x32_bf16 v[196:199], v[244:247], v[84:87], v[196:199]
    ds_read_b64_tr_b16 v[230:231], v18 offset:38912
    s_waitcnt vmcnt(5)
    s_barrier
    s_waitcnt lgkmcnt(6)
    v_mfma_f32_16x16x32_bf16 v[168:171], v[216:219], v[88:91], v[168:171]
    ds_read_b64_tr_b16 v[232:233], v17 offset:40960
    v_mfma_f32_16x16x32_bf16 v[172:175], v[216:219], v[92:95], v[172:175]
    ds_read_b64_tr_b16 v[234:235], v17 offset:43008
    s_add_u32 m0, s18, 8192
    s_add_u32 s48, s36, 2359424
    buffer_load_dwordx4 v1, s[20:23], s48 offen lds
    s_waitcnt lgkmcnt(6)
    v_mfma_f32_16x16x32_bf16 v[176:179], v[220:223], v[88:91], v[176:179]
    ds_read_b64_tr_b16 v[236:237], v18 offset:40960
    v_mfma_f32_16x16x32_bf16 v[180:183], v[220:223], v[92:95], v[180:183]
    ds_read_b64_tr_b16 v[238:239], v18 offset:43008
    s_waitcnt lgkmcnt(6)
    v_mfma_f32_16x16x32_bf16 v[184:187], v[224:227], v[88:91], v[184:187]
    ds_read_b64_tr_b16 v[240:241], v17 offset:45056
    v_mfma_f32_16x16x32_bf16 v[188:191], v[224:227], v[92:95], v[188:191]
    ds_read_b64_tr_b16 v[242:243], v17 offset:47104
    s_waitcnt lgkmcnt(6)
    v_mfma_f32_16x16x32_bf16 v[192:195], v[228:231], v[88:91], v[192:195]
    ds_read_b64_tr_b16 v[244:245], v18 offset:45056
    v_mfma_f32_16x16x32_bf16 v[196:199], v[228:231], v[92:95], v[196:199]
    ds_read_b64_tr_b16 v[246:247], v18 offset:47104
    s_waitcnt lgkmcnt(6)
    v_mfma_f32_16x16x32_bf16 v[168:171], v[232:235], v[96:99], v[168:171]
    ds_read_b64_tr_b16 v[216:217], v19 offset:0
    v_mfma_f32_16x16x32_bf16 v[172:175], v[232:235], v[100:103], v[172:175]
    ds_read_b64_tr_b16 v[218:219], v19 offset:2048
    s_add_u32 m0, s18, 16384
    s_add_u32 s48, s36, 2506880
    buffer_load_dwordx4 v1, s[20:23], s48 offen lds
    s_waitcnt lgkmcnt(6)
    v_mfma_f32_16x16x32_bf16 v[176:179], v[236:239], v[96:99], v[176:179]
    ds_read_b64_tr_b16 v[220:221], v20 offset:0
    v_mfma_f32_16x16x32_bf16 v[180:183], v[236:239], v[100:103], v[180:183]
    ds_read_b64_tr_b16 v[222:223], v20 offset:2048
    s_waitcnt lgkmcnt(6)
    v_mfma_f32_16x16x32_bf16 v[184:187], v[240:243], v[96:99], v[184:187]
    ds_read_b64_tr_b16 v[224:225], v19 offset:4096
    v_mfma_f32_16x16x32_bf16 v[188:191], v[240:243], v[100:103], v[188:191]
    ds_read_b64_tr_b16 v[226:227], v19 offset:6144
    s_waitcnt lgkmcnt(6)
    v_mfma_f32_16x16x32_bf16 v[192:195], v[244:247], v[96:99], v[192:195]
    ds_read_b64_tr_b16 v[228:229], v20 offset:4096
    v_mfma_f32_16x16x32_bf16 v[196:199], v[244:247], v[100:103], v[196:199]
    ds_read_b64_tr_b16 v[230:231], v20 offset:6144
    s_waitcnt lgkmcnt(6)
    v_mfma_f32_16x16x32_bf16 v[168:171], v[216:219], v[104:107], v[168:171]
    ds_read_b64_tr_b16 v[232:233], v19 offset:8192
    v_mfma_f32_16x16x32_bf16 v[172:175], v[216:219], v[108:111], v[172:175]
    ds_read_b64_tr_b16 v[234:235], v19 offset:10240
    s_add_u32 m0, s18, 24576
    s_add_u32 s48, s36, 256
    buffer_load_dwordx4 v1, s[20:23], s48 offen lds
    s_waitcnt lgkmcnt(6)
    v_mfma_f32_16x16x32_bf16 v[176:179], v[220:223], v[104:107], v[176:179]
    ds_read_b64_tr_b16 v[236:237], v20 offset:8192
    v_mfma_f32_16x16x32_bf16 v[180:183], v[220:223], v[108:111], v[180:183]
    ds_read_b64_tr_b16 v[238:239], v20 offset:10240
    s_waitcnt lgkmcnt(6)
    v_mfma_f32_16x16x32_bf16 v[184:187], v[224:227], v[104:107], v[184:187]
    ds_read_b64_tr_b16 v[240:241], v19 offset:12288
    v_mfma_f32_16x16x32_bf16 v[188:191], v[224:227], v[108:111], v[188:191]
    ds_read_b64_tr_b16 v[242:243], v19 offset:14336
    s_waitcnt lgkmcnt(6)
    v_mfma_f32_16x16x32_bf16 v[192:195], v[228:231], v[104:107], v[192:195]
    ds_read_b64_tr_b16 v[244:245], v20 offset:12288
    v_mfma_f32_16x16x32_bf16 v[196:199], v[228:231], v[108:111], v[196:199]
    ds_read_b64_tr_b16 v[246:247], v20 offset:14336
    s_waitcnt vmcnt(5)
    s_barrier
    s_add_u32 s28, s62, 32768
    s_addc_u32 s29, s63, 0
    s_mov_b32 s30, 32768
    s_mov_b32 s31, 0x20000
    s_lshl_b32 s57, s14, 11
    s_lshl_b32 s56, s12, 7
    s_add_u32 s56, s56, s57
    v_cmp_eq_u32 vcc, 0x1c0, v0
    s_nop 1
    v_cndmask_b32 v14, 2.0, v4, vcc
    v_and_b32 v15, 0x70, v4
    v_lshlrev_b32 v15, 4, v15
    s_xor_b32 s19, s56, 128
    s_lshl_b32 s42, s13, 7
    s_add_u32 s57, s57, s42
    s_waitcnt lgkmcnt(6)
    v_mfma_f32_16x16x32_bf16 v[168:171], v[232:235], v[112:115], v[168:171]
    ds_read_b64_tr_b16 v[216:217], v19 offset:16384
    v_mfma_f32_16x16x32_bf16 v[172:175], v[232:235], v[116:119], v[172:175]
    ds_read_b64_tr_b16 v[218:219], v19 offset:18432
    s_add_u32 m0, s18, 32768
    s_add_u32 s48, s36, 147712
    buffer_load_dwordx4 v1, s[20:23], s48 offen lds
    s_waitcnt lgkmcnt(6)
    v_mfma_f32_16x16x32_bf16 v[176:179], v[236:239], v[112:115], v[176:179]
    ds_read_b64_tr_b16 v[220:221], v20 offset:16384
    v_mfma_f32_16x16x32_bf16 v[180:183], v[236:239], v[116:119], v[180:183]
    ds_read_b64_tr_b16 v[222:223], v20 offset:18432
    s_waitcnt lgkmcnt(6)
    v_mfma_f32_16x16x32_bf16 v[184:187], v[240:243], v[112:115], v[184:187]
    ds_read_b64_tr_b16 v[224:225], v19 offset:20480
    v_mfma_f32_16x16x32_bf16 v[188:191], v[240:243], v[116:119], v[188:191]
    ds_read_b64_tr_b16 v[226:227], v19 offset:22528
    s_waitcnt lgkmcnt(6)
    v_mfma_f32_16x16x32_bf16 v[192:195], v[244:247], v[112:115], v[192:195]
    ds_read_b64_tr_b16 v[228:229], v20 offset:20480
    v_mfma_f32_16x16x32_bf16 v[196:199], v[244:247], v[116:119], v[196:199]
    ds_read_b64_tr_b16 v[230:231], v20 offset:22528
    s_waitcnt lgkmcnt(6)
    v_mfma_f32_16x16x32_bf16 v[168:171], v[216:219], v[120:123], v[168:171]
    ds_read_b64_tr_b16 v[232:233], v19 offset:24576
    v_mfma_f32_16x16x32_bf16 v[172:175], v[216:219], v[124:127], v[172:175]
    ds_read_b64_tr_b16 v[234:235], v19 offset:26624
    s_add_u32 m0, s18, 40960
    s_add_u32 s48, s36, 295168
    buffer_load_dwordx4 v1, s[20:23], s48 offen lds
    s_waitcnt lgkmcnt(6)
    v_mfma_f32_16x16x32_bf16 v[176:179], v[220:223], v[120:123], v[176:179]
    ds_read_b64_tr_b16 v[236:237], v20 offset:24576
    v_mfma_f32_16x16x32_bf16 v[180:183], v[220:223], v[124:127], v[180:183]
    ds_read_b64_tr_b16 v[238:239], v20 offset:26624
    buffer_load_dword v13, v12, s[24:27], s59 offen
    s_waitcnt lgkmcnt(6)
    v_mfma_f32_16x16x32_bf16 v[184:187], v[224:227], v[120:123], v[184:187]
    ds_read_b64_tr_b16 v[240:241], v19 offset:28672
    v_mfma_f32_16x16x32_bf16 v[188:191], v[224:227], v[124:127], v[188:191]
    ds_read_b64_tr_b16 v[242:243], v19 offset:30720
    s_waitcnt lgkmcnt(6)
    v_mfma_f32_16x16x32_bf16 v[192:195], v[228:231], v[120:123], v[192:195]
    ds_read_b64_tr_b16 v[244:245], v20 offset:28672
    v_mfma_f32_16x16x32_bf16 v[196:199], v[228:231], v[124:127], v[196:199]
    ds_read_b64_tr_b16 v[246:247], v20 offset:30720
    s_waitcnt lgkmcnt(6)
    v_mfma_f32_16x16x32_bf16 v[168:171], v[232:235], v[128:131], v[168:171]
    ds_read_b64_tr_b16 v[216:217], v19 offset:32768
    v_mfma_f32_16x16x32_bf16 v[172:175], v[232:235], v[132:135], v[172:175]
    ds_read_b64_tr_b16 v[218:219], v19 offset:34816
    s_add_u32 m0, s18, 49152
    s_add_u32 s48, s36, 442624
    buffer_load_dwordx4 v1, s[20:23], s48 offen lds
    s_waitcnt lgkmcnt(6)
    v_mfma_f32_16x16x32_bf16 v[176:179], v[236:239], v[128:131], v[176:179]
    ds_read_b64_tr_b16 v[220:221], v20 offset:32768
    v_mfma_f32_16x16x32_bf16 v[180:183], v[236:239], v[132:135], v[180:183]
    ds_read_b64_tr_b16 v[222:223], v20 offset:34816
    s_waitcnt lgkmcnt(6)
    v_mfma_f32_16x16x32_bf16 v[184:187], v[240:243], v[128:131], v[184:187]
    ds_read_b64_tr_b16 v[224:225], v19 offset:36864
    v_mfma_f32_16x16x32_bf16 v[188:191], v[240:243], v[132:135], v[188:191]
    ds_read_b64_tr_b16 v[226:227], v19 offset:38912
    s_waitcnt lgkmcnt(6)
    v_mfma_f32_16x16x32_bf16 v[192:195], v[244:247], v[128:131], v[192:195]
    ds_read_b64_tr_b16 v[228:229], v20 offset:36864
    v_mfma_f32_16x16x32_bf16 v[196:199], v[244:247], v[132:135], v[196:199]
    ds_read_b64_tr_b16 v[230:231], v20 offset:38912
    s_waitcnt vmcnt(5)
    s_barrier
    s_waitcnt lgkmcnt(6)
    v_mfma_f32_16x16x32_bf16 v[168:171], v[216:219], v[136:139], v[168:171]
    ds_read_b64_tr_b16 v[232:233], v17 offset:0
    v_mfma_f32_16x16x32_bf16 v[172:175], v[216:219], v[140:143], v[172:175]
    ds_read_b64_tr_b16 v[234:235], v17 offset:2048
    s_add_u32 m0, s18, 57344
    s_add_u32 s48, s36, 590080
    buffer_load_dwordx4 v1, s[20:23], s48 offen lds
    s_waitcnt lgkmcnt(6)
    v_mfma_f32_16x16x32_bf16 v[176:179], v[220:223], v[136:139], v[176:179]
    ds_read_b64_tr_b16 v[236:237], v18 offset:0
    v_mfma_f32_16x16x32_bf16 v[180:183], v[220:223], v[140:143], v[180:183]
    ds_read_b64_tr_b16 v[238:239], v18 offset:2048
    s_waitcnt lgkmcnt(6)
    v_mfma_f32_16x16x32_bf16 v[184:187], v[224:227], v[136:139], v[184:187]
    ds_read_b64_tr_b16 v[240:241], v17 offset:4096
    v_mfma_f32_16x16x32_bf16 v[188:191], v[224:227], v[140:143], v[188:191]
    ds_read_b64_tr_b16 v[242:243], v17 offset:6144
    s_waitcnt lgkmcnt(6)
    v_mfma_f32_16x16x32_bf16 v[192:195], v[228:231], v[136:139], v[192:195]
    ds_read_b64_tr_b16 v[244:245], v18 offset:4096
    v_mfma_f32_16x16x32_bf16 v[196:199], v[228:231], v[140:143], v[196:199]
    ds_read_b64_tr_b16 v[246:247], v18 offset:6144
    s_waitcnt lgkmcnt(6)
    v_mfma_f32_16x16x32_bf16 v[168:171], v[232:235], v[144:147], v[168:171]
    ds_read_b64_tr_b16 v[216:217], v17 offset:8192
    v_mfma_f32_16x16x32_bf16 v[172:175], v[232:235], v[148:151], v[172:175]
    ds_read_b64_tr_b16 v[218:219], v17 offset:10240
    s_add_u32 m0, s18, 65536
    s_add_u32 s48, s36, 737536
    buffer_load_dwordx4 v1, s[20:23], s48 offen lds
    s_waitcnt lgkmcnt(6)
    v_mfma_f32_16x16x32_bf16 v[176:179], v[236:239], v[144:147], v[176:179]
    ds_read_b64_tr_b16 v[220:221], v18 offset:8192
    v_mfma_f32_16x16x32_bf16 v[180:183], v[236:239], v[148:151], v[180:183]
    ds_read_b64_tr_b16 v[222:223], v18 offset:10240
    s_waitcnt lgkmcnt(6)
    v_mfma_f32_16x16x32_bf16 v[184:187], v[240:243], v[144:147], v[184:187]
    ds_read_b64_tr_b16 v[224:225], v17 offset:12288
    v_mfma_f32_16x16x32_bf16 v[188:191], v[240:243], v[148:151], v[188:191]
    ds_read_b64_tr_b16 v[226:227], v17 offset:14336
    s_waitcnt lgkmcnt(6)
    v_mfma_f32_16x16x32_bf16 v[192:195], v[244:247], v[144:147], v[192:195]
    ds_read_b64_tr_b16 v[228:229], v18 offset:12288
    v_mfma_f32_16x16x32_bf16 v[196:199], v[244:247], v[148:151], v[196:199]
    ds_read_b64_tr_b16 v[230:231], v18 offset:14336
    s_waitcnt lgkmcnt(6)
    v_mfma_f32_16x16x32_bf16 v[168:171], v[216:219], v[152:155], v[168:171]
    ds_read_b64_tr_b16 v[232:233], v17 offset:16384
    v_mfma_f32_16x16x32_bf16 v[172:175], v[216:219], v[156:159], v[172:175]
    ds_read_b64_tr_b16 v[234:235], v17 offset:18432
    s_add_u32 m0, s18, 73728
    s_add_u32 s48, s36, 884992
    buffer_load_dwordx4 v1, s[20:23], s48 offen lds
    s_waitcnt lgkmcnt(6)
    v_mfma_f32_16x16x32_bf16 v[176:179], v[220:223], v[152:155], v[176:179]
    ds_read_b64_tr_b16 v[236:237], v18 offset:16384
    v_mfma_f32_16x16x32_bf16 v[180:183], v[220:223], v[156:159], v[180:183]
    ds_read_b64_tr_b16 v[238:239], v18 offset:18432
    s_waitcnt lgkmcnt(6)
    v_mfma_f32_16x16x32_bf16 v[184:187], v[224:227], v[152:155], v[184:187]
    ds_read_b64_tr_b16 v[240:241], v17 offset:20480
    v_mfma_f32_16x16x32_bf16 v[188:191], v[224:227], v[156:159], v[188:191]
    ds_read_b64_tr_b16 v[242:243], v17 offset:22528
    s_waitcnt lgkmcnt(6)
    v_mfma_f32_16x16x32_bf16 v[192:195], v[228:231], v[152:155], v[192:195]
    ds_read_b64_tr_b16 v[244:245], v18 offset:20480
    v_mfma_f32_16x16x32_bf16 v[196:199], v[228:231], v[156:159], v[196:199]
    ds_read_b64_tr_b16 v[246:247], v18 offset:22528
    s_waitcnt vmcnt(5)
    s_barrier
    s_waitcnt lgkmcnt(6)
    v_mfma_f32_16x16x32_bf16 v[168:171], v[232:235], v[160:163], v[168:171]
    ds_read_b64_tr_b16 v[216:217], v17 offset:24576
    v_mfma_f32_16x16x32_bf16 v[172:175], v[232:235], v[164:167], v[172:175]
    ds_read_b64_tr_b16 v[218:219], v17 offset:26624
    s_add_u32 m0, s18, 81920
    s_add_u32 s48, s36, 1032448
    buffer_load_dwordx4 v1, s[20:23], s48 offen lds
    s_waitcnt lgkmcnt(6)
    v_mfma_f32_16x16x32_bf16 v[176:179], v[236:239], v[160:163], v[176:179]
    ds_read_b64_tr_b16 v[220:221], v18 offset:24576
    v_mfma_f32_16x16x32_bf16 v[180:183], v[236:239], v[164:167], v[180:183]
    ds_read_b64_tr_b16 v[222:223], v18 offset:26624
    s_waitcnt lgkmcnt(6)
    v_mfma_f32_16x16x32_bf16 v[184:187], v[240:243], v[160:163], v[184:187]
    ds_read_b64_tr_b16 v[224:225], v17 offset:28672
    v_mfma_f32_16x16x32_bf16 v[188:191], v[240:243], v[164:167], v[188:191]
    ds_read_b64_tr_b16 v[226:227], v17 offset:30720
    s_waitcnt lgkmcnt(6)
    v_mfma_f32_16x16x32_bf16 v[192:195], v[244:247], v[160:163], v[192:195]
    ds_read_b64_tr_b16 v[228:229], v18 offset:28672
    v_mfma_f32_16x16x32_bf16 v[196:199], v[244:247], v[164:167], v[196:199]
    ds_read_b64_tr_b16 v[230:231], v18 offset:30720
    v_mul_f32 v168, v168, v184
    v_mul_f32 v169, v169, v185
    v_mul_f32 v170, v170, v186
    v_mul_f32 v171, v171, v187
    v_cvt_pk_bf16_f32 v232, v168, v169
    v_cvt_pk_bf16_f32 v233, v170, v171
    v_mul_f32 v176, v176, v192
    v_mul_f32 v177, v177, v193
    v_mul_f32 v178, v178, v194
    v_mul_f32 v179, v179, v195
    v_cvt_pk_bf16_f32 v234, v176, v177
    v_cvt_pk_bf16_f32 v235, v178, v179
    ds_write_b128 v6, v[232:235] offset:16384
    s_add_u32 s49, s88, 16384
    buffer_store_dwordx4 v[232:235], v4, s[84:87], s49 offen sc1
    v_mul_f32 v172, v172, v188
    v_mul_f32 v173, v173, v189
    v_mul_f32 v174, v174, v190
    v_mul_f32 v175, v175, v191
    v_cvt_pk_bf16_f32 v236, v172, v173
    v_cvt_pk_bf16_f32 v237, v174, v175
    v_mul_f32 v180, v180, v196
    v_mul_f32 v181, v181, v197
    v_mul_f32 v182, v182, v198
    v_mul_f32 v183, v183, v199
    v_cvt_pk_bf16_f32 v238, v180, v181
    v_cvt_pk_bf16_f32 v239, v182, v183
    ds_write_b128 v6, v[236:239] offset:17408
    s_add_u32 s49, s88, 17408
    buffer_store_dwordx4 v[236:239], v4, s[84:87], s49 offen sc1
    s_waitcnt lgkmcnt(8)
    v_mfma_f32_16x16x32_bf16 v[168:171], v[216:219], v[24:27], 0
    ds_read_b64_tr_b16 v[232:233], v17 offset:32768
    v_mfma_f32_16x16x32_bf16 v[172:175], v[216:219], v[28:31], 0
    ds_read_b64_tr_b16 v[234:235], v17 offset:34816
    s_add_u32 m0, s18, 0
    s_add_u32 s48, s36, 1179904
    buffer_load_dwordx4 v1, s[20:23], s48 offen lds
    s_waitcnt lgkmcnt(8)
    v_mfma_f32_16x16x32_bf16 v[176:179], v[220:223], v[24:27], 0
    ds_read_b64_tr_b16 v[236:237], v18 offset:32768
    v_mfma_f32_16x16x32_bf16 v[180:183], v[220:223], v[28:31], 0
    ds_read_b64_tr_b16 v[238:239], v18 offset:34816
    s_waitcnt lgkmcnt(8)
    v_mfma_f32_16x16x32_bf16 v[184:187], v[224:227], v[24:27], 0
    ds_read_b64_tr_b16 v[240:241], v17 offset:36864
    v_mfma_f32_16x16x32_bf16 v[188:191], v[224:227], v[28:31], 0
    ds_read_b64_tr_b16 v[242:243], v17 offset:38912
    s_waitcnt lgkmcnt(8)
    v_mfma_f32_16x16x32_bf16 v[192:195], v[228:231], v[24:27], 0
    ds_read_b64_tr_b16 v[244:245], v18 offset:36864
    v_mfma_f32_16x16x32_bf16 v[196:199], v[228:231], v[28:31], 0
    ds_read_b64_tr_b16 v[246:247], v18 offset:38912
    s_waitcnt lgkmcnt(6)
    v_mfma_f32_16x16x32_bf16 v[168:171], v[232:235], v[32:35], v[168:171]
    ds_read_b64_tr_b16 v[216:217], v17 offset:40960
    v_mfma_f32_16x16x32_bf16 v[172:175], v[232:235], v[36:39], v[172:175]
    ds_read_b64_tr_b16 v[218:219], v17 offset:43008
    s_add_u32 m0, s18, 8192
    s_add_u32 s48, s36, 1327360
    buffer_load_dwordx4 v1, s[20:23], s48 offen lds
    s_waitcnt lgkmcnt(6)
    v_mfma_f32_16x16x32_bf16 v[176:179], v[236:239], v[32:35], v[176:179]
    ds_read_b64_tr_b16 v[220:221], v18 offset:40960
    v_mfma_f32_16x16x32_bf16 v[180:183], v[236:239], v[36:39], v[180:183]
    ds_read_b64_tr_b16 v[222:223], v18 offset:43008
    s_waitcnt lgkmcnt(6)
    v_mfma_f32_16x16x32_bf16 v[184:187], v[240:243], v[32:35], v[184:187]
    ds_read_b64_tr_b16 v[224:225], v17 offset:45056
    v_mfma_f32_16x16x32_bf16 v[188:191], v[240:243], v[36:39], v[188:191]
    ds_read_b64_tr_b16 v[226:227], v17 offset:47104
    s_waitcnt lgkmcnt(6)
    v_mfma_f32_16x16x32_bf16 v[192:195], v[244:247], v[32:35], v[192:195]
    ds_read_b64_tr_b16 v[228:229], v18 offset:45056
    v_mfma_f32_16x16x32_bf16 v[196:199], v[244:247], v[36:39], v[196:199]
    ds_read_b64_tr_b16 v[230:231], v18 offset:47104
    s_waitcnt vmcnt(6)
    s_barrier
    s_waitcnt lgkmcnt(6)
    v_mfma_f32_16x16x32_bf16 v[168:171], v[216:219], v[40:43], v[168:171]
    ds_read_b64_tr_b16 v[232:233], v19 offset:0
    v_mfma_f32_16x16x32_bf16 v[172:175], v[216:219], v[44:47], v[172:175]
    ds_read_b64_tr_b16 v[234:235], v19 offset:2048
    s_add_u32 m0, s18, 16384
    s_add_u32 s48, s36, 1474816
    buffer_load_dwordx4 v1, s[20:23], s48 offen lds
    s_waitcnt lgkmcnt(6)
    v_mfma_f32_16x16x32_bf16 v[176:179], v[220:223], v[40:43], v[176:179]
    ds_read_b64_tr_b16 v[236:237], v20 offset:0
    v_mfma_f32_16x16x32_bf16 v[180:183], v[220:223], v[44:47], v[180:183]
    ds_read_b64_tr_b16 v[238:239], v20 offset:2048
    s_waitcnt lgkmcnt(6)
    v_mfma_f32_16x16x32_bf16 v[184:187], v[224:227], v[40:43], v[184:187]
    ds_read_b64_tr_b16 v[240:241], v19 offset:4096
    v_mfma_f32_16x16x32_bf16 v[188:191], v[224:227], v[44:47], v[188:191]
    ds_read_b64_tr_b16 v[242:243], v19 offset:6144
    s_waitcnt lgkmcnt(6)
    v_mfma_f32_16x16x32_bf16 v[192:195], v[228:231], v[40:43], v[192:195]
    ds_read_b64_tr_b16 v[244:245], v20 offset:4096
    v_mfma_f32_16x16x32_bf16 v[196:199], v[228:231], v[44:47], v[196:199]
    ds_read_b64_tr_b16 v[246:247], v20 offset:6144
    s_waitcnt lgkmcnt(6)
    v_mfma_f32_16x16x32_bf16 v[168:171], v[232:235], v[48:51], v[168:171]
    ds_read_b64_tr_b16 v[216:217], v19 offset:8192
    v_mfma_f32_16x16x32_bf16 v[172:175], v[232:235], v[52:55], v[172:175]
    ds_read_b64_tr_b16 v[218:219], v19 offset:10240
    s_add_u32 m0, s18, 24576
    s_add_u32 s48, s36, 1622272
    buffer_load_dwordx4 v1, s[20:23], s48 offen lds
    s_waitcnt lgkmcnt(6)
    v_mfma_f32_16x16x32_bf16 v[176:179], v[236:239], v[48:51], v[176:179]
    ds_read_b64_tr_b16 v[220:221], v20 offset:8192
    v_mfma_f32_16x16x32_bf16 v[180:183], v[236:239], v[52:55], v[180:183]
    ds_read_b64_tr_b16 v[222:223], v20 offset:10240
    s_waitcnt lgkmcnt(6)
    v_mfma_f32_16x16x32_bf16 v[184:187], v[240:243], v[48:51], v[184:187]
    ds_read_b64_tr_b16 v[224:225], v19 offset:12288
    v_mfma_f32_16x16x32_bf16 v[188:191], v[240:243], v[52:55], v[188:191]
    ds_read_b64_tr_b16 v[226:227], v19 offset:14336
    s_waitcnt lgkmcnt(6)
    v_mfma_f32_16x16x32_bf16 v[192:195], v[244:247], v[48:51], v[192:195]
    ds_read_b64_tr_b16 v[228:229], v20 offset:12288
    v_mfma_f32_16x16x32_bf16 v[196:199], v[244:247], v[52:55], v[196:199]
    ds_read_b64_tr_b16 v[230:231], v20 offset:14336
    s_waitcnt lgkmcnt(6)
    v_mfma_f32_16x16x32_bf16 v[168:171], v[216:219], v[56:59], v[168:171]
    ds_read_b64_tr_b16 v[232:233], v19 offset:16384
    v_mfma_f32_16x16x32_bf16 v[172:175], v[216:219], v[60:63], v[172:175]
    ds_read_b64_tr_b16 v[234:235], v19 offset:18432
    s_add_u32 m0, s18, 32768
    s_add_u32 s48, s36, 1769728
    buffer_load_dwordx4 v1, s[20:23], s48 offen lds
    s_waitcnt lgkmcnt(6)
    v_mfma_f32_16x16x32_bf16 v[176:179], v[220:223], v[56:59], v[176:179]
    ds_read_b64_tr_b16 v[236:237], v20 offset:16384
    v_mfma_f32_16x16x32_bf16 v[180:183], v[220:223], v[60:63], v[180:183]
    ds_read_b64_tr_b16 v[238:239], v20 offset:18432
    s_waitcnt lgkmcnt(6)
    v_mfma_f32_16x16x32_bf16 v[184:187], v[224:227], v[56:59], v[184:187]
    ds_read_b64_tr_b16 v[240:241], v19 offset:20480
    v_mfma_f32_16x16x32_bf16 v[188:191], v[224:227], v[60:63], v[188:191]
    ds_read_b64_tr_b16 v[242:243], v19 offset:22528
    s_waitcnt lgkmcnt(6)
    v_mfma_f32_16x16x32_bf16 v[192:195], v[228:231], v[56:59], v[192:195]
    ds_read_b64_tr_b16 v[244:245], v20 offset:20480
    v_mfma_f32_16x16x32_bf16 v[196:199], v[228:231], v[60:63], v[196:199]
    ds_read_b64_tr_b16 v[246:247], v20 offset:22528
    s_waitcnt vmcnt(4)
    s_barrier
    s_waitcnt lgkmcnt(6)
    v_mfma_f32_16x16x32_bf16 v[168:171], v[232:235], v[64:67], v[168:171]
    ds_read_b64_tr_b16 v[216:217], v19 offset:24576
    v_mfma_f32_16x16x32_bf16 v[172:175], v[232:235], v[68:71], v[172:175]
    ds_read_b64_tr_b16 v[218:219], v19 offset:26624
    s_add_u32 m0, s18, 40960
    s_add_u32 s48, s36, 1917184
    buffer_load_dwordx4 v1, s[20:23], s48 offen lds
    s_waitcnt lgkmcnt(6)
    v_mfma_f32_16x16x32_bf16 v[176:179], v[236:239], v[64:67], v[176:179]
    ds_read_b64_tr_b16 v[220:221], v20 offset:24576
    v_mfma_f32_16x16x32_bf16 v[180:183], v[236:239], v[68:71], v[180:183]
    ds_read_b64_tr_b16 v[222:223], v20 offset:26624
    s_waitcnt lgkmcnt(6)
    v_mfma_f32_16x16x32_bf16 v[184:187], v[240:243], v[64:67], v[184:187]
    ds_read_b64_tr_b16 v[224:225], v19 offset:28672
    v_mfma_f32_16x16x32_bf16 v[188:191], v[240:243], v[68:71], v[188:191]
    ds_read_b64_tr_b16 v[226:227], v19 offset:30720
    s_waitcnt lgkmcnt(6)
    v_mfma_f32_16x16x32_bf16 v[192:195], v[244:247], v[64:67], v[192:195]
    ds_read_b64_tr_b16 v[228:229], v20 offset:28672
    v_mfma_f32_16x16x32_bf16 v[196:199], v[244:247], v[68:71], v[196:199]
    ds_read_b64_tr_b16 v[230:231], v20 offset:30720
    s_waitcnt lgkmcnt(6)
    v_mfma_f32_16x16x32_bf16 v[168:171], v[216:219], v[72:75], v[168:171]
    ds_read_b64_tr_b16 v[232:233], v19 offset:32768
    v_mfma_f32_16x16x32_bf16 v[172:175], v[216:219], v[76:79], v[172:175]
    ds_read_b64_tr_b16 v[234:235], v19 offset:34816
    s_add_u32 m0, s18, 49152
    s_add_u32 s48, s36, 2064640
    buffer_load_dwordx4 v1, s[20:23], s48 offen lds
    s_waitcnt lgkmcnt(6)
    v_mfma_f32_16x16x32_bf16 v[176:179], v[220:223], v[72:75], v[176:179]
    ds_read_b64_tr_b16 v[236:237], v20 offset:32768
    v_mfma_f32_16x16x32_bf16 v[180:183], v[220:223], v[76:79], v[180:183]
    ds_read_b64_tr_b16 v[238:239], v20 offset:34816
    s_add_u32 s49, s47, 24576
    buffer_store_dwordx4 v[200:203], v4, s[32:35], s49 offen sc1
    s_waitcnt lgkmcnt(6)
    v_mfma_f32_16x16x32_bf16 v[184:187], v[224:227], v[72:75], v[184:187]
    ds_read_b64_tr_b16 v[240:241], v19 offset:36864
    v_mfma_f32_16x16x32_bf16 v[188:191], v[224:227], v[76:79], v[188:191]
    ds_read_b64_tr_b16 v[242:243], v19 offset:38912
    s_waitcnt lgkmcnt(6)
    v_mfma_f32_16x16x32_bf16 v[192:195], v[228:231], v[72:75], v[192:195]
    ds_read_b64_tr_b16 v[244:245], v20 offset:36864
    v_mfma_f32_16x16x32_bf16 v[196:199], v[228:231], v[76:79], v[196:199]
    ds_read_b64_tr_b16 v[246:247], v20 offset:38912
    s_waitcnt lgkmcnt(6)
    v_mfma_f32_16x16x32_bf16 v[168:171], v[232:235], v[80:83], v[168:171]
    ds_read_b64_tr_b16 v[216:217], v17 offset:0
    v_mfma_f32_16x16x32_bf16 v[172:175], v[232:235], v[84:87], v[172:175]
    ds_read_b64_tr_b16 v[218:219], v17 offset:2048
    s_add_u32 m0, s18, 57344
    s_add_u32 s48, s36, 2212096
    buffer_load_dwordx4 v1, s[20:23], s48 offen lds
    s_waitcnt lgkmcnt(6)
    v_mfma_f32_16x16x32_bf16 v[176:179], v[236:239], v[80:83], v[176:179]
    ds_read_b64_tr_b16 v[220:221], v18 offset:0
    v_mfma_f32_16x16x32_bf16 v[180:183], v[236:239], v[84:87], v[180:183]
    ds_read_b64_tr_b16 v[222:223], v18 offset:2048
    s_waitcnt lgkmcnt(6)
    v_mfma_f32_16x16x32_bf16 v[184:187], v[240:243], v[80:83], v[184:187]
    ds_read_b64_tr_b16 v[224:225], v17 offset:4096
    v_mfma_f32_16x16x32_bf16 v[188:191], v[240:243], v[84:87], v[188:191]
    ds_read_b64_tr_b16 v[226:227], v17 offset:6144
    s_waitcnt lgkmcnt(6)
    v_mfma_f32_16x16x32_bf16 v[192:195], v[244:247], v[80:83], v[192:195]
    ds_read_b64_tr_b16 v[228:229], v18 offset:4096
    v_mfma_f32_16x16x32_bf16 v[196:199], v[244:247], v[84:87], v[196:199]
    ds_read_b64_tr_b16 v[230:231], v18 offset:6144
    s_waitcnt vmcnt(5)
    s_barrier
    s_waitcnt lgkmcnt(6)
    v_mfma_f32_16x16x32_bf16 v[168:171], v[216:219], v[88:91], v[168:171]
    ds_read_b64_tr_b16 v[232:233], v17 offset:8192
    v_mfma_f32_16x16x32_bf16 v[172:175], v[216:219], v[92:95], v[172:175]
    ds_read_b64_tr_b16 v[234:235], v17 offset:10240
    s_add_u32 m0, s18, 65536
    s_add_u32 s48, s36, 2359552
    buffer_load_dwordx4 v1, s[20:23], s48 offen lds
    s_waitcnt lgkmcnt(6)
    v_mfma_f32_16x16x32_bf16 v[176:179], v[220:223], v[88:91], v[176:179]
    ds_read_b64_tr_b16 v[236:237], v18 offset:8192
    v_mfma_f32_16x16x32_bf16 v[180:183], v[220:223], v[92:95], v[180:183]
    ds_read_b64_tr_b16 v[238:239], v18 offset:10240
    s_waitcnt lgkmcnt(6)
    v_mfma_f32_16x16x32_bf16 v[184:187], v[224:227], v[88:91], v[184:187]
    ds_read_b64_tr_b16 v[240:241], v17 offset:12288
    v_mfma_f32_16x16x32_bf16 v[188:191], v[224:227], v[92:95], v[188:191]
    ds_read_b64_tr_b16 v[242:243], v17 offset:14336
    s_waitcnt lgkmcnt(6)
    v_mfma_f32_16x16x32_bf16 v[192:195], v[228:231], v[88:91], v[192:195]
    ds_read_b64_tr_b16 v[244:245], v18 offset:12288
    v_mfma_f32_16x16x32_bf16 v[196:199], v[228:231], v[92:95], v[196:199]
    ds_read_b64_tr_b16 v[246:247], v18 offset:14336
    s_waitcnt lgkmcnt(6)
    v_mfma_f32_16x16x32_bf16 v[168:171], v[232:235], v[96:99], v[168:171]
    ds_read_b64_tr_b16 v[216:217], v17 offset:16384
    v_mfma_f32_16x16x32_bf16 v[172:175], v[232:235], v[100:103], v[172:175]
    ds_read_b64_tr_b16 v[218:219], v17 offset:18432
    s_add_u32 m0, s18, 73728
    s_add_u32 s48, s36, 2507008
    buffer_load_dwordx4 v1, s[20:23], s48 offen lds
    s_waitcnt lgkmcnt(6)
    v_mfma_f32_16x16x32_bf16 v[176:179], v[236:239], v[96:99], v[176:179]
    ds_read_b64_tr_b16 v[220:221], v18 offset:16384
    v_mfma_f32_16x16x32_bf16 v[180:183], v[236:239], v[100:103], v[180:183]
    ds_read_b64_tr_b16 v[222:223], v18 offset:18432
    s_waitcnt lgkmcnt(6)
    v_mfma_f32_16x16x32_bf16 v[184:187], v[240:243], v[96:99], v[184:187]
    ds_read_b64_tr_b16 v[224:225], v17 offset:20480
    v_mfma_f32_16x16x32_bf16 v[188:191], v[240:243], v[100:103], v[188:191]
    ds_read_b64_tr_b16 v[226:227], v17 offset:22528
    s_waitcnt lgkmcnt(6)
    v_mfma_f32_16x16x32_bf16 v[192:195], v[244:247], v[96:99], v[192:195]
    ds_read_b64_tr_b16 v[228:229], v18 offset:20480
    v_mfma_f32_16x16x32_bf16 v[196:199], v[244:247], v[100:103], v[196:199]
    ds_read_b64_tr_b16 v[230:231], v18 offset:22528
    s_waitcnt lgkmcnt(6)
    v_mfma_f32_16x16x32_bf16 v[168:171], v[216:219], v[104:107], v[168:171]
    ds_read_b64_tr_b16 v[232:233], v17 offset:24576
    v_mfma_f32_16x16x32_bf16 v[172:175], v[216:219], v[108:111], v[172:175]
    ds_read_b64_tr_b16 v[234:235], v17 offset:26624
    s_add_u32 m0, s18, 81920
    s_add_u32 s48, s36, 384
    buffer_load_dwordx4 v1, s[20:23], s48 offen lds
    s_waitcnt lgkmcnt(6)
    v_mfma_f32_16x16x32_bf16 v[176:179], v[220:223], v[104:107], v[176:179]
    ds_read_b64_tr_b16 v[236:237], v18 offset:24576
    v_mfma_f32_16x16x32_bf16 v[180:183], v[220:223], v[108:111], v[180:183]
    ds_read_b64_tr_b16 v[238:239], v18 offset:26624
    s_waitcnt lgkmcnt(6)
    v_mfma_f32_16x16x32_bf16 v[184:187], v[224:227], v[104:107], v[184:187]
    ds_read_b64_tr_b16 v[240:241], v17 offset:28672
    v_mfma_f32_16x16x32_bf16 v[188:191], v[224:227], v[108:111], v[188:191]
    ds_read_b64_tr_b16 v[242:243], v17 offset:30720
    s_waitcnt lgkmcnt(6)
    v_mfma_f32_16x16x32_bf16 v[192:195], v[228:231], v[104:107], v[192:195]
    ds_read_b64_tr_b16 v[244:245], v18 offset:28672
    v_mfma_f32_16x16x32_bf16 v[196:199], v[228:231], v[108:111], v[196:199]
    ds_read_b64_tr_b16 v[246:247], v18 offset:30720
    s_waitcnt vmcnt(5)
    s_barrier
    s_waitcnt lgkmcnt(6)
    v_mfma_f32_16x16x32_bf16 v[168:171], v[232:235], v[112:115], v[168:171]
    ds_read_b64_tr_b16 v[216:217], v17 offset:32768
    v_mfma_f32_16x16x32_bf16 v[172:175], v[232:235], v[116:119], v[172:175]
    ds_read_b64_tr_b16 v[218:219], v17 offset:34816
    s_add_u32 m0, s18, 0
    s_add_u32 s48, s36, 147840
    buffer_load_dwordx4 v1, s[20:23], s48 offen lds
    s_waitcnt lgkmcnt(6)
    v_mfma_f32_16x16x32_bf16 v[176:179], v[236:239], v[112:115], v[176:179]
    ds_read_b64_tr_b16 v[220:221], v18 offset:32768
    v_mfma_f32_16x16x32_bf16 v[180:183], v[236:239], v[116:119], v[180:183]
    ds_read_b64_tr_b16 v[222:223], v18 offset:34816
    s_waitcnt lgkmcnt(6)
    v_mfma_f32_16x16x32_bf16 v[184:187], v[240:243], v[112:115], v[184:187]
    ds_read_b64_tr_b16 v[224:225], v17 offset:36864
    v_mfma_f32_16x16x32_bf16 v[188:191], v[240:243], v[116:119], v[188:191]
    ds_read_b64_tr_b16 v[226:227], v17 offset:38912
    s_waitcnt lgkmcnt(6)
    v_mfma_f32_16x16x32_bf16 v[192:195], v[244:247], v[112:115], v[192:195]
    ds_read_b64_tr_b16 v[228:229], v18 offset:36864
    v_mfma_f32_16x16x32_bf16 v[196:199], v[244:247], v[116:119], v[196:199]
    ds_read_b64_tr_b16 v[230:231], v18 offset:38912
    s_waitcnt lgkmcnt(6)
    v_mfma_f32_16x16x32_bf16 v[168:171], v[216:219], v[120:123], v[168:171]
    ds_read_b64_tr_b16 v[232:233], v17 offset:40960
    v_mfma_f32_16x16x32_bf16 v[172:175], v[216:219], v[124:127], v[172:175]
    ds_read_b64_tr_b16 v[234:235], v17 offset:43008
    s_add_u32 m0, s18, 8192
    s_add_u32 s48, s36, 295296
    buffer_load_dwordx4 v1, s[20:23], s48 offen lds
    s_waitcnt lgkmcnt(6)
    v_mfma_f32_16x16x32_bf16 v[176:179], v[220:223], v[120:123], v[176:179]
    ds_read_b64_tr_b16 v[236:237], v18 offset:40960
    v_mfma_f32_16x16x32_bf16 v[180:183], v[220:223], v[124:127], v[180:183]
    ds_read_b64_tr_b16 v[238:239], v18 offset:43008
    s_mov_b32 s49, s94
    buffer_store_dwordx4 v[200:203], v4, s[32:35], s49 offen sc1
    s_waitcnt lgkmcnt(6)
    v_mfma_f32_16x16x32_bf16 v[184:187], v[224:227], v[120:123], v[184:187]
    ds_read_b64_tr_b16 v[240:241], v17 offset:45056
    v_mfma_f32_16x16x32_bf16 v[188:191], v[224:227], v[124:127], v[188:191]
    ds_read_b64_tr_b16 v[242:243], v17 offset:47104
    s_waitcnt lgkmcnt(6)
    v_mfma_f32_16x16x32_bf16 v[192:195], v[228:231], v[120:123], v[192:195]
    ds_read_b64_tr_b16 v[244:245], v18 offset:45056
    v_mfma_f32_16x16x32_bf16 v[196:199], v[228:231], v[124:127], v[196:199]
    ds_read_b64_tr_b16 v[246:247], v18 offset:47104
    s_waitcnt lgkmcnt(6)
    v_mfma_f32_16x16x32_bf16 v[168:171], v[232:235], v[128:131], v[168:171]
    ds_read_b64_tr_b16 v[216:217], v19 offset:0
    v_mfma_f32_16x16x32_bf16 v[172:175], v[232:235], v[132:135], v[172:175]
    ds_read_b64_tr_b16 v[218:219], v19 offset:2048
    s_add_u32 m0, s18, 16384
    s_add_u32 s48, s36, 442752
    buffer_load_dwordx4 v1, s[20:23], s48 offen lds
    s_waitcnt lgkmcnt(6)
    v_mfma_f32_16x16x32_bf16 v[176:179], v[236:239], v[128:131], v[176:179]
    ds_read_b64_tr_b16 v[220:221], v20 offset:0
    v_mfma_f32_16x16x32_bf16 v[180:183], v[236:239], v[132:135], v[180:183]
    ds_read_b64_tr_b16 v[222:223], v20 offset:2048
    s_waitcnt lgkmcnt(6)
    v_mfma_f32_16x16x32_bf16 v[184:187], v[240:243], v[128:131], v[184:187]
    ds_read_b64_tr_b16 v[224:225], v19 offset:4096
    v_mfma_f32_16x16x32_bf16 v[188:191], v[240:243], v[132:135], v[188:191]
    ds_read_b64_tr_b16 v[226:227], v19 offset:6144
    s_waitcnt lgkmcnt(6)
    v_mfma_f32_16x16x32_bf16 v[192:195], v[244:247], v[128:131], v[192:195]
    ds_read_b64_tr_b16 v[228:229], v20 offset:4096
    v_mfma_f32_16x16x32_bf16 v[196:199], v[244:247], v[132:135], v[196:199]
    ds_read_b64_tr_b16 v[230:231], v20 offset:6144
    s_waitcnt vmcnt(5)
    s_barrier
    s_waitcnt lgkmcnt(6)
    v_mfma_f32_16x16x32_bf16 v[168:171], v[216:219], v[136:139], v[168:171]
    ds_read_b64_tr_b16 v[232:233], v19 offset:8192
    v_mfma_f32_16x16x32_bf16 v[172:175], v[216:219], v[140:143], v[172:175]
    ds_read_b64_tr_b16 v[234:235], v19 offset:10240
    s_add_u32 m0, s18, 24576
    s_add_u32 s48, s36, 590208
    buffer_load_dwordx4 v1, s[20:23], s48 offen lds
    s_waitcnt lgkmcnt(6)
    v_mfma_f32_16x16x32_bf16 v[176:179], v[220:223], v[136:139], v[176:179]
    ds_read_b64_tr_b16 v[236:237], v20 offset:8192
    v_mfma_f32_16x16x32_bf16 v[180:183], v[220:223], v[140:143], v[180:183]
    ds_read_b64_tr_b16 v[238:239], v20 offset:10240
    s_waitcnt lgkmcnt(6)
    v_mfma_f32_16x16x32_bf16 v[184:187], v[224:227], v[136:139], v[184:187]
    ds_read_b64_tr_b16 v[240:241], v19 offset:12288
    v_mfma_f32_16x16x32_bf16 v[188:191], v[224:227], v[140:143], v[188:191]
    ds_read_b64_tr_b16 v[242:243], v19 offset:14336
    s_waitcnt lgkmcnt(6)
    v_mfma_f32_16x16x32_bf16 v[192:195], v[228:231], v[136:139], v[192:195]
    ds_read_b64_tr_b16 v[244:245], v20 offset:12288
    v_mfma_f32_16x16x32_bf16 v[196:199], v[228:231], v[140:143], v[196:199]
    ds_read_b64_tr_b16 v[246:247], v20 offset:14336
    s_waitcnt lgkmcnt(6)
    v_mfma_f32_16x16x32_bf16 v[168:171], v[232:235], v[144:147], v[168:171]
    ds_read_b64_tr_b16 v[216:217], v19 offset:16384
    v_mfma_f32_16x16x32_bf16 v[172:175], v[232:235], v[148:151], v[172:175]
    ds_read_b64_tr_b16 v[218:219], v19 offset:18432
    s_add_u32 m0, s18, 32768
    s_add_u32 s48, s36, 737664
    buffer_load_dwordx4 v1, s[20:23], s48 offen lds
    s_waitcnt lgkmcnt(6)
    v_mfma_f32_16x16x32_bf16 v[176:179], v[236:239], v[144:147], v[176:179]
    ds_read_b64_tr_b16 v[220:221], v20 offset:16384
    v_mfma_f32_16x16x32_bf16 v[180:183], v[236:239], v[148:151], v[180:183]
    ds_read_b64_tr_b16 v[222:223], v20 offset:18432
    s_waitcnt lgkmcnt(6)
    v_mfma_f32_16x16x32_bf16 v[184:187], v[240:243], v[144:147], v[184:187]
    ds_read_b64_tr_b16 v[224:225], v19 offset:20480
    v_mfma_f32_16x16x32_bf16 v[188:191], v[240:243], v[148:151], v[188:191]
    ds_read_b64_tr_b16 v[226:227], v19 offset:22528
    s_waitcnt lgkmcnt(6)
    v_mfma_f32_16x16x32_bf16 v[192:195], v[244:247], v[144:147], v[192:195]
    ds_read_b64_tr_b16 v[228:229], v20 offset:20480
    v_mfma_f32_16x16x32_bf16 v[196:199], v[244:247], v[148:151], v[196:199]
    ds_read_b64_tr_b16 v[230:231], v20 offset:22528
    s_waitcnt lgkmcnt(6)
    v_mfma_f32_16x16x32_bf16 v[168:171], v[216:219], v[152:155], v[168:171]
    ds_read_b64_tr_b16 v[232:233], v19 offset:24576
    v_mfma_f32_16x16x32_bf16 v[172:175], v[216:219], v[156:159], v[172:175]
    ds_read_b64_tr_b16 v[234:235], v19 offset:26624
    s_add_u32 m0, s18, 40960
    s_add_u32 s48, s36, 885120
    buffer_load_dwordx4 v1, s[20:23], s48 offen lds
    s_waitcnt lgkmcnt(6)
    v_mfma_f32_16x16x32_bf16 v[176:179], v[220:223], v[152:155], v[176:179]
    ds_read_b64_tr_b16 v[236:237], v20 offset:24576
    v_mfma_f32_16x16x32_bf16 v[180:183], v[220:223], v[156:159], v[180:183]
    ds_read_b64_tr_b16 v[238:239], v20 offset:26624
    s_waitcnt lgkmcnt(6)
    v_mfma_f32_16x16x32_bf16 v[184:187], v[224:227], v[152:155], v[184:187]
    ds_read_b64_tr_b16 v[240:241], v19 offset:28672
    v_mfma_f32_16x16x32_bf16 v[188:191], v[224:227], v[156:159], v[188:191]
    ds_read_b64_tr_b16 v[242:243], v19 offset:30720
    s_waitcnt lgkmcnt(6)
    v_mfma_f32_16x16x32_bf16 v[192:195], v[228:231], v[152:155], v[192:195]
    ds_read_b64_tr_b16 v[244:245], v20 offset:28672
    v_mfma_f32_16x16x32_bf16 v[196:199], v[228:231], v[156:159], v[196:199]
    ds_read_b64_tr_b16 v[246:247], v20 offset:30720
    s_waitcnt vmcnt(5)
    s_barrier
    s_waitcnt lgkmcnt(6)
    v_mfma_f32_16x16x32_bf16 v[168:171], v[232:235], v[160:163], v[168:171]
    ds_read_b64_tr_b16 v[216:217], v19 offset:32768
    v_mfma_f32_16x16x32_bf16 v[172:175], v[232:235], v[164:167], v[172:175]
    ds_read_b64_tr_b16 v[218:219], v19 offset:34816
    s_add_u32 m0, s18, 49152
    s_add_u32 s48, s36, 1032576
    buffer_load_dwordx4 v1, s[20:23], s48 offen lds
    s_waitcnt lgkmcnt(6)
    v_mfma_f32_16x16x32_bf16 v[176:179], v[236:239], v[160:163], v[176:179]
    ds_read_b64_tr_b16 v[220:221], v20 offset:32768
    v_mfma_f32_16x16x32_bf16 v[180:183], v[236:239], v[164:167], v[180:183]
    ds_read_b64_tr_b16 v[222:223], v20 offset:34816
    s_waitcnt lgkmcnt(6)
    v_mfma_f32_16x16x32_bf16 v[184:187], v[240:243], v[160:163], v[184:187]
    ds_read_b64_tr_b16 v[224:225], v19 offset:36864
    v_mfma_f32_16x16x32_bf16 v[188:191], v[240:243], v[164:167], v[188:191]
    ds_read_b64_tr_b16 v[226:227], v19 offset:38912
    s_waitcnt lgkmcnt(6)
    v_mfma_f32_16x16x32_bf16 v[192:195], v[244:247], v[160:163], v[192:195]
    ds_read_b64_tr_b16 v[228:229], v20 offset:36864
    v_mfma_f32_16x16x32_bf16 v[196:199], v[244:247], v[164:167], v[196:199]
    ds_read_b64_tr_b16 v[230:231], v20 offset:38912
    v_mul_f32 v168, v168, v184
    v_mul_f32 v169, v169, v185
    v_mul_f32 v170, v170, v186
    v_mul_f32 v171, v171, v187
    v_cvt_pk_bf16_f32 v232, v168, v169
    v_cvt_pk_bf16_f32 v233, v170, v171
    v_mul_f32 v176, v176, v192
    v_mul_f32 v177, v177, v193
    v_mul_f32 v178, v178, v194
    v_mul_f32 v179, v179, v195
    v_cvt_pk_bf16_f32 v234, v176, v177
    v_cvt_pk_bf16_f32 v235, v178, v179
    ds_write_b128 v6, v[232:235] offset:32768
    s_add_u32 s49, s88, 32768
    buffer_store_dwordx4 v[232:235], v4, s[84:87], s49 offen sc1
    v_mul_f32 v172, v172, v188
    v_mul_f32 v173, v173, v189
    v_mul_f32 v174, v174, v190
    v_mul_f32 v175, v175, v191
    v_cvt_pk_bf16_f32 v236, v172, v173
    v_cvt_pk_bf16_f32 v237, v174, v175
    v_mul_f32 v180, v180, v196
    v_mul_f32 v181, v181, v197
    v_mul_f32 v182, v182, v198
    v_mul_f32 v183, v183, v199
    v_cvt_pk_bf16_f32 v238, v180, v181
    v_cvt_pk_bf16_f32 v239, v182, v183
    ds_write_b128 v6, v[236:239] offset:33792
    s_add_u32 s49, s88, 33792
    buffer_store_dwordx4 v[236:239], v4, s[84:87], s49 offen sc1
    s_waitcnt lgkmcnt(8)
    v_mfma_f32_16x16x32_bf16 v[168:171], v[216:219], v[24:27], 0
    ds_read_b64_tr_b16 v[232:233], v17 offset:0
    v_mfma_f32_16x16x32_bf16 v[172:175], v[216:219], v[28:31], 0
    ds_read_b64_tr_b16 v[234:235], v17 offset:2048
    s_add_u32 m0, s18, 57344
    s_add_u32 s48, s36, 1180032
    buffer_load_dwordx4 v1, s[20:23], s48 offen lds
    s_waitcnt lgkmcnt(8)
    v_mfma_f32_16x16x32_bf16 v[176:179], v[220:223], v[24:27], 0
    ds_read_b64_tr_b16 v[236:237], v18 offset:0
    v_mfma_f32_16x16x32_bf16 v[180:183], v[220:223], v[28:31], 0
    ds_read_b64_tr_b16 v[238:239], v18 offset:2048
    s_waitcnt lgkmcnt(8)
    v_mfma_f32_16x16x32_bf16 v[184:187], v[224:227], v[24:27], 0
    ds_read_b64_tr_b16 v[240:241], v17 offset:4096
    v_mfma_f32_16x16x32_bf16 v[188:191], v[224:227], v[28:31], 0
    ds_read_b64_tr_b16 v[242:243], v17 offset:6144
    s_waitcnt lgkmcnt(8)
    v_mfma_f32_16x16x32_bf16 v[192:195], v[228:231], v[24:27], 0
    ds_read_b64_tr_b16 v[244:245], v18 offset:4096
    v_mfma_f32_16x16x32_bf16 v[196:199], v[228:231], v[28:31], 0
    ds_read_b64_tr_b16 v[246:247], v18 offset:6144
    s_waitcnt lgkmcnt(6)
    v_mfma_f32_16x16x32_bf16 v[168:171], v[232:235], v[32:35], v[168:171]
    ds_read_b64_tr_b16 v[216:217], v17 offset:8192
    v_mfma_f32_16x16x32_bf16 v[172:175], v[232:235], v[36:39], v[172:175]
    ds_read_b64_tr_b16 v[218:219], v17 offset:10240
    s_add_u32 m0, s18, 65536
    s_add_u32 s48, s36, 1327488
    buffer_load_dwordx4 v1, s[20:23], s48 offen lds
    s_waitcnt lgkmcnt(6)
    v_mfma_f32_16x16x32_bf16 v[176:179], v[236:239], v[32:35], v[176:179]
    ds_read_b64_tr_b16 v[220:221], v18 offset:8192
    v_mfma_f32_16x16x32_bf16 v[180:183], v[236:239], v[36:39], v[180:183]
    ds_read_b64_tr_b16 v[222:223], v18 offset:10240
    s_waitcnt lgkmcnt(6)
    v_mfma_f32_16x16x32_bf16 v[184:187], v[240:243], v[32:35], v[184:187]
    ds_read_b64_tr_b16 v[224:225], v17 offset:12288
    v_mfma_f32_16x16x32_bf16 v[188:191], v[240:243], v[36:39], v[188:191]
    ds_read_b64_tr_b16 v[226:227], v17 offset:14336
    s_waitcnt lgkmcnt(6)
    v_mfma_f32_16x16x32_bf16 v[192:195], v[244:247], v[32:35], v[192:195]
    ds_read_b64_tr_b16 v[228:229], v18 offset:12288
    v_mfma_f32_16x16x32_bf16 v[196:199], v[244:247], v[36:39], v[196:199]
    ds_read_b64_tr_b16 v[230:231], v18 offset:14336
    s_waitcnt vmcnt(6)
    s_barrier
    s_waitcnt lgkmcnt(6)
    v_mfma_f32_16x16x32_bf16 v[168:171], v[216:219], v[40:43], v[168:171]
    ds_read_b64_tr_b16 v[232:233], v17 offset:16384
    v_mfma_f32_16x16x32_bf16 v[172:175], v[216:219], v[44:47], v[172:175]
    ds_read_b64_tr_b16 v[234:235], v17 offset:18432
    s_add_u32 m0, s18, 73728
    s_add_u32 s48, s36, 1474944
    buffer_load_dwordx4 v1, s[20:23], s48 offen lds
    s_waitcnt lgkmcnt(6)
    v_mfma_f32_16x16x32_bf16 v[176:179], v[220:223], v[40:43], v[176:179]
    ds_read_b64_tr_b16 v[236:237], v18 offset:16384
    v_mfma_f32_16x16x32_bf16 v[180:183], v[220:223], v[44:47], v[180:183]
    ds_read_b64_tr_b16 v[238:239], v18 offset:18432
    s_waitcnt lgkmcnt(6)
    v_mfma_f32_16x16x32_bf16 v[184:187], v[224:227], v[40:43], v[184:187]
    ds_read_b64_tr_b16 v[240:241], v17 offset:20480
    v_mfma_f32_16x16x32_bf16 v[188:191], v[224:227], v[44:47], v[188:191]
    ds_read_b64_tr_b16 v[242:243], v17 offset:22528
    s_waitcnt lgkmcnt(6)
    v_mfma_f32_16x16x32_bf16 v[192:195], v[228:231], v[40:43], v[192:195]
    ds_read_b64_tr_b16 v[244:245], v18 offset:20480
    v_mfma_f32_16x16x32_bf16 v[196:199], v[228:231], v[44:47], v[196:199]
    ds_read_b64_tr_b16 v[246:247], v18 offset:22528
    s_waitcnt lgkmcnt(6)
    v_mfma_f32_16x16x32_bf16 v[168:171], v[232:235], v[48:51], v[168:171]
    ds_read_b64_tr_b16 v[216:217], v17 offset:24576
    v_mfma_f32_16x16x32_bf16 v[172:175], v[232:235], v[52:55], v[172:175]
    ds_read_b64_tr_b16 v[218:219], v17 offset:26624
    s_add_u32 m0, s18, 81920
    s_add_u32 s48, s36, 1622400
    buffer_load_dwordx4 v1, s[20:23], s48 offen lds
    s_waitcnt lgkmcnt(6)
    v_mfma_f32_16x16x32_bf16 v[176:179], v[236:239], v[48:51], v[176:179]
    ds_read_b64_tr_b16 v[220:221], v18 offset:24576
    v_mfma_f32_16x16x32_bf16 v[180:183], v[236:239], v[52:55], v[180:183]
    ds_read_b64_tr_b16 v[222:223], v18 offset:26624
    s_waitcnt lgkmcnt(6)
    v_mfma_f32_16x16x32_bf16 v[184:187], v[240:243], v[48:51], v[184:187]
    ds_read_b64_tr_b16 v[224:225], v17 offset:28672
    v_mfma_f32_16x16x32_bf16 v[188:191], v[240:243], v[52:55], v[188:191]
    ds_read_b64_tr_b16 v[226:227], v17 offset:30720
    s_waitcnt lgkmcnt(6)
    v_mfma_f32_16x16x32_bf16 v[192:195], v[244:247], v[48:51], v[192:195]
    ds_read_b64_tr_b16 v[228:229], v18 offset:28672
    v_mfma_f32_16x16x32_bf16 v[196:199], v[244:247], v[52:55], v[196:199]
    ds_read_b64_tr_b16 v[230:231], v18 offset:30720
    s_waitcnt lgkmcnt(6)
    v_mfma_f32_16x16x32_bf16 v[168:171], v[216:219], v[56:59], v[168:171]
    ds_read_b64_tr_b16 v[232:233], v17 offset:32768
    v_mfma_f32_16x16x32_bf16 v[172:175], v[216:219], v[60:63], v[172:175]
    ds_read_b64_tr_b16 v[234:235], v17 offset:34816
    s_add_u32 m0, s18, 0
    s_add_u32 s48, s36, 1769856
    buffer_load_dwordx4 v1, s[20:23], s48 offen lds
    s_waitcnt lgkmcnt(6)
    v_mfma_f32_16x16x32_bf16 v[176:179], v[220:223], v[56:59], v[176:179]
    ds_read_b64_tr_b16 v[236:237], v18 offset:32768
    v_mfma_f32_16x16x32_bf16 v[180:183], v[220:223], v[60:63], v[180:183]
    ds_read_b64_tr_b16 v[238:239], v18 offset:34816
    s_waitcnt lgkmcnt(6)
    v_mfma_f32_16x16x32_bf16 v[184:187], v[224:227], v[56:59], v[184:187]
    ds_read_b64_tr_b16 v[240:241], v17 offset:36864
    v_mfma_f32_16x16x32_bf16 v[188:191], v[224:227], v[60:63], v[188:191]
    ds_read_b64_tr_b16 v[242:243], v17 offset:38912
    s_waitcnt lgkmcnt(6)
    v_mfma_f32_16x16x32_bf16 v[192:195], v[228:231], v[56:59], v[192:195]
    ds_read_b64_tr_b16 v[244:245], v18 offset:36864
    v_mfma_f32_16x16x32_bf16 v[196:199], v[228:231], v[60:63], v[196:199]
    ds_read_b64_tr_b16 v[246:247], v18 offset:38912
    s_waitcnt vmcnt(4)
    s_barrier
    v_mov_b32 v16, 1
    buffer_store_dword v16, v14, s[28:31], s56 offen sc1
    s_waitcnt lgkmcnt(6)
    v_mfma_f32_16x16x32_bf16 v[168:171], v[232:235], v[64:67], v[168:171]
    ds_read_b64_tr_b16 v[216:217], v17 offset:40960
    v_mfma_f32_16x16x32_bf16 v[172:175], v[232:235], v[68:71], v[172:175]
    ds_read_b64_tr_b16 v[218:219], v17 offset:43008
    s_add_u32 m0, s18, 8192
    s_add_u32 s48, s36, 1917312
    buffer_load_dwordx4 v1, s[20:23], s48 offen lds
    s_waitcnt lgkmcnt(6)
    v_mfma_f32_16x16x32_bf16 v[176:179], v[236:239], v[64:67], v[176:179]
    ds_read_b64_tr_b16 v[220:221], v18 offset:40960
    v_mfma_f32_16x16x32_bf16 v[180:183], v[236:239], v[68:71], v[180:183]
    ds_read_b64_tr_b16 v[222:223], v18 offset:43008
    s_waitcnt lgkmcnt(6)
    v_mfma_f32_16x16x32_bf16 v[184:187], v[240:243], v[64:67], v[184:187]
    ds_read_b64_tr_b16 v[224:225], v17 offset:45056
    v_mfma_f32_16x16x32_bf16 v[188:191], v[240:243], v[68:71], v[188:191]
    ds_read_b64_tr_b16 v[226:227], v17 offset:47104
    s_waitcnt lgkmcnt(6)
    v_mfma_f32_16x16x32_bf16 v[192:195], v[244:247], v[64:67], v[192:195]
    ds_read_b64_tr_b16 v[228:229], v18 offset:45056
    v_mfma_f32_16x16x32_bf16 v[196:199], v[244:247], v[68:71], v[196:199]
    ds_read_b64_tr_b16 v[230:231], v18 offset:47104
    s_waitcnt lgkmcnt(6)
    v_mfma_f32_16x16x32_bf16 v[168:171], v[216:219], v[72:75], v[168:171]
    ds_read_b64_tr_b16 v[232:233], v19 offset:0
    v_mfma_f32_16x16x32_bf16 v[172:175], v[216:219], v[76:79], v[172:175]
    ds_read_b64_tr_b16 v[234:235], v19 offset:2048
    s_add_u32 m0, s18, 16384
    s_add_u32 s48, s36, 2064768
    buffer_load_dwordx4 v1, s[20:23], s48 offen lds
    s_waitcnt lgkmcnt(6)
    v_mfma_f32_16x16x32_bf16 v[176:179], v[220:223], v[72:75], v[176:179]
    ds_read_b64_tr_b16 v[236:237], v20 offset:0
    v_mfma_f32_16x16x32_bf16 v[180:183], v[220:223], v[76:79], v[180:183]
    ds_read_b64_tr_b16 v[238:239], v20 offset:2048
    s_waitcnt lgkmcnt(6)
    v_mfma_f32_16x16x32_bf16 v[184:187], v[224:227], v[72:75], v[184:187]
    ds_read_b64_tr_b16 v[240:241], v19 offset:4096
    v_mfma_f32_16x16x32_bf16 v[188:191], v[224:227], v[76:79], v[188:191]
    ds_read_b64_tr_b16 v[242:243], v19 offset:6144
    s_waitcnt lgkmcnt(6)
    v_mfma_f32_16x16x32_bf16 v[192:195], v[228:231], v[72:75], v[192:195]
    ds_read_b64_tr_b16 v[244:245], v20 offset:4096
    v_mfma_f32_16x16x32_bf16 v[196:199], v[228:231], v[76:79], v[196:199]
    ds_read_b64_tr_b16 v[246:247], v20 offset:6144
    s_waitcnt lgkmcnt(6)
    v_mfma_f32_16x16x32_bf16 v[168:171], v[232:235], v[80:83], v[168:171]
    ds_read_b64_tr_b16 v[216:217], v19 offset:8192
    v_mfma_f32_16x16x32_bf16 v[172:175], v[232:235], v[84:87], v[172:175]
    ds_read_b64_tr_b16 v[218:219], v19 offset:10240
    s_add_u32 m0, s18, 24576
    s_add_u32 s48, s36, 2212224
    buffer_load_dwordx4 v1, s[20:23], s48 offen lds
    s_waitcnt lgkmcnt(6)
    v_mfma_f32_16x16x32_bf16 v[176:179], v[236:239], v[80:83], v[176:179]
    ds_read_b64_tr_b16 v[220:221], v20 offset:8192
    v_mfma_f32_16x16x32_bf16 v[180:183], v[236:239], v[84:87], v[180:183]
    ds_read_b64_tr_b16 v[222:223], v20 offset:10240
    s_waitcnt lgkmcnt(6)
    v_mfma_f32_16x16x32_bf16 v[184:187], v[240:243], v[80:83], v[184:187]
    ds_read_b64_tr_b16 v[224:225], v19 offset:12288
    v_mfma_f32_16x16x32_bf16 v[188:191], v[240:243], v[84:87], v[188:191]
    ds_read_b64_tr_b16 v[226:227], v19 offset:14336
    s_waitcnt lgkmcnt(6)
    v_mfma_f32_16x16x32_bf16 v[192:195], v[244:247], v[80:83], v[192:195]
    ds_read_b64_tr_b16 v[228:229], v20 offset:12288
    v_mfma_f32_16x16x32_bf16 v[196:199], v[244:247], v[84:87], v[196:199]
    ds_read_b64_tr_b16 v[230:231], v20 offset:14336
    s_waitcnt vmcnt(5)
    s_barrier
    s_waitcnt lgkmcnt(6)
    v_mfma_f32_16x16x32_bf16 v[168:171], v[216:219], v[88:91], v[168:171]
    ds_read_b64_tr_b16 v[232:233], v19 offset:16384
    v_mfma_f32_16x16x32_bf16 v[172:175], v[216:219], v[92:95], v[172:175]
    ds_read_b64_tr_b16 v[234:235], v19 offset:18432
    s_add_u32 m0, s18, 32768
    s_add_u32 s48, s36, 2359680
    buffer_load_dwordx4 v1, s[20:23], s48 offen lds
    s_waitcnt lgkmcnt(6)
    v_mfma_f32_16x16x32_bf16 v[176:179], v[220:223], v[88:91], v[176:179]
    ds_read_b64_tr_b16 v[236:237], v20 offset:16384
    v_mfma_f32_16x16x32_bf16 v[180:183], v[220:223], v[92:95], v[180:183]
    ds_read_b64_tr_b16 v[238:239], v20 offset:18432
    s_waitcnt lgkmcnt(6)
    v_mfma_f32_16x16x32_bf16 v[184:187], v[224:227], v[88:91], v[184:187]
    ds_read_b64_tr_b16 v[240:241], v19 offset:20480
    v_mfma_f32_16x16x32_bf16 v[188:191], v[224:227], v[92:95], v[188:191]
    ds_read_b64_tr_b16 v[242:243], v19 offset:22528
    s_waitcnt lgkmcnt(6)
    v_mfma_f32_16x16x32_bf16 v[192:195], v[228:231], v[88:91], v[192:195]
    ds_read_b64_tr_b16 v[244:245], v20 offset:20480
    v_mfma_f32_16x16x32_bf16 v[196:199], v[228:231], v[92:95], v[196:199]
    ds_read_b64_tr_b16 v[246:247], v20 offset:22528
    s_waitcnt lgkmcnt(6)
    v_mfma_f32_16x16x32_bf16 v[168:171], v[232:235], v[96:99], v[168:171]
    ds_read_b64_tr_b16 v[216:217], v19 offset:24576
    v_mfma_f32_16x16x32_bf16 v[172:175], v[232:235], v[100:103], v[172:175]
    ds_read_b64_tr_b16 v[218:219], v19 offset:26624
    s_add_u32 m0, s18, 40960
    s_add_u32 s48, s36, 2507136
    buffer_load_dwordx4 v1, s[20:23], s48 offen lds
    s_waitcnt lgkmcnt(6)
    v_mfma_f32_16x16x32_bf16 v[176:179], v[236:239], v[96:99], v[176:179]
    ds_read_b64_tr_b16 v[220:221], v20 offset:24576
    v_mfma_f32_16x16x32_bf16 v[180:183], v[236:239], v[100:103], v[180:183]
    ds_read_b64_tr_b16 v[222:223], v20 offset:26624
    s_waitcnt lgkmcnt(6)
    v_mfma_f32_16x16x32_bf16 v[184:187], v[240:243], v[96:99], v[184:187]
    ds_read_b64_tr_b16 v[224:225], v19 offset:28672
    v_mfma_f32_16x16x32_bf16 v[188:191], v[240:243], v[100:103], v[188:191]
    ds_read_b64_tr_b16 v[226:227], v19 offset:30720
    s_waitcnt lgkmcnt(6)
    v_mfma_f32_16x16x32_bf16 v[192:195], v[244:247], v[96:99], v[192:195]
    ds_read_b64_tr_b16 v[228:229], v20 offset:28672
    v_mfma_f32_16x16x32_bf16 v[196:199], v[244:247], v[100:103], v[196:199]
    ds_read_b64_tr_b16 v[230:231], v20 offset:30720
    s_waitcnt lgkmcnt(6)
    v_mfma_f32_16x16x32_bf16 v[168:171], v[216:219], v[104:107], v[168:171]
    ds_read_b64_tr_b16 v[232:233], v19 offset:32768
    v_mfma_f32_16x16x32_bf16 v[172:175], v[216:219], v[108:111], v[172:175]
    ds_read_b64_tr_b16 v[234:235], v19 offset:34816
    s_add_u32 m0, s18, 49152
    s_add_u32 s48, s37, 0
    buffer_load_dwordx4 v2, s[20:23], s48 offen lds
    s_waitcnt lgkmcnt(6)
    v_mfma_f32_16x16x32_bf16 v[176:179], v[220:223], v[104:107], v[176:179]
    ds_read_b64_tr_b16 v[236:237], v20 offset:32768
    v_mfma_f32_16x16x32_bf16 v[180:183], v[220:223], v[108:111], v[180:183]
    ds_read_b64_tr_b16 v[238:239], v20 offset:34816
    s_waitcnt lgkmcnt(6)
    v_mfma_f32_16x16x32_bf16 v[184:187], v[224:227], v[104:107], v[184:187]
    ds_read_b64_tr_b16 v[240:241], v19 offset:36864
    v_mfma_f32_16x16x32_bf16 v[188:191], v[224:227], v[108:111], v[188:191]
    ds_read_b64_tr_b16 v[242:243], v19 offset:38912
    s_waitcnt lgkmcnt(6)
    v_mfma_f32_16x16x32_bf16 v[192:195], v[228:231], v[104:107], v[192:195]
    ds_read_b64_tr_b16 v[244:245], v20 offset:36864
    v_mfma_f32_16x16x32_bf16 v[196:199], v[228:231], v[108:111], v[196:199]
    ds_read_b64_tr_b16 v[246:247], v20 offset:38912
    s_waitcnt vmcnt(4)
    s_barrier
    s_waitcnt lgkmcnt(6)
    v_mfma_f32_16x16x32_bf16 v[168:171], v[232:235], v[112:115], v[168:171]
    ds_read_b64_tr_b16 v[216:217], v17 offset:0
    v_mfma_f32_16x16x32_bf16 v[172:175], v[232:235], v[116:119], v[172:175]
    ds_read_b64_tr_b16 v[218:219], v17 offset:2048
    s_add_u32 m0, s18, 57344
    s_add_u32 s48, s37, 294912
    buffer_load_dwordx4 v2, s[20:23], s48 offen lds
    s_waitcnt lgkmcnt(6)
    v_mfma_f32_16x16x32_bf16 v[176:179], v[236:239], v[112:115], v[176:179]
    ds_read_b64_tr_b16 v[220:221], v18 offset:0
    v_mfma_f32_16x16x32_bf16 v[180:183], v[236:239], v[116:119], v[180:183]
    ds_read_b64_tr_b16 v[222:223], v18 offset:2048
    s_waitcnt lgkmcnt(6)
    v_mfma_f32_16x16x32_bf16 v[184:187], v[240:243], v[112:115], v[184:187]
    ds_read_b64_tr_b16 v[224:225], v17 offset:4096
    v_mfma_f32_16x16x32_bf16 v[188:191], v[240:243], v[116:119], v[188:191]
    ds_read_b64_tr_b16 v[226:227], v17 offset:6144
    s_waitcnt lgkmcnt(6)
    v_mfma_f32_16x16x32_bf16 v[192:195], v[244:247], v[112:115], v[192:195]
    ds_read_b64_tr_b16 v[228:229], v18 offset:4096
    v_mfma_f32_16x16x32_bf16 v[196:199], v[244:247], v[116:119], v[196:199]
    ds_read_b64_tr_b16 v[230:231], v18 offset:6144
    s_waitcnt lgkmcnt(6)
    v_mfma_f32_16x16x32_bf16 v[168:171], v[216:219], v[120:123], v[168:171]
    ds_read_b64_tr_b16 v[232:233], v17 offset:8192
    v_mfma_f32_16x16x32_bf16 v[172:175], v[216:219], v[124:127], v[172:175]
    ds_read_b64_tr_b16 v[234:235], v17 offset:10240
    s_add_u32 m0, s18, 65536
    s_add_u32 s48, s37, 589824
    buffer_load_dwordx4 v2, s[20:23], s48 offen lds
    s_waitcnt lgkmcnt(6)
    v_mfma_f32_16x16x32_bf16 v[176:179], v[220:223], v[120:123], v[176:179]
    ds_read_b64_tr_b16 v[236:237], v18 offset:8192
    v_mfma_f32_16x16x32_bf16 v[180:183], v[220:223], v[124:127], v[180:183]
    ds_read_b64_tr_b16 v[238:239], v18 offset:10240
    buffer_load_dword v13, off, s[28:31], s19 sc1
    s_waitcnt lgkmcnt(6)
    v_mfma_f32_16x16x32_bf16 v[184:187], v[224:227], v[120:123], v[184:187]
    ds_read_b64_tr_b16 v[240:241], v17 offset:12288
    v_mfma_f32_16x16x32_bf16 v[188:191], v[224:227], v[124:127], v[188:191]
    ds_read_b64_tr_b16 v[242:243], v17 offset:14336
    s_waitcnt lgkmcnt(6)
    v_mfma_f32_16x16x32_bf16 v[192:195], v[228:231], v[120:123], v[192:195]
    ds_read_b64_tr_b16 v[244:245], v18 offset:12288
    v_mfma_f32_16x16x32_bf16 v[196:199], v[228:231], v[124:127], v[196:199]
    ds_read_b64_tr_b16 v[246:247], v18 offset:14336
    s_waitcnt lgkmcnt(6)
    v_mfma_f32_16x16x32_bf16 v[168:171], v[232:235], v[128:131], v[168:171]
    ds_read_b64_tr_b16 v[216:217], v17 offset:16384
    v_mfma_f32_16x16x32_bf16 v[172:175], v[232:235], v[132:135], v[172:175]
    ds_read_b64_tr_b16 v[218:219], v17 offset:18432
    s_add_u32 m0, s18, 73728
    s_add_u32 s48, s37, 884736
    buffer_load_dwordx4 v2, s[20:23], s48 offen lds
    s_waitcnt lgkmcnt(6)
    v_mfma_f32_16x16x32_bf16 v[176:179], v[236:239], v[128:131], v[176:179]
    ds_read_b64_tr_b16 v[220:221], v18 offset:16384
    v_mfma_f32_16x16x32_bf16 v[180:183], v[236:239], v[132:135], v[180:183]
    ds_read_b64_tr_b16 v[222:223], v18 offset:18432
    s_waitcnt lgkmcnt(6)
    v_mfma_f32_16x16x32_bf16 v[184:187], v[240:243], v[128:131], v[184:187]
    ds_read_b64_tr_b16 v[224:225], v17 offset:20480
    v_mfma_f32_16x16x32_bf16 v[188:191], v[240:243], v[132:135], v[188:191]
    ds_read_b64_tr_b16 v[226:227], v17 offset:22528
    s_waitcnt lgkmcnt(6)
    v_mfma_f32_16x16x32_bf16 v[192:195], v[244:247], v[128:131], v[192:195]
    ds_read_b64_tr_b16 v[228:229], v18 offset:20480
    v_mfma_f32_16x16x32_bf16 v[196:199], v[244:247], v[132:135], v[196:199]
    ds_read_b64_tr_b16 v[230:231], v18 offset:22528
    s_waitcnt vmcnt(5)
    s_barrier
    s_waitcnt lgkmcnt(6)
    v_mfma_f32_16x16x32_bf16 v[168:171], v[216:219], v[136:139], v[168:171]
    ds_read_b64_tr_b16 v[232:233], v17 offset:24576
    v_mfma_f32_16x16x32_bf16 v[172:175], v[216:219], v[140:143], v[172:175]
    ds_read_b64_tr_b16 v[234:235], v17 offset:26624
    s_add_u32 m0, s18, 81920
    s_add_u32 s48, s37, 1179648
    buffer_load_dwordx4 v2, s[20:23], s48 offen lds
    s_waitcnt lgkmcnt(6)
    v_mfma_f32_16x16x32_bf16 v[176:179], v[220:223], v[136:139], v[176:179]
    ds_read_b64_tr_b16 v[236:237], v18 offset:24576
    v_mfma_f32_16x16x32_bf16 v[180:183], v[220:223], v[140:143], v[180:183]
    ds_read_b64_tr_b16 v[238:239], v18 offset:26624
    s_waitcnt lgkmcnt(6)
    v_mfma_f32_16x16x32_bf16 v[184:187], v[224:227], v[136:139], v[184:187]
    ds_read_b64_tr_b16 v[240:241], v17 offset:28672
    v_mfma_f32_16x16x32_bf16 v[188:191], v[224:227], v[140:143], v[188:191]
    ds_read_b64_tr_b16 v[242:243], v17 offset:30720
    s_waitcnt lgkmcnt(6)
    v_mfma_f32_16x16x32_bf16 v[192:195], v[228:231], v[136:139], v[192:195]
    ds_read_b64_tr_b16 v[244:245], v18 offset:28672
    v_mfma_f32_16x16x32_bf16 v[196:199], v[228:231], v[140:143], v[196:199]
    ds_read_b64_tr_b16 v[246:247], v18 offset:30720
    s_waitcnt lgkmcnt(6)
    v_mfma_f32_16x16x32_bf16 v[168:171], v[232:235], v[144:147], v[168:171]
    ds_read_b64_tr_b16 v[216:217], v17 offset:32768
    v_mfma_f32_16x16x32_bf16 v[172:175], v[232:235], v[148:151], v[172:175]
    ds_read_b64_tr_b16 v[218:219], v17 offset:34816
    s_add_u32 m0, s18, 0
    s_add_u32 s48, s37, 1474560
    buffer_load_dwordx4 v2, s[20:23], s48 offen lds
    s_waitcnt lgkmcnt(6)
    v_mfma_f32_16x16x32_bf16 v[176:179], v[236:239], v[144:147], v[176:179]
    ds_read_b64_tr_b16 v[220:221], v18 offset:32768
    v_mfma_f32_16x16x32_bf16 v[180:183], v[236:239], v[148:151], v[180:183]
    ds_read_b64_tr_b16 v[222:223], v18 offset:34816
    s_waitcnt lgkmcnt(6)
    v_mfma_f32_16x16x32_bf16 v[184:187], v[240:243], v[144:147], v[184:187]
    ds_read_b64_tr_b16 v[224:225], v17 offset:36864
    v_mfma_f32_16x16x32_bf16 v[188:191], v[240:243], v[148:151], v[188:191]
    ds_read_b64_tr_b16 v[226:227], v17 offset:38912
    s_waitcnt lgkmcnt(6)
    v_mfma_f32_16x16x32_bf16 v[192:195], v[244:247], v[144:147], v[192:195]
    ds_read_b64_tr_b16 v[228:229], v18 offset:36864
    v_mfma_f32_16x16x32_bf16 v[196:199], v[244:247], v[148:151], v[196:199]
    ds_read_b64_tr_b16 v[230:231], v18 offset:38912
    s_waitcnt lgkmcnt(6)
    v_mfma_f32_16x16x32_bf16 v[168:171], v[216:219], v[152:155], v[168:171]
    ds_read_b64_tr_b16 v[232:233], v17 offset:40960
    v_mfma_f32_16x16x32_bf16 v[172:175], v[216:219], v[156:159], v[172:175]
    ds_read_b64_tr_b16 v[234:235], v17 offset:43008
    s_add_u32 m0, s18, 8192
    s_add_u32 s48, s37, 1769472
    buffer_load_dwordx4 v2, s[20:23], s48 offen lds
    s_waitcnt lgkmcnt(6)
    v_mfma_f32_16x16x32_bf16 v[176:179], v[220:223], v[152:155], v[176:179]
    ds_read_b64_tr_b16 v[236:237], v18 offset:40960
    v_mfma_f32_16x16x32_bf16 v[180:183], v[220:223], v[156:159], v[180:183]
    ds_read_b64_tr_b16 v[238:239], v18 offset:43008
    s_waitcnt lgkmcnt(6)
    v_mfma_f32_16x16x32_bf16 v[184:187], v[224:227], v[152:155], v[184:187]
    ds_read_b64_tr_b16 v[240:241], v17 offset:45056
    v_mfma_f32_16x16x32_bf16 v[188:191], v[224:227], v[156:159], v[188:191]
    ds_read_b64_tr_b16 v[242:243], v17 offset:47104
    s_waitcnt lgkmcnt(6)
    v_mfma_f32_16x16x32_bf16 v[192:195], v[228:231], v[152:155], v[192:195]
    ds_read_b64_tr_b16 v[244:245], v18 offset:45056
    v_mfma_f32_16x16x32_bf16 v[196:199], v[228:231], v[156:159], v[196:199]
    ds_read_b64_tr_b16 v[246:247], v18 offset:47104
    s_waitcnt vmcnt(5)
    s_barrier
    s_waitcnt lgkmcnt(6)
    v_mfma_f32_16x16x32_bf16 v[168:171], v[232:235], v[160:163], v[168:171]
    ds_read_b64_tr_b16 v[216:217], v22 offset:0
    v_mfma_f32_16x16x32_bf16 v[172:175], v[232:235], v[164:167], v[172:175]
    ds_read_b64_tr_b16 v[218:219], v22 offset:1024
    s_add_u32 m0, s18, 16384
    s_add_u32 s48, s37, 2064384
    buffer_load_dwordx4 v2, s[20:23], s48 offen lds
    s_waitcnt lgkmcnt(6)
    v_mfma_f32_16x16x32_bf16 v[176:179], v[236:239], v[160:163], v[176:179]
    ds_read_b64_tr_b16 v[220:221], v22 offset:4096
    v_mfma_f32_16x16x32_bf16 v[180:183], v[236:239], v[164:167], v[180:183]
    ds_read_b64_tr_b16 v[222:223], v22 offset:5120
    s_waitcnt lgkmcnt(6)
    v_mfma_f32_16x16x32_bf16 v[184:187], v[240:243], v[160:163], v[184:187]
    ds_read_b64_tr_b16 v[224:225], v22 offset:2048
    v_mfma_f32_16x16x32_bf16 v[188:191], v[240:243], v[164:167], v[188:191]
    ds_read_b64_tr_b16 v[226:227], v22 offset:3072
    s_waitcnt lgkmcnt(6)
    v_mfma_f32_16x16x32_bf16 v[192:195], v[244:247], v[160:163], v[192:195]
    ds_read_b64_tr_b16 v[228:229], v22 offset:6144
    v_mfma_f32_16x16x32_bf16 v[196:199], v[244:247], v[164:167], v[196:199]
    ds_read_b64_tr_b16 v[230:231], v22 offset:7168
    v_mul_f32 v168, v168, v184
    v_mul_f32 v169, v169, v185
    v_mul_f32 v170, v170, v186
    v_mul_f32 v171, v171, v187
    v_cvt_pk_bf16_f32 v232, v168, v169
    v_cvt_pk_bf16_f32 v233, v170, v171
    v_mul_f32 v176, v176, v192
    v_mul_f32 v177, v177, v193
    v_mul_f32 v178, v178, v194
    v_mul_f32 v179, v179, v195
    v_cvt_pk_bf16_f32 v234, v176, v177
    v_cvt_pk_bf16_f32 v235, v178, v179
    ds_write_b128 v6, v[232:235] offset:49152
    s_add_u32 s49, s88, 49152
    buffer_store_dwordx4 v[232:235], v4, s[84:87], s49 offen sc1
    v_mul_f32 v172, v172, v188
    v_mul_f32 v173, v173, v189
    v_mul_f32 v174, v174, v190
    v_mul_f32 v175, v175, v191
    v_cvt_pk_bf16_f32 v236, v172, v173
    v_cvt_pk_bf16_f32 v237, v174, v175
    v_mul_f32 v180, v180, v196
    v_mul_f32 v181, v181, v197
    v_mul_f32 v182, v182, v198
    v_mul_f32 v183, v183, v199
    v_cvt_pk_bf16_f32 v238, v180, v181
    v_cvt_pk_bf16_f32 v239, v182, v183
    ds_write_b128 v6, v[236:239] offset:50176
    s_add_u32 s49, s88, 50176
    buffer_store_dwordx4 v[236:239], v4, s[84:87], s49 offen sc1
    s_waitcnt lgkmcnt(8)
    v_mfma_f32_16x16x32_bf16 v[168:171], v[216:219], v[24:27], 0
    ds_read_b64_tr_b16 v[232:233], v22 offset:8192
    v_mfma_f32_16x16x32_bf16 v[172:175], v[216:219], v[28:31], 0
    ds_read_b64_tr_b16 v[234:235], v22 offset:9216
    s_add_u32 m0, s18, 24576
    s_add_u32 s48, s37, 2359296
    buffer_load_dwordx4 v2, s[20:23], s48 offen lds
    s_waitcnt lgkmcnt(8)
    v_mfma_f32_16x16x32_bf16 v[184:187], v[220:223], v[24:27], 0
    ds_read_b64_tr_b16 v[236:237], v22 offset:12288
    v_mfma_f32_16x16x32_bf16 v[188:191], v[220:223], v[28:31], 0
    ds_read_b64_tr_b16 v[238:239], v22 offset:13312
    s_waitcnt lgkmcnt(8)
    v_mfma_f32_16x16x32_bf16 v[168:171], v[224:227], v[32:35], v[168:171]
    ds_read_b64_tr_b16 v[240:241], v22 offset:10240
    v_mfma_f32_16x16x32_bf16 v[172:175], v[224:227], v[36:39], v[172:175]
    ds_read_b64_tr_b16 v[242:243], v22 offset:11264
    s_waitcnt lgkmcnt(8)
    v_mfma_f32_16x16x32_bf16 v[184:187], v[228:231], v[32:35], v[184:187]
    ds_read_b64_tr_b16 v[244:245], v22 offset:14336
    v_mfma_f32_16x16x32_bf16 v[188:191], v[228:231], v[36:39], v[188:191]
    ds_read_b64_tr_b16 v[246:247], v22 offset:15360
    s_waitcnt lgkmcnt(6)
    v_mfma_f32_16x16x32_bf16 v[168:171], v[232:235], v[40:43], v[168:171]
    ds_read_b64_tr_b16 v[216:217], v22 offset:16384
    v_mfma_f32_16x16x32_bf16 v[172:175], v[232:235], v[44:47], v[172:175]
    ds_read_b64_tr_b16 v[218:219], v22 offset:17408
    s_add_u32 m0, s18, 32768
    s_add_u32 s48, s50, 0
    buffer_load_dwordx4 v3, s[24:27], s48 offen lds
    s_waitcnt lgkmcnt(6)
    v_mfma_f32_16x16x32_bf16 v[184:187], v[236:239], v[40:43], v[184:187]
    ds_read_b64_tr_b16 v[220:221], v22 offset:20480
    v_mfma_f32_16x16x32_bf16 v[188:191], v[236:239], v[44:47], v[188:191]
    ds_read_b64_tr_b16 v[222:223], v22 offset:21504
    s_waitcnt lgkmcnt(6)
    v_mfma_f32_16x16x32_bf16 v[168:171], v[240:243], v[48:51], v[168:171]
    ds_read_b64_tr_b16 v[224:225], v22 offset:18432
    v_mfma_f32_16x16x32_bf16 v[172:175], v[240:243], v[52:55], v[172:175]
    ds_read_b64_tr_b16 v[226:227], v22 offset:19456
    s_waitcnt lgkmcnt(6)
    v_mfma_f32_16x16x32_bf16 v[184:187], v[244:247], v[48:51], v[184:187]
    ds_read_b64_tr_b16 v[228:229], v22 offset:22528
    v_mfma_f32_16x16x32_bf16 v[188:191], v[244:247], v[52:55], v[188:191]
    ds_read_b64_tr_b16 v[230:231], v22 offset:23552
    s_waitcnt vmcnt(9)
    v_cmp_gt_u32 vcc, 1, v13
    s_cbranch_vccz K4_ok0
    s_mov_b32 s48, 0x100000
K4_sp0:
    buffer_load_dword v13, off, s[28:31], s19 sc1
    s_sub_u32 s48, s48, 1
    s_cbranch_scc1 K4_ok0
    s_waitcnt vmcnt(0)
    v_cmp_gt_u32 vcc, 1, v13
    s_cbranch_vccnz K4_sp0
K4_ok0:
    s_waitcnt vmcnt(6)
    s_barrier
    s_waitcnt lgkmcnt(6)
    v_mfma_f32_16x16x32_bf16 v[168:171], v[216:219], v[56:59], v[168:171]
    ds_read_b64_tr_b16 v[232:233], v22 offset:24576
    v_mfma_f32_16x16x32_bf16 v[172:175], v[216:219], v[60:63], v[172:175]
    ds_read_b64_tr_b16 v[234:235], v22 offset:25600
    s_add_u32 m0, s18, 40960
    s_add_u32 s48, s50, 128
    buffer_load_dwordx4 v3, s[24:27], s48 offen lds
    s_waitcnt lgkmcnt(6)
    v_mfma_f32_16x16x32_bf16 v[184:187], v[220:223], v[56:59], v[184:187]
    ds_read_b64_tr_b16 v[236:237], v22 offset:28672
    v_mfma_f32_16x16x32_bf16 v[188:191], v[220:223], v[60:63], v[188:191]
    ds_read_b64_tr_b16 v[238:239], v22 offset:29696
    s_add_u32 s49, s89, 0
    buffer_load_dwordx4 v[24:27], v4, s[84:87], s49 offen sc1
    s_waitcnt lgkmcnt(6)
    v_mfma_f32_16x16x32_bf16 v[168:171], v[224:227], v[64:67], v[168:171]
    ds_read_b64_tr_b16 v[240:241], v22 offset:26624
    v_mfma_f32_16x16x32_bf16 v[172:175], v[224:227], v[68:71], v[172:175]
    ds_read_b64_tr_b16 v[242:243], v22 offset:27648
    s_waitcnt lgkmcnt(6)
    v_mfma_f32_16x16x32_bf16 v[184:187], v[228:231], v[64:67], v[184:187]
    ds_read_b64_tr_b16 v[244:245], v22 offset:30720
    v_mfma_f32_16x16x32_bf16 v[188:191], v[228:231], v[68:71], v[188:191]
    ds_read_b64_tr_b16 v[246:247], v22 offset:31744
    s_waitcnt lgkmcnt(6)
    v_mfma_f32_16x16x32_bf16 v[168:171], v[232:235], v[72:75], v[168:171]
    ds_read_b64_tr_b16 v[216:217], v22 offset:32768
    v_mfma_f32_16x16x32_bf16 v[172:175], v[232:235], v[76:79], v[172:175]
    ds_read_b64_tr_b16 v[218:219], v22 offset:33792
    s_add_u32 m0, s18, 49152
    s_add_u32 s48, s50, 73728
    buffer_load_dwordx4 v3, s[24:27], s48 offen lds
    s_waitcnt lgkmcnt(6)
    v_mfma_f32_16x16x32_bf16 v[184:187], v[236:239], v[72:75], v[184:187]
    ds_read_b64_tr_b16 v[220:221], v22 offset:36864
    v_mfma_f32_16x16x32_bf16 v[188:191], v[236:239], v[76:79], v[188:191]
    ds_read_b64_tr_b16 v[222:223], v22 offset:37888
    s_add_u32 s49, s89, 1024
    buffer_load_dwordx4 v[28:31], v4, s[84:87], s49 offen sc1
    s_waitcnt lgkmcnt(6)
    v_mfma_f32_16x16x32_bf16 v[168:171], v[240:243], v[80:83], v[168:171]
    ds_read_b64_tr_b16 v[224:225], v22 offset:34816
    v_mfma_f32_16x16x32_bf16 v[172:175], v[240:243], v[84:87], v[172:175]
    ds_read_b64_tr_b16 v[226:227], v22 offset:35840
    s_waitcnt lgkmcnt(6)
    v_mfma_f32_16x16x32_bf16 v[184:187], v[244:247], v[80:83], v[184:187]
    ds_read_b64_tr_b16 v[228:229], v22 offset:38912
    v_mfma_f32_16x16x32_bf16 v[188:191], v[244:247], v[84:87], v[188:191]
    ds_read_b64_tr_b16 v[230:231], v22 offset:39936
    s_waitcnt lgkmcnt(6)
    v_mfma_f32_16x16x32_bf16 v[168:171], v[216:219], v[88:91], v[168:171]
    ds_read_b64_tr_b16 v[232:233], v21 offset:0
    v_mfma_f32_16x16x32_bf16 v[172:175], v[216:219], v[92:95], v[172:175]
    ds_read_b64_tr_b16 v[234:235], v21 offset:1024
    s_add_u32 m0, s18, 57344
    s_add_u32 s48, s50, 73856
    buffer_load_dwordx4 v3, s[24:27], s48 offen lds
    s_waitcnt lgkmcnt(6)
    v_mfma_f32_16x16x32_bf16 v[184:187], v[220:223], v[88:91], v[184:187]
    ds_read_b64_tr_b16 v[236:237], v21 offset:4096
    v_mfma_f32_16x16x32_bf16 v[188:191], v[220:223], v[92:95], v[188:191]
    ds_read_b64_tr_b16 v[238:239], v21 offset:5120
    s_add_u32 s49, s89, 8192
    buffer_load_dwordx4 v[32:35], v4, s[84:87], s49 offen sc1
    s_waitcnt lgkmcnt(6)
    v_mfma_f32_16x16x32_bf16 v[168:171], v[224:227], v[96:99], v[168:171]
    ds_read_b64_tr_b16 v[240:241], v21 offset:2048
    v_mfma_f32_16x16x32_bf16 v[172:175], v[224:227], v[100:103], v[172:175]
    ds_read_b64_tr_b16 v[242:243], v21 offset:3072
    s_waitcnt lgkmcnt(6)
    v_mfma_f32_16x16x32_bf16 v[184:187], v[228:231], v[96:99], v[184:187]
    ds_read_b64_tr_b16 v[244:245], v21 offset:6144
    v_mfma_f32_16x16x32_bf16 v[188:191], v[228:231], v[100:103], v[188:191]
    ds_read_b64_tr_b16 v[246:247], v21 offset:7168
    s_waitcnt vmcnt(7)
    s_barrier
    s_waitcnt lgkmcnt(6)
    v_mfma_f32_16x16x32_bf16 v[168:171], v[232:235], v[104:107], v[168:171]
    ds_read_b64_tr_b16 v[216:217], v21 offset:8192
    v_mfma_f32_16x16x32_bf16 v[172:175], v[232:235], v[108:111], v[172:175]
    ds_read_b64_tr_b16 v[218:219], v21 offset:9216
    s_add_u32 m0, s18, 65536
    s_add_u32 s48, s50, 147456
    buffer_load_dwordx4 v3, s[24:27], s48 offen lds
    s_waitcnt lgkmcnt(6)
    v_mfma_f32_16x16x32_bf16 v[184:187], v[236:239], v[104:107], v[184:187]
    ds_read_b64_tr_b16 v[220:221], v21 offset:12288
    v_mfma_f32_16x16x32_bf16 v[188:191], v[236:239], v[108:111], v[188:191]
    ds_read_b64_tr_b16 v[222:223], v21 offset:13312
    s_add_u32 s49, s89, 9216
    buffer_load_dwordx4 v[36:39], v4, s[84:87], s49 offen sc1
    s_waitcnt lgkmcnt(6)
    v_mfma_f32_16x16x32_bf16 v[168:171], v[240:243], v[112:115], v[168:171]
    ds_read_b64_tr_b16 v[224:225], v21 offset:10240
    v_mfma_f32_16x16x32_bf16 v[172:175], v[240:243], v[116:119], v[172:175]
    ds_read_b64_tr_b16 v[226:227], v21 offset:11264
    s_waitcnt lgkmcnt(6)
    v_mfma_f32_16x16x32_bf16 v[184:187], v[244:247], v[112:115], v[184:187]
    ds_read_b64_tr_b16 v[228:229], v21 offset:14336
    v_mfma_f32_16x16x32_bf16 v[188:191], v[244:247], v[116:119], v[188:191]
    ds_read_b64_tr_b16 v[230:231], v21 offset:15360
    s_waitcnt lgkmcnt(6)
    v_mfma_f32_16x16x32_bf16 v[168:171], v[216:219], v[120:123], v[168:171]
    ds_read_b64_tr_b16 v[232:233], v21 offset:16384
    v_mfma_f32_16x16x32_bf16 v[172:175], v[216:219], v[124:127], v[172:175]
    ds_read_b64_tr_b16 v[234:235], v21 offset:17408
    s_add_u32 m0, s18, 73728
    s_add_u32 s48, s50, 147584
    buffer_load_dwordx4 v3, s[24:27], s48 offen lds
    s_waitcnt lgkmcnt(6)
    v_mfma_f32_16x16x32_bf16 v[184:187], v[220:223], v[120:123], v[184:187]
    ds_read_b64_tr_b16 v[236:237], v21 offset:20480
    v_mfma_f32_16x16x32_bf16 v[188:191], v[220:223], v[124:127], v[188:191]
    ds_read_b64_tr_b16 v[238:239], v21 offset:21504
    s_add_u32 s49, s89, 16384
    buffer_load_dwordx4 v[40:43], v4, s[84:87], s49 offen sc1
    s_waitcnt lgkmcnt(6)
    v_mfma_f32_16x16x32_bf16 v[168:171], v[224:227], v[128:131], v[168:171]
    ds_read_b64_tr_b16 v[240:241], v21 offset:18432
    v_mfma_f32_16x16x32_bf16 v[172:175], v[224:227], v[132:135], v[172:175]
    ds_read_b64_tr_b16 v[242:243], v21 offset:19456
    s_waitcnt lgkmcnt(6)
    v_mfma_f32_16x16x32_bf16 v[184:187], v[228:231], v[128:131], v[184:187]
    ds_read_b64_tr_b16 v[244:245], v21 offset:22528
    v_mfma_f32_16x16x32_bf16 v[188:191], v[228:231], v[132:135], v[188:191]
    ds_read_b64_tr_b16 v[246:247], v21 offset:23552
    s_waitcnt lgkmcnt(6)
    v_mfma_f32_16x16x32_bf16 v[168:171], v[232:235], v[136:139], v[168:171]
    ds_read_b64_tr_b16 v[216:217], v21 offset:24576
    v_mfma_f32_16x16x32_bf16 v[172:175], v[232:235], v[140:143], v[172:175]
    ds_read_b64_tr_b16 v[218:219], v21 offset:25600
    s_add_u32 m0, s18, 81920
    s_add_u32 s48, s50, 221184
    buffer_load_dwordx4 v3, s[24:27], s48 offen lds
    s_waitcnt lgkmcnt(6)
    v_mfma_f32_16x16x32_bf16 v[184:187], v[236:239], v[136:139], v[184:187]
    ds_read_b64_tr_b16 v[220:221], v21 offset:28672
    v_mfma_f32_16x16x32_bf16 v[188:191], v[236:239], v[140:143], v[188:191]
    ds_read_b64_tr_b16 v[222:223], v21 offset:29696
    s_add_u32 s49, s89, 17408
    buffer_load_dwordx4 v[44:47], v4, s[84:87], s49 offen sc1
    s_waitcnt lgkmcnt(6)
    v_mfma_f32_16x16x32_bf16 v[168:171], v[240:243], v[144:147], v[168:171]
    ds_read_b64_tr_b16 v[224:225], v21 offset:26624
    v_mfma_f32_16x16x32_bf16 v[172:175], v[240:243], v[148:151], v[172:175]
    ds_read_b64_tr_b16 v[226:227], v21 offset:27648
    s_waitcnt lgkmcnt(6)
    v_mfma_f32_16x16x32_bf16 v[184:187], v[244:247], v[144:147], v[184:187]
    ds_read_b64_tr_b16 v[228:229], v21 offset:30720
    v_mfma_f32_16x16x32_bf16 v[188:191], v[244:247], v[148:151], v[188:191]
    ds_read_b64_tr_b16 v[230:231], v21 offset:31744
    s_waitcnt vmcnt(9)
    s_barrier
    v_lshrrev_b32 v1, 6, v4
    v_mul_u32_u24 v11, 8064, v1
    v_sub_u32 v1, v2, v11
    s_waitcnt lgkmcnt(6)
    v_mfma_f32_16x16x32_bf16 v[168:171], v[216:219], v[152:155], v[168:171]
    ds_read_b128 v[72:75], v7 offset:0
    ds_read_b128 v[80:83], v7 offset:8192
    v_mfma_f32_16x16x32_bf16 v[172:175], v[216:219], v[156:159], v[172:175]
    ds_read_b128 v[76:79], v7 offset:1024
    ds_read_b128 v[84:87], v7 offset:9216
    s_add_u32 m0, s18, 0
    s_add_u32 s48, s50, 221312
    buffer_load_dwordx4 v3, s[24:27], s48 offen lds
    s_waitcnt lgkmcnt(8)
    v_mfma_f32_16x16x32_bf16 v[184:187], v[220:223], v[152:155], v[184:187]
    ds_read_b64_tr_b16 v[232:233], v17 offset:32768
    ds_read_b64_tr_b16 v[234:235], v17 offset:34816
    v_mfma_f32_16x16x32_bf16 v[188:191], v[220:223], v[156:159], v[188:191]
    ds_read_b64_tr_b16 v[236:237], v18 offset:32768
    ds_read_b64_tr_b16 v[238:239], v18 offset:34816
    s_add_u32 s49, s89, 24576
    buffer_load_dwordx4 v[48:51], v4, s[84:87], s49 offen sc1
    s_waitcnt lgkmcnt(10)
    v_mfma_f32_16x16x32_bf16 v[168:171], v[224:227], v[160:163], v[168:171]
    ds_read_b64_tr_b16 v[240:241], v17 offset:36864
    v_mfma_f32_16x16x32_bf16 v[172:175], v[224:227], v[164:167], v[172:175]
    ds_read_b64_tr_b16 v[242:243], v17 offset:38912
    s_waitcnt lgkmcnt(10)
    v_mfma_f32_16x16x32_bf16 v[184:187], v[228:231], v[160:163], v[184:187]
    ds_read_b64_tr_b16 v[244:245], v18 offset:36864
    v_mfma_f32_16x16x32_bf16 v[188:191], v[228:231], v[164:167], v[188:191]
    ds_read_b64_tr_b16 v[246:247], v18 offset:38912
    s_nop 4
    v_mul_f32 v168, v168, v184
    v_mul_f32 v169, v169, v185
    v_mul_f32 v170, v170, v186
    v_mul_f32 v171, v171, v187
    v_cvt_pk_bf16_f32 v216, v168, v169
    v_cvt_pk_bf16_f32 v217, v170, v171
    ds_write_b64 v8, v[216:217] offset:0
    v_mul_f32 v172, v172, v188
    v_mul_f32 v173, v173, v189
    v_mul_f32 v174, v174, v190
    v_mul_f32 v175, v175, v191
    v_cvt_pk_bf16_f32 v218, v172, v173
    v_cvt_pk_bf16_f32 v219, v174, v175
    ds_write_b64 v8, v[218:219] offset:1024
    buffer_store_dwordx4 v[216:219], v4, s[84:87], s95 offen sc1
    s_waitcnt lgkmcnt(8)
    v_mfma_f32_16x16x32_bf16 v[168:171], v[232:235], v[72:75], 0
    ds_read_b64_tr_b16 v[216:217], v17 offset:40960
    v_mfma_f32_16x16x32_bf16 v[176:179], v[232:235], v[76:79], 0
    ds_read_b64_tr_b16 v[218:219], v17 offset:43008
    s_add_u32 m0, s18, 8192
    s_add_u32 s48, s51, 0
    buffer_load_dwordx4 v3, s[24:27], s48 offen lds
    s_waitcnt lgkmcnt(8)
    v_mfma_f32_16x16x32_bf16 v[172:175], v[236:239], v[72:75], 0
    ds_read_b64_tr_b16 v[220:221], v18 offset:40960
    v_mfma_f32_16x16x32_bf16 v[180:183], v[236:239], v[76:79], 0
    ds_read_b64_tr_b16 v[222:223], v18 offset:43008
    s_add_u32 s49, s89, 25600
    buffer_load_dwordx4 v[52:55], v4, s[84:87], s49 offen sc1
    s_waitcnt lgkmcnt(8)
    v_mfma_f32_16x16x32_bf16 v[168:171], v[240:243], v[80:83], v[168:171]
    ds_read_b64_tr_b16 v[224:225], v17 offset:45056
    v_mfma_f32_16x16x32_bf16 v[176:179], v[240:243], v[84:87], v[176:179]
    ds_read_b64_tr_b16 v[226:227], v17 offset:47104
    s_waitcnt lgkmcnt(8)
    v_mfma_f32_16x16x32_bf16 v[172:175], v[244:247], v[80:83], v[172:175]
    ds_read_b64_tr_b16 v[228:229], v18 offset:45056
    v_mfma_f32_16x16x32_bf16 v[180:183], v[244:247], v[84:87], v[180:183]
    ds_read_b64_tr_b16 v[230:231], v18 offset:47104
    s_waitcnt lgkmcnt(6)
    v_mfma_f32_16x16x32_bf16 v[184:187], v[216:219], v[72:75], 0
    ds_read_b128 v[88:91], v7 offset:16384
    ds_read_b128 v[96:99], v7 offset:24576
    v_mfma_f32_16x16x32_bf16 v[192:195], v[216:219], v[76:79], 0
    ds_read_b128 v[92:95], v7 offset:17408
    ds_read_b128 v[100:103], v7 offset:25600
    s_add_u32 m0, s18, 16384
    s_add_u32 s48, s51, 128
    buffer_load_dwordx4 v3, s[24:27], s48 offen lds
    s_waitcnt lgkmcnt(8)
    v_mfma_f32_16x16x32_bf16 v[188:191], v[220:223], v[72:75], 0
    ds_read_b64_tr_b16 v[232:233], v19 offset:0
    ds_read_b64_tr_b16 v[234:235], v19 offset:2048
    v_mfma_f32_16x16x32_bf16 v[196:199], v[220:223], v[76:79], 0
    ds_read_b64_tr_b16 v[236:237], v20 offset:0
    ds_read_b64_tr_b16 v[238:239], v20 offset:2048
    s_add_u32 s49, s89, 32768
    buffer_load_dwordx4 v[56:59], v4, s[84:87], s49 offen sc1
    s_waitcnt lgkmcnt(10)
    v_mfma_f32_16x16x32_bf16 v[184:187], v[224:227], v[80:83], v[184:187]
    ds_read_b64_tr_b16 v[240:241], v19 offset:4096
    v_mfma_f32_16x16x32_bf16 v[192:195], v[224:227], v[84:87], v[192:195]
    ds_read_b64_tr_b16 v[242:243], v19 offset:6144
    s_waitcnt lgkmcnt(10)
    v_mfma_f32_16x16x32_bf16 v[188:191], v[228:231], v[80:83], v[188:191]
    ds_read_b64_tr_b16 v[244:245], v20 offset:4096
    v_mfma_f32_16x16x32_bf16 v[196:199], v[228:231], v[84:87], v[196:199]
    ds_read_b64_tr_b16 v[246:247], v20 offset:6144
    s_waitcnt vmcnt(10)
    s_barrier
    s_waitcnt lgkmcnt(6)
    v_mfma_f32_16x16x32_bf16 v[168:171], v[232:235], v[88:91], v[168:171]
    ds_read_b64_tr_b16 v[216:217], v19 offset:8192
    v_mfma_f32_16x16x32_bf16 v[176:179], v[232:235], v[92:95], v[176:179]
    ds_read_b64_tr_b16 v[218:219], v19 offset:10240
    s_add_u32 m0, s18, 24576
    s_add_u32 s48, s51, 73728
    buffer_load_dwordx4 v3, s[24:27], s48 offen lds
    s_waitcnt lgkmcnt(6)
    v_mfma_f32_16x16x32_bf16 v[172:175], v[236:239], v[88:91], v[172:175]
    ds_read_b64_tr_b16 v[220:221], v20 offset:8192
    v_mfma_f32_16x16x32_bf16 v[180:183], v[236:239], v[92:95], v[180:183]
    ds_read_b64_tr_b16 v[222:223], v20 offset:10240
    s_add_u32 s49, s89, 33792
    buffer_load_dwordx4 v[60:63], v4, s[84:87], s49 offen sc1
    s_waitcnt lgkmcnt(6)
    v_mfma_f32_16x16x32_bf16 v[168:171], v[240:243], v[96:99], v[168:171]
    ds_read_b64_tr_b16 v[224:225], v19 offset:12288
    v_mfma_f32_16x16x32_bf16 v[176:179], v[240:243], v[100:103], v[176:179]
    ds_read_b64_tr_b16 v[226:227], v19 offset:14336
    s_waitcnt lgkmcnt(6)
    v_mfma_f32_16x16x32_bf16 v[172:175], v[244:247], v[96:99], v[172:175]
    ds_read_b64_tr_b16 v[228:229], v20 offset:12288
    v_mfma_f32_16x16x32_bf16 v[180:183], v[244:247], v[100:103], v[180:183]
    ds_read_b64_tr_b16 v[230:231], v20 offset:14336
    s_waitcnt lgkmcnt(6)
    v_mfma_f32_16x16x32_bf16 v[184:187], v[216:219], v[88:91], v[184:187]
    ds_read_b128 v[104:107], v7 offset:32768
    ds_read_b128 v[112:115], v7 offset:40960
    v_mfma_f32_16x16x32_bf16 v[192:195], v[216:219], v[92:95], v[192:195]
    ds_read_b128 v[108:111], v7 offset:33792
    ds_read_b128 v[116:119], v7 offset:41984
    s_add_u32 m0, s18, 32768
    s_add_u32 s48, s51, 73856
    buffer_load_dwordx4 v3, s[24:27], s48 offen lds
    s_waitcnt lgkmcnt(8)
    v_mfma_f32_16x16x32_bf16 v[188:191], v[220:223], v[88:91], v[188:191]
    ds_read_b64_tr_b16 v[232:233], v19 offset:16384
    ds_read_b64_tr_b16 v[234:235], v19 offset:18432
    v_mfma_f32_16x16x32_bf16 v[196:199], v[220:223], v[92:95], v[196:199]
    ds_read_b64_tr_b16 v[236:237], v20 offset:16384
    ds_read_b64_tr_b16 v[238:239], v20 offset:18432
    s_add_u32 s49, s89, 40960
    buffer_load_dwordx4 v[64:67], v4, s[84:87], s49 offen sc1
    s_waitcnt lgkmcnt(10)
    v_mfma_f32_16x16x32_bf16 v[184:187], v[224:227], v[96:99], v[184:187]
    ds_read_b64_tr_b16 v[240:241], v19 offset:20480
    v_mfma_f32_16x16x32_bf16 v[192:195], v[224:227], v[100:103], v[192:195]
    ds_read_b64_tr_b16 v[242:243], v19 offset:22528
    s_waitcnt lgkmcnt(10)
    v_mfma_f32_16x16x32_bf16 v[188:191], v[228:231], v[96:99], v[188:191]
    ds_read_b64_tr_b16 v[244:245], v20 offset:20480
    v_mfma_f32_16x16x32_bf16 v[196:199], v[228:231], v[100:103], v[196:199]
    ds_read_b64_tr_b16 v[246:247], v20 offset:22528
    s_waitcnt lgkmcnt(6)
    v_mfma_f32_16x16x32_bf16 v[168:171], v[232:235], v[104:107], v[168:171]
    ds_read_b64_tr_b16 v[216:217], v19 offset:24576
    v_mfma_f32_16x16x32_bf16 v[176:179], v[232:235], v[108:111], v[176:179]
    ds_read_b64_tr_b16 v[218:219], v19 offset:26624
    s_add_u32 m0, s18, 40960
    s_add_u32 s48, s51, 147456
    buffer_load_dwordx4 v3, s[24:27], s48 offen lds
    s_waitcnt lgkmcnt(6)
    v_mfma_f32_16x16x32_bf16 v[172:175], v[236:239], v[104:107], v[172:175]
    ds_read_b64_tr_b16 v[220:221], v20 offset:24576
    v_mfma_f32_16x16x32_bf16 v[180:183], v[236:239], v[108:111], v[180:183]
    ds_read_b64_tr_b16 v[222:223], v20 offset:26624
    s_add_u32 s49, s89, 41984
    buffer_load_dwordx4 v[68:71], v4, s[84:87], s49 offen sc1
    s_waitcnt lgkmcnt(6)
    v_mfma_f32_16x16x32_bf16 v[168:171], v[240:243], v[112:115], v[168:171]
    ds_read_b64_tr_b16 v[224:225], v19 offset:28672
    v_mfma_f32_16x16x32_bf16 v[176:179], v[240:243], v[116:119], v[176:179]
    ds_read_b64_tr_b16 v[226:227], v19 offset:30720
    s_waitcnt lgkmcnt(6)
    v_mfma_f32_16x16x32_bf16 v[172:175], v[244:247], v[112:115], v[172:175]
    ds_read_b64_tr_b16 v[228:229], v20 offset:28672
    v_mfma_f32_16x16x32_bf16 v[180:183], v[244:247], v[116:119], v[180:183]
    ds_read_b64_tr_b16 v[230:231], v20 offset:30720
    s_waitcnt vmcnt(9)
    s_barrier
    v_mov_b32 v16, 3
    buffer_store_dword v16, v14, s[28:31], s56 offen sc1
    s_waitcnt lgkmcnt(6)
    v_mfma_f32_16x16x32_bf16 v[184:187], v[216:219], v[104:107], v[184:187]
    ds_read_b128 v[120:123], v7 offset:49152
    ds_read_b128 v[128:131], v7 offset:57344
    v_mfma_f32_16x16x32_bf16 v[192:195], v[216:219], v[108:111], v[192:195]
    ds_read_b128 v[124:127], v7 offset:50176
    ds_read_b128 v[132:135], v7 offset:58368
    s_add_u32 m0, s18, 49152
    s_add_u32 s48, s51, 147584
    buffer_load_dwordx4 v3, s[24:27], s48 offen lds
    s_waitcnt lgkmcnt(8)
    v_mfma_f32_16x16x32_bf16 v[188:191], v[220:223], v[104:107], v[188:191]
    ds_read_b64_tr_b16 v[232:233], v19 offset:32768
    ds_read_b64_tr_b16 v[234:235], v19 offset:34816
    v_mfma_f32_16x16x32_bf16 v[196:199], v[220:223], v[108:111], v[196:199]
    ds_read_b64_tr_b16 v[236:237], v20 offset:32768
    ds_read_b64_tr_b16 v[238:239], v20 offset:34816
    s_waitcnt lgkmcnt(10)
    v_mfma_f32_16x16x32_bf16 v[184:187], v[224:227], v[112:115], v[184:187]
    ds_read_b64_tr_b16 v[240:241], v19 offset:36864
    v_mfma_f32_16x16x32_bf16 v[192:195], v[224:227], v[116:119], v[192:195]
    ds_read_b64_tr_b16 v[242:243], v19 offset:38912
    s_waitcnt lgkmcnt(10)
    v_mfma_f32_16x16x32_bf16 v[188:191], v[228:231], v[112:115], v[188:191]
    ds_read_b64_tr_b16 v[244:245], v20 offset:36864
    v_mfma_f32_16x16x32_bf16 v[196:199], v[228:231], v[116:119], v[196:199]
    ds_read_b64_tr_b16 v[246:247], v20 offset:38912
    s_waitcnt lgkmcnt(6)
    v_mfma_f32_16x16x32_bf16 v[168:171], v[232:235], v[120:123], v[168:171]
    ds_read_b64_tr_b16 v[216:217], v17 offset:0
    v_mfma_f32_16x16x32_bf16 v[176:179], v[232:235], v[124:127], v[176:179]
    ds_read_b64_tr_b16 v[218:219], v17 offset:2048
    s_add_u32 m0, s18, 57344
    s_add_u32 s48, s50, 256
    buffer_load_dwordx4 v3, s[24:27], s48 offen lds
    s_waitcnt lgkmcnt(6)
    v_mfma_f32_16x16x32_bf16 v[172:175], v[236:239], v[120:123], v[172:175]
    ds_read_b64_tr_b16 v[220:221], v18 offset:0
    v_mfma_f32_16x16x32_bf16 v[180:183], v[236:239], v[124:127], v[180:183]
    ds_read_b64_tr_b16 v[222:223], v18 offset:2048
    s_waitcnt lgkmcnt(6)
    v_mfma_f32_16x16x32_bf16 v[168:171], v[240:243], v[128:131], v[168:171]
    ds_read_b64_tr_b16 v[224:225], v17 offset:4096
    v_mfma_f32_16x16x32_bf16 v[176:179], v[240:243], v[132:135], v[176:179]
    ds_read_b64_tr_b16 v[226:227], v17 offset:6144
    s_waitcnt lgkmcnt(6)
    v_mfma_f32_16x16x32_bf16 v[172:175], v[244:247], v[128:131], v[172:175]
    ds_read_b64_tr_b16 v[228:229], v18 offset:4096
    v_mfma_f32_16x16x32_bf16 v[180:183], v[244:247], v[132:135], v[180:183]
    ds_read_b64_tr_b16 v[230:231], v18 offset:6144
    s_waitcnt lgkmcnt(6)
    v_mfma_f32_16x16x32_bf16 v[184:187], v[216:219], v[120:123], v[184:187]
    ds_read_b64_tr_b16 v[232:233], v17 offset:8192
    v_mfma_f32_16x16x32_bf16 v[192:195], v[216:219], v[124:127], v[192:195]
    ds_read_b64_tr_b16 v[234:235], v17 offset:10240
    s_add_u32 m0, s18, 65536
    s_add_u32 s48, s50, 73984
    buffer_load_dwordx4 v3, s[24:27], s48 offen lds
    s_waitcnt lgkmcnt(6)
    v_mfma_f32_16x16x32_bf16 v[188:191], v[220:223], v[120:123], v[188:191]
    ds_read_b64_tr_b16 v[236:237], v18 offset:8192
    v_mfma_f32_16x16x32_bf16 v[196:199], v[220:223], v[124:127], v[196:199]
    ds_read_b64_tr_b16 v[238:239], v18 offset:10240
    s_waitcnt lgkmcnt(6)
    v_mfma_f32_16x16x32_bf16 v[184:187], v[224:227], v[128:131], v[184:187]
    ds_read_b64_tr_b16 v[240:241], v17 offset:12288
    v_mfma_f32_16x16x32_bf16 v[192:195], v[224:227], v[132:135], v[192:195]
    ds_read_b64_tr_b16 v[242:243], v17 offset:14336
    s_waitcnt lgkmcnt(6)
    v_mfma_f32_16x16x32_bf16 v[188:191], v[228:231], v[128:131], v[188:191]
    ds_read_b64_tr_b16 v[244:245], v18 offset:12288
    v_mfma_f32_16x16x32_bf16 v[196:199], v[228:231], v[132:135], v[196:199]
    ds_read_b64_tr_b16 v[246:247], v18 offset:14336
    s_waitcnt vmcnt(7)
    s_barrier
    s_add_u32 s20, s62, 8388608
    s_addc_u32 s21, s63, 0
    s_mov_b32 s22, 18874368
    s_mov_b32 s23, 0x20000
    s_lshr_b32 s80, s15, 1
    s_add_u32 s80, s80, 4
    s_cmp_eq_u32 s80, 7
    s_cselect_b32 s80, 64, s80
    s_lshl_b32 s81, s14, 3
    s_lshr_b32 s82, s12, 1
    s_add_u32 s81, s81, s82
    s_mul_i32 s81, s81, 18
    s_mul_i32 s82, s13, 10
    s_add_u32 s81, s81, s82
    s_add_u32 s81, s81, s15
    s_lshl_b32 s81, s81, 10
    s_mov_b32 s82, 0
    s_lshl_b32 s83, s15, 13
    s_add_u32 s83, s83, 90112
    s_lshr_b32 s3, s12, 1
    s_lshl_b32 s8, s16, 1
    s_cmp_eq_u32 s8, s3
    s_cselect_b64 s[4:5], -1, 0
    s_add_u32 s9, s8, 1
    s_cmp_eq_u32 s9, s3
    s_cselect_b64 s[6:7], -1, 0
    s_add_u32 s8, s8, s17
    s_cmp_eq_u32 s8, s3
    s_cselect_b64 s[8:9], -1, 0
    s_lshl_b32 s48, s17, 13
    s_add_u32 s48, s48, 90112
    v_add_u32 v12, s48, v4
    v_add_u32 v11, 155648, v4
    s_waitcnt lgkmcnt(6)
    v_mfma_f32_16x16x32_bf16 v[168:171], v[232:235], v[24:27], v[168:171]
    ds_read_b64_tr_b16 v[216:217], v17 offset:16384
    v_mfma_f32_16x16x32_bf16 v[176:179], v[232:235], v[28:31], v[176:179]
    ds_read_b64_tr_b16 v[218:219], v17 offset:18432
    s_add_u32 m0, s18, 73728
    s_add_u32 s48, s50, 147712
    buffer_load_dwordx4 v3, s[24:27], s48 offen lds
    s_waitcnt lgkmcnt(6)
    v_mfma_f32_16x16x32_bf16 v[172:175], v[236:239], v[24:27], v[172:175]
    ds_read_b64_tr_b16 v[220:221], v18 offset:16384
    v_mfma_f32_16x16x32_bf16 v[180:183], v[236:239], v[28:31], v[180:183]
    ds_read_b64_tr_b16 v[222:223], v18 offset:18432
    buffer_load_dword v13, off, s[28:31], s19 sc1
    s_waitcnt lgkmcnt(6)
    v_mfma_f32_16x16x32_bf16 v[168:171], v[240:243], v[32:35], v[168:171]
    ds_read_b64_tr_b16 v[224:225], v17 offset:20480
    v_mfma_f32_16x16x32_bf16 v[176:179], v[240:243], v[36:39], v[176:179]
    ds_read_b64_tr_b16 v[226:227], v17 offset:22528
    s_waitcnt lgkmcnt(6)
    v_mfma_f32_16x16x32_bf16 v[172:175], v[244:247], v[32:35], v[172:175]
    ds_read_b64_tr_b16 v[228:229], v18 offset:20480
    v_mfma_f32_16x16x32_bf16 v[180:183], v[244:247], v[36:39], v[180:183]
    ds_read_b64_tr_b16 v[230:231], v18 offset:22528
    s_waitcnt lgkmcnt(6)
    v_mfma_f32_16x16x32_bf16 v[184:187], v[216:219], v[24:27], v[184:187]
    ds_read_b64_tr_b16 v[232:233], v17 offset:24576
    v_mfma_f32_16x16x32_bf16 v[192:195], v[216:219], v[28:31], v[192:195]
    ds_read_b64_tr_b16 v[234:235], v17 offset:26624
    s_add_u32 m0, s18, 81920
    s_add_u32 s48, s51, 221184
    buffer_load_dwordx4 v3, s[24:27], s48 offen lds
    s_waitcnt lgkmcnt(6)
    v_mfma_f32_16x16x32_bf16 v[188:191], v[220:223], v[24:27], v[188:191]
    ds_read_b64_tr_b16 v[236:237], v18 offset:24576
    v_mfma_f32_16x16x32_bf16 v[196:199], v[220:223], v[28:31], v[196:199]
    ds_read_b64_tr_b16 v[238:239], v18 offset:26624
    s_waitcnt lgkmcnt(6)
    v_mfma_f32_16x16x32_bf16 v[184:187], v[224:227], v[32:35], v[184:187]
    ds_read_b64_tr_b16 v[240:241], v17 offset:28672
    v_mfma_f32_16x16x32_bf16 v[192:195], v[224:227], v[36:39], v[192:195]
    ds_read_b64_tr_b16 v[242:243], v17 offset:30720
    s_waitcnt lgkmcnt(6)
    v_mfma_f32_16x16x32_bf16 v[188:191], v[228:231], v[32:35], v[188:191]
    ds_read_b64_tr_b16 v[244:245], v18 offset:28672
    v_mfma_f32_16x16x32_bf16 v[196:199], v[228:231], v[36:39], v[196:199]
    ds_read_b64_tr_b16 v[246:247], v18 offset:30720
    s_waitcnt lgkmcnt(6)
    v_mfma_f32_16x16x32_bf16 v[168:171], v[232:235], v[40:43], v[168:171]
    ds_read_b64_tr_b16 v[216:217], v17 offset:32768
    v_mfma_f32_16x16x32_bf16 v[176:179], v[232:235], v[44:47], v[176:179]
    ds_read_b64_tr_b16 v[218:219], v17 offset:34816
    s_add_u32 m0, s18, 0
    s_add_u32 s48, s52, 0
    buffer_load_dwordx4 v3, s[24:27], s48 offen lds
    s_waitcnt lgkmcnt(6)
    v_mfma_f32_16x16x32_bf16 v[172:175], v[236:239], v[40:43], v[172:175]
    ds_read_b64_tr_b16 v[220:221], v18 offset:32768
    v_mfma_f32_16x16x32_bf16 v[180:183], v[236:239], v[44:47], v[180:183]
    ds_read_b64_tr_b16 v[222:223], v18 offset:34816
    s_waitcnt lgkmcnt(6)
    v_mfma_f32_16x16x32_bf16 v[168:171], v[240:243], v[48:51], v[168:171]
    ds_read_b64_tr_b16 v[224:225], v17 offset:36864
    v_mfma_f32_16x16x32_bf16 v[176:179], v[240:243], v[52:55], v[176:179]
    ds_read_b64_tr_b16 v[226:227], v17 offset:38912
    s_waitcnt lgkmcnt(6)
    v_mfma_f32_16x16x32_bf16 v[172:175], v[244:247], v[48:51], v[172:175]
    ds_read_b64_tr_b16 v[228:229], v18 offset:36864
    v_mfma_f32_16x16x32_bf16 v[180:183], v[244:247], v[52:55], v[180:183]
    ds_read_b64_tr_b16 v[230:231], v18 offset:38912
    s_waitcnt vmcnt(2)
    v_cmp_gt_u32 vcc, 3, v13
    s_cbranch_vccz K4_ok2
    s_mov_b32 s48, 0x100000
K4_sp2:
    buffer_load_dword v13, off, s[28:31], s19 sc1
    s_sub_u32 s48, s48, 1
    s_cbranch_scc1 K4_ok2
    s_waitcnt vmcnt(0)
    v_cmp_gt_u32 vcc, 3, v13
    s_cbranch_vccnz K4_sp2
K4_ok2:
    s_barrier
    s_waitcnt lgkmcnt(6)
    v_mfma_f32_16x16x32_bf16 v[184:187], v[216:219], v[40:43], v[184:187]
    ds_read_b64_tr_b16 v[232:233], v17 offset:40960
    v_mfma_f32_16x16x32_bf16 v[192:195], v[216:219], v[44:47], v[192:195]
    ds_read_b64_tr_b16 v[234:235], v17 offset:43008
    s_add_u32 m0, s18, 8192
    s_add_u32 s48, s51, 221312
    buffer_load_dwordx4 v3, s[24:27], s48 offen lds
    s_waitcnt lgkmcnt(6)
    v_mfma_f32_16x16x32_bf16 v[188:191], v[220:223], v[40:43], v[188:191]
    ds_read_b64_tr_b16 v[236:237], v18 offset:40960
    v_mfma_f32_16x16x32_bf16 v[196:199], v[220:223], v[44:47], v[196:199]
    ds_read_b64_tr_b16 v[238:239], v18 offset:43008
    s_add_u32 s49, s89, 49152
    buffer_load_dwordx4 v[136:139], v4, s[84:87], s49 offen sc1
    s_waitcnt lgkmcnt(6)
    v_mfma_f32_16x16x32_bf16 v[184:187], v[224:227], v[48:51], v[184:187]
    ds_read_b64_tr_b16 v[240:241], v17 offset:45056
    v_mfma_f32_16x16x32_bf16 v[192:195], v[224:227], v[52:55], v[192:195]
    ds_read_b64_tr_b16 v[242:243], v17 offset:47104
    s_add_u32 s49, s89, 50176
    buffer_load_dwordx4 v[140:143], v4, s[84:87], s49 offen sc1
    s_waitcnt lgkmcnt(6)
    v_mfma_f32_16x16x32_bf16 v[188:191], v[228:231], v[48:51], v[188:191]
    ds_read_b64_tr_b16 v[244:245], v18 offset:45056
    v_mfma_f32_16x16x32_bf16 v[196:199], v[228:231], v[52:55], v[196:199]
    ds_read_b64_tr_b16 v[246:247], v18 offset:47104
    s_add_u32 s49, s89, 57344
    buffer_load_dwordx4 v[144:147], v4, s[84:87], s49 offen sc1
    s_add_u32 s49, s89, 58368
    buffer_load_dwordx4 v[148:151], v4, s[84:87], s49 offen sc1
    s_waitcnt lgkmcnt(6)
    v_mfma_f32_16x16x32_bf16 v[168:171], v[232:235], v[56:59], v[168:171]
    ds_read_b64_tr_b16 v[216:217], v19 offset:0
    v_mfma_f32_16x16x32_bf16 v[176:179], v[232:235], v[60:63], v[176:179]
    ds_read_b64_tr_b16 v[218:219], v19 offset:2048
    s_add_u32 m0, s18, 16384
    s_add_u32 s48, s52, 128
    buffer_load_dwordx4 v3, s[24:27], s48 offen lds
    s_waitcnt lgkmcnt(6)
    v_mfma_f32_16x16x32_bf16 v[172:175], v[236:239], v[56:59], v[172:175]
    ds_read_b64_tr_b16 v[220:221], v20 offset:0
    v_mfma_f32_16x16x32_bf16 v[180:183], v[236:239], v[60:63], v[180:183]
    ds_read_b64_tr_b16 v[222:223], v20 offset:2048
    s_add_u32 s49, s89, 65536
    buffer_load_dwordx2 v[160:161], v4, s[84:87], s49 offen offset:0 sc1
    s_waitcnt lgkmcnt(6)
    v_mfma_f32_16x16x32_bf16 v[168:171], v[240:243], v[64:67], v[168:171]
    ds_read_b64_tr_b16 v[224:225], v19 offset:4096
    v_mfma_f32_16x16x32_bf16 v[176:179], v[240:243], v[68:71], v[176:179]
    ds_read_b64_tr_b16 v[226:227], v19 offset:6144
    s_add_u32 s49, s89, 65536
    buffer_load_dwordx2 v[162:163], v4, s[84:87], s49 offen offset:1024 sc1
    s_waitcnt lgkmcnt(6)
    v_mfma_f32_16x16x32_bf16 v[172:175], v[244:247], v[64:67], v[172:175]
    ds_read_b64_tr_b16 v[228:229], v20 offset:4096
    v_mfma_f32_16x16x32_bf16 v[180:183], v[244:247], v[68:71], v[180:183]
    ds_read_b64_tr_b16 v[230:231], v20 offset:6144
    s_add_u32 s49, s89, 65536
    buffer_load_dwordx2 v[164:165], v4, s[84:87], s49 offen offset:8 sc1
    s_add_u32 s49, s89, 65536
    buffer_load_dwordx2 v[166:167], v4, s[84:87], s49 offen offset:1032 sc1
    s_waitcnt lgkmcnt(6)
    v_mfma_f32_16x16x32_bf16 v[184:187], v[216:219], v[56:59], v[184:187]
    ds_read_b64_tr_b16 v[232:233], v19 offset:8192
    v_mfma_f32_16x16x32_bf16 v[192:195], v[216:219], v[60:63], v[192:195]
    ds_read_b64_tr_b16 v[234:235], v19 offset:10240
    s_add_u32 m0, s18, 24576
    s_add_u32 s48, s50, 221440
    buffer_load_dwordx4 v3, s[24:27], s48 offen lds
    s_waitcnt lgkmcnt(6)
    v_mfma_f32_16x16x32_bf16 v[188:191], v[220:223], v[56:59], v[188:191]
    ds_read_b64_tr_b16 v[236:237], v20 offset:8192
    v_mfma_f32_16x16x32_bf16 v[196:199], v[220:223], v[60:63], v[196:199]
    ds_read_b64_tr_b16 v[238:239], v20 offset:10240
    s_waitcnt lgkmcnt(6)
    v_mfma_f32_16x16x32_bf16 v[184:187], v[224:227], v[64:67], v[184:187]
    ds_read_b64_tr_b16 v[240:241], v19 offset:12288
    v_mfma_f32_16x16x32_bf16 v[192:195], v[224:227], v[68:71], v[192:195]
    ds_read_b64_tr_b16 v[242:243], v19 offset:14336
    s_waitcnt lgkmcnt(6)
    v_mfma_f32_16x16x32_bf16 v[188:191], v[228:231], v[64:67], v[188:191]
    ds_read_b64_tr_b16 v[244:245], v20 offset:12288
    v_mfma_f32_16x16x32_bf16 v[196:199], v[228:231], v[68:71], v[196:199]
    ds_read_b64_tr_b16 v[246:247], v20 offset:14336
    s_waitcnt vmcnt(12)
    s_barrier
    s_waitcnt lgkmcnt(6)
    v_mfma_f32_16x16x32_bf16 v[200:203], v[232:235], v[72:75], 0
    ds_read_b64_tr_b16 v[216:217], v19 offset:16384
    v_mfma_f32_16x16x32_bf16 v[208:211], v[232:235], v[76:79], 0
    ds_read_b64_tr_b16 v[218:219], v19 offset:18432
    s_add_u32 m0, s18, 32768
    s_add_u32 s48, s51, 256
    buffer_load_dwordx4 v3, s[24:27], s48 offen lds
    s_waitcnt lgkmcnt(6)
    v_mfma_f32_16x16x32_bf16 v[204:207], v[236:239], v[72:75], 0
    ds_read_b64_tr_b16 v[220:221], v20 offset:16384
    v_mfma_f32_16x16x32_bf16 v[212:215], v[236:239], v[76:79], 0
    ds_read_b64_tr_b16 v[222:223], v20 offset:18432
    s_waitcnt lgkmcnt(6)
    v_mfma_f32_16x16x32_bf16 v[200:203], v[240:243], v[80:83], v[200:203]
    ds_read_b64_tr_b16 v[224:225], v19 offset:20480
    v_mfma_f32_16x16x32_bf16 v[208:211], v[240:243], v[84:87], v[208:211]
    ds_read_b64_tr_b16 v[226:227], v19 offset:22528
    s_waitcnt lgkmcnt(6)
    v_mfma_f32_16x16x32_bf16 v[204:207], v[244:247], v[80:83], v[204:207]
    ds_read_b64_tr_b16 v[228:229], v20 offset:20480
    v_mfma_f32_16x16x32_bf16 v[212:215], v[244:247], v[84:87], v[212:215]
    ds_read_b64_tr_b16 v[230:231], v20 offset:22528
    s_waitcnt lgkmcnt(6)
    v_mfma_f32_16x16x32_bf16 v[200:203], v[216:219], v[88:91], v[200:203]
    ds_read_b64_tr_b16 v[232:233], v19 offset:24576
    v_mfma_f32_16x16x32_bf16 v[208:211], v[216:219], v[92:95], v[208:211]
    ds_read_b64_tr_b16 v[234:235], v19 offset:26624
    s_add_u32 m0, s18, 40960
    s_add_u32 s48, s51, 73984
    buffer_load_dwordx4 v3, s[24:27], s48 offen lds
    s_waitcnt lgkmcnt(6)
    v_mfma_f32_16x16x32_bf16 v[204:207], v[220:223], v[88:91], v[204:207]
    ds_read_b64_tr_b16 v[236:237], v20 offset:24576
    v_mfma_f32_16x16x32_bf16 v[212:215], v[220:223], v[92:95], v[212:215]
    ds_read_b64_tr_b16 v[238:239], v20 offset:26624
    s_waitcnt lgkmcnt(6)
    v_mfma_f32_16x16x32_bf16 v[200:203], v[224:227], v[96:99], v[200:203]
    ds_read_b64_tr_b16 v[240:241], v19 offset:28672
    v_mfma_f32_16x16x32_bf16 v[208:211], v[224:227], v[100:103], v[208:211]
    ds_read_b64_tr_b16 v[242:243], v19 offset:30720
    s_waitcnt lgkmcnt(6)
    v_mfma_f32_16x16x32_bf16 v[204:207], v[228:231], v[96:99], v[204:207]
    ds_read_b64_tr_b16 v[244:245], v20 offset:28672
    v_mfma_f32_16x16x32_bf16 v[212:215], v[228:231], v[100:103], v[212:215]
    ds_read_b64_tr_b16 v[246:247], v20 offset:30720
    s_waitcnt lgkmcnt(6)
    v_mfma_f32_16x16x32_bf16 v[200:203], v[232:235], v[104:107], v[200:203]
    ds_read_b64_tr_b16 v[216:217], v19 offset:32768
    v_mfma_f32_16x16x32_bf16 v[208:211], v[232:235], v[108:111], v[208:211]
    ds_read_b64_tr_b16 v[218:219], v19 offset:34816
    s_add_u32 m0, s18, 49152
    s_add_u32 s48, s51, 147712
    buffer_load_dwordx4 v3, s[24:27], s48 offen lds
    s_waitcnt lgkmcnt(6)
    v_mfma_f32_16x16x32_bf16 v[204:207], v[236:239], v[104:107], v[204:207]
    ds_read_b64_tr_b16 v[220:221], v20 offset:32768
    v_mfma_f32_16x16x32_bf16 v[212:215], v[236:239], v[108:111], v[212:215]
    ds_read_b64_tr_b16 v[222:223], v20 offset:34816
    s_waitcnt lgkmcnt(6)
    v_mfma_f32_16x16x32_bf16 v[200:203], v[240:243], v[112:115], v[200:203]
    ds_read_b64_tr_b16 v[224:225], v19 offset:36864
    v_mfma_f32_16x16x32_bf16 v[208:211], v[240:243], v[116:119], v[208:211]
    ds_read_b64_tr_b16 v[226:227], v19 offset:38912
    s_waitcnt lgkmcnt(6)
    v_mfma_f32_16x16x32_bf16 v[204:207], v[244:247], v[112:115], v[204:207]
    ds_read_b64_tr_b16 v[228:229], v20 offset:36864
    v_mfma_f32_16x16x32_bf16 v[212:215], v[244:247], v[116:119], v[212:215]
    ds_read_b64_tr_b16 v[230:231], v20 offset:38912
    s_waitcnt vmcnt(8)
    s_barrier
    s_waitcnt lgkmcnt(6)
    v_mfma_f32_16x16x32_bf16 v[168:171], v[216:219], v[136:139], v[168:171]
    ds_read_b128 v[152:155], v9 offset:0
    ds_read_b128 v[156:159], v9 offset:1024
    v_mfma_f32_16x16x32_bf16 v[176:179], v[216:219], v[140:143], v[176:179]
    ds_read_b64_tr_b16 v[232:233], v17 offset:0
    ds_read_b64_tr_b16 v[234:235], v17 offset:2048
    s_add_u32 m0, s18, 57344
    s_add_u32 s48, s51, 221440
    buffer_load_dwordx4 v3, s[24:27], s48 offen lds
    s_waitcnt lgkmcnt(8)
    v_mfma_f32_16x16x32_bf16 v[172:175], v[220:223], v[136:139], v[172:175]
    ds_read_b64_tr_b16 v[236:237], v18 offset:0
    v_mfma_f32_16x16x32_bf16 v[180:183], v[220:223], v[140:143], v[180:183]
    ds_read_b64_tr_b16 v[238:239], v18 offset:2048
    s_waitcnt lgkmcnt(8)
    v_mfma_f32_16x16x32_bf16 v[168:171], v[224:227], v[144:147], v[168:171]
    ds_read_b64_tr_b16 v[240:241], v17 offset:4096
    v_mfma_f32_16x16x32_bf16 v[176:179], v[224:227], v[148:151], v[176:179]
    ds_read_b64_tr_b16 v[242:243], v17 offset:6144
    s_waitcnt lgkmcnt(8)
    v_mfma_f32_16x16x32_bf16 v[172:175], v[228:231], v[144:147], v[172:175]
    ds_read_b64_tr_b16 v[244:245], v18 offset:4096
    v_mfma_f32_16x16x32_bf16 v[180:183], v[228:231], v[148:151], v[180:183]
    ds_read_b64_tr_b16 v[246:247], v18 offset:6144
    s_waitcnt lgkmcnt(6)
    v_mfma_f32_16x16x32_bf16 v[168:171], v[232:235], v[152:155], v[168:171]
    ds_read_b64_tr_b16 v[216:217], v17 offset:8192
    v_mfma_f32_16x16x32_bf16 v[176:179], v[232:235], v[156:159], v[176:179]
    ds_read_b64_tr_b16 v[218:219], v17 offset:10240
    s_add_u32 m0, s18, 65536
    s_add_u32 s48, s52, 256
    buffer_load_dwordx4 v3, s[24:27], s48 offen lds
    s_waitcnt lgkmcnt(6)
    v_mfma_f32_16x16x32_bf16 v[172:175], v[236:239], v[152:155], v[172:175]
    ds_read_b64_tr_b16 v[220:221], v18 offset:8192
    v_mfma_f32_16x16x32_bf16 v[180:183], v[236:239], v[156:159], v[180:183]
    ds_read_b64_tr_b16 v[222:223], v18 offset:10240
    s_waitcnt lgkmcnt(6)
    s_waitcnt vmcnt(8)
    v_mfma_f32_16x16x32_bf16 v[168:171], v[240:243], v[160:163], v[168:171]
    ds_read_b64_tr_b16 v[224:225], v17 offset:12288
    s_waitcnt vmcnt(6)
    v_mfma_f32_16x16x32_bf16 v[176:179], v[240:243], v[164:167], v[176:179]
    ds_read_b64_tr_b16 v[226:227], v17 offset:14336
    s_waitcnt lgkmcnt(6)
    v_mfma_f32_16x16x32_bf16 v[172:175], v[244:247], v[160:163], v[172:175]
    ds_read_b64_tr_b16 v[228:229], v18 offset:12288
    v_mfma_f32_16x16x32_bf16 v[180:183], v[244:247], v[164:167], v[180:183]
    ds_read_b64_tr_b16 v[230:231], v18 offset:14336
    s_waitcnt lgkmcnt(6)
    v_mfma_f32_16x16x32_bf16 v[184:187], v[216:219], v[136:139], v[184:187]
    ds_read_b64_tr_b16 v[232:233], v17 offset:16384
    v_mfma_f32_16x16x32_bf16 v[192:195], v[216:219], v[140:143], v[192:195]
    ds_read_b64_tr_b16 v[234:235], v17 offset:18432
    s_add_u32 m0, s18, 73728
    s_add_u32 s48, s50, 384
    buffer_load_dwordx4 v3, s[24:27], s48 offen lds
    s_waitcnt lgkmcnt(6)
    v_mfma_f32_16x16x32_bf16 v[188:191], v[220:223], v[136:139], v[188:191]
    ds_read_b64_tr_b16 v[236:237], v18 offset:16384
    v_mfma_f32_16x16x32_bf16 v[196:199], v[220:223], v[140:143], v[196:199]
    ds_read_b64_tr_b16 v[238:239], v18 offset:18432
    v_cvt_pk_bf16_f32 v168, v168, v169
    v_cvt_pk_bf16_f32 v169, v170, v171
    v_cvt_pk_bf16_f32 v170, v172, v173
    v_cvt_pk_bf16_f32 v171, v174, v175
    v_min_u32 v168, -2, v168
    v_min_u32 v169, -2, v169
    v_min_u32 v170, -2, v170
    v_min_u32 v171, -2, v171
    s_add_u32 s49, s47, 0
    s_not_b64 exec, s[4:5]
    buffer_store_dwordx4 v[168:171], v4, s[32:35], s49 offen sc1
    s_mov_b64 exec, s[4:5]
    ds_write_b128 v12, v[168:171] offset:0
    s_mov_b64 exec, -1
    s_waitcnt lgkmcnt(7)
    v_mfma_f32_16x16x32_bf16 v[184:187], v[224:227], v[144:147], v[184:187]
    ds_read_b64_tr_b16 v[240:241], v17 offset:20480
    v_mfma_f32_16x16x32_bf16 v[192:195], v[224:227], v[148:151], v[192:195]
    ds_read_b64_tr_b16 v[242:243], v17 offset:22528
    v_cvt_pk_bf16_f32 v176, v176, v177
    v_cvt_pk_bf16_f32 v177, v178, v179
    v_cvt_pk_bf16_f32 v178, v180, v181
    v_cvt_pk_bf16_f32 v179, v182, v183
    v_min_u32 v176, -2, v176
    v_min_u32 v177, -2, v177
    v_min_u32 v178, -2, v178
    v_min_u32 v179, -2, v179
    s_add_u32 s49, s47, 18432
    s_not_b64 exec, s[6:7]
    buffer_store_dwordx4 v[176:179], v4, s[32:35], s49 offen sc1
    s_mov_b64 exec, s[6:7]
    ds_write_b128 v12, v[176:179] offset:0
    s_mov_b64 exec, -1
    s_waitcnt lgkmcnt(8)
    v_mfma_f32_16x16x32_bf16 v[188:191], v[228:231], v[144:147], v[188:191]
    ds_read_b64_tr_b16 v[244:245], v18 offset:20480
    v_mfma_f32_16x16x32_bf16 v[196:199], v[228:231], v[148:151], v[196:199]
    ds_read_b64_tr_b16 v[246:247], v18 offset:22528
    s_waitcnt vmcnt(6)
    s_waitcnt lgkmcnt(2)
    s_barrier
    v_mfma_f32_16x16x32_bf16 v[184:187], v[232:235], v[152:155], v[184:187]
    ds_read_b64_tr_b16 v[216:217], v17 offset:24576
    v_mfma_f32_16x16x32_bf16 v[192:195], v[232:235], v[156:159], v[192:195]
    ds_read_b64_tr_b16 v[218:219], v17 offset:26624
    s_add_u32 m0, s18, 81920
    s_add_u32 s48, s50, 74112
    buffer_load_dwordx4 v3, s[24:27], s48 offen lds
    v_mfma_f32_16x16x32_bf16 v[188:191], v[236:239], v[152:155], v[188:191]
    ds_read_b64_tr_b16 v[220:221], v18 offset:24576
    v_mfma_f32_16x16x32_bf16 v[196:199], v[236:239], v[156:159], v[196:199]
    ds_read_b64_tr_b16 v[222:223], v18 offset:26624
    v_mfma_f32_16x16x32_bf16 v[184:187], v[240:243], v[160:163], v[184:187]
    ds_read_b64_tr_b16 v[224:225], v17 offset:28672
    v_mfma_f32_16x16x32_bf16 v[192:195], v[240:243], v[164:167], v[192:195]
    ds_read_b64_tr_b16 v[226:227], v17 offset:30720
    s_waitcnt lgkmcnt(6)
    v_mfma_f32_16x16x32_bf16 v[188:191], v[244:247], v[160:163], v[188:191]
    ds_read_b64_tr_b16 v[228:229], v18 offset:28672
    v_mfma_f32_16x16x32_bf16 v[196:199], v[244:247], v[164:167], v[196:199]
    ds_read_b64_tr_b16 v[230:231], v18 offset:30720
    s_waitcnt lgkmcnt(6)
    v_mfma_f32_16x16x32_bf16 v[200:203], v[216:219], v[120:123], v[200:203]
    ds_read_b64_tr_b16 v[232:233], v17 offset:32768
    v_mfma_f32_16x16x32_bf16 v[208:211], v[216:219], v[124:127], v[208:211]
    ds_read_b64_tr_b16 v[234:235], v17 offset:34816
    s_add_u32 m0, s18, 0
    s_add_u32 s48, s50, 147840
    buffer_load_dwordx4 v3, s[24:27], s48 offen lds
    s_waitcnt lgkmcnt(6)
    v_mfma_f32_16x16x32_bf16 v[204:207], v[220:223], v[120:123], v[204:207]
    ds_read_b64_tr_b16 v[236:237], v18 offset:32768
    v_mfma_f32_16x16x32_bf16 v[212:215], v[220:223], v[124:127], v[212:215]
    ds_read_b64_tr_b16 v[238:239], v18 offset:34816
    v_cvt_pk_bf16_f32 v184, v184, v185
    v_cvt_pk_bf16_f32 v185, v186, v187
    v_cvt_pk_bf16_f32 v186, v188, v189
    v_cvt_pk_bf16_f32 v187, v190, v191
    v_min_u32 v184, -2, v184
    v_min_u32 v185, -2, v185
    v_min_u32 v186, -2, v186
    v_min_u32 v187, -2, v187
    s_add_u32 s49, s47, 2048
    s_not_b64 exec, s[4:5]
    buffer_store_dwordx4 v[184:187], v4, s[32:35], s49 offen sc1
    s_mov_b64 exec, s[4:5]
    ds_write_b128 v12, v[184:187] offset:16384
    s_mov_b64 exec, -1
    s_waitcnt lgkmcnt(7)
    v_mfma_f32_16x16x32_bf16 v[200:203], v[224:227], v[128:131], v[200:203]
    ds_read_b64_tr_b16 v[240:241], v17 offset:36864
    v_mfma_f32_16x16x32_bf16 v[208:211], v[224:227], v[132:135], v[208:211]
    ds_read_b64_tr_b16 v[242:243], v17 offset:38912
    v_cvt_pk_bf16_f32 v192, v192, v193
    v_cvt_pk_bf16_f32 v193, v194, v195
    v_cvt_pk_bf16_f32 v194, v196, v197
    v_cvt_pk_bf16_f32 v195, v198, v199
    v_min_u32 v192, -2, v192
    v_min_u32 v193, -2, v193
    v_min_u32 v194, -2, v194
    v_min_u32 v195, -2, v195
    s_add_u32 s49, s47, 20480
    s_not_b64 exec, s[6:7]
    buffer_store_dwordx4 v[192:195], v4, s[32:35], s49 offen sc1
    s_mov_b64 exec, s[6:7]
    ds_write_b128 v12, v[192:195] offset:16384
    s_mov_b64 exec, -1
    s_waitcnt lgkmcnt(8)
    v_mfma_f32_16x16x32_bf16 v[204:207], v[228:231], v[128:131], v[204:207]
    ds_read_b64_tr_b16 v[244:245], v18 offset:36864
    v_mfma_f32_16x16x32_bf16 v[212:215], v[228:231], v[132:135], v[212:215]
    ds_read_b64_tr_b16 v[246:247], v18 offset:38912
    s_waitcnt lgkmcnt(8)
    v_mfma_f32_16x16x32_bf16 v[200:203], v[232:235], v[24:27], v[200:203]
    ds_read_b64_tr_b16 v[216:217], v17 offset:40960
    v_mfma_f32_16x16x32_bf16 v[208:211], v[232:235], v[28:31], v[208:211]
    ds_read_b64_tr_b16 v[218:219], v17 offset:43008
    s_add_u32 m0, s18, 8192
    s_add_u32 s48, s50, 221568
    buffer_load_dwordx4 v3, s[24:27], s48 offen lds
    s_waitcnt lgkmcnt(8)
    v_mfma_f32_16x16x32_bf16 v[204:207], v[236:239], v[24:27], v[204:207]
    ds_read_b64_tr_b16 v[220:221], v18 offset:40960
    v_mfma_f32_16x16x32_bf16 v[212:215], v[236:239], v[28:31], v[212:215]
    ds_read_b64_tr_b16 v[222:223], v18 offset:43008
    s_waitcnt lgkmcnt(7)
    v_mfma_f32_16x16x32_bf16 v[200:203], v[240:243], v[32:35], v[200:203]
    ds_read_b64_tr_b16 v[224:225], v17 offset:45056
    v_mfma_f32_16x16x32_bf16 v[208:211], v[240:243], v[36:39], v[208:211]
    ds_read_b64_tr_b16 v[226:227], v17 offset:47104
    s_waitcnt lgkmcnt(6)
    v_mfma_f32_16x16x32_bf16 v[204:207], v[244:247], v[32:35], v[204:207]
    ds_read_b64_tr_b16 v[228:229], v18 offset:45056
    v_mfma_f32_16x16x32_bf16 v[212:215], v[244:247], v[36:39], v[212:215]
    ds_read_b64_tr_b16 v[230:231], v18 offset:47104
    s_waitcnt vmcnt(5)
    s_barrier
    v_mov_b32 v16, 4
    buffer_store_dword v16, v14, s[28:31], s56 offen sc1
    s_waitcnt lgkmcnt(6)
    v_mfma_f32_16x16x32_bf16 v[200:203], v[216:219], v[40:43], v[200:203]
    ds_read_b64_tr_b16 v[232:233], v19 offset:0
    v_mfma_f32_16x16x32_bf16 v[208:211], v[216:219], v[44:47], v[208:211]
    ds_read_b64_tr_b16 v[234:235], v19 offset:2048
    s_add_u32 m0, s18, 16384
    s_add_u32 s48, s51, 384
    buffer_load_dwordx4 v3, s[24:27], s48 offen lds
    s_waitcnt lgkmcnt(6)
    v_mfma_f32_16x16x32_bf16 v[204:207], v[220:223], v[40:43], v[204:207]
    ds_read_b64_tr_b16 v[236:237], v20 offset:0
    v_mfma_f32_16x16x32_bf16 v[212:215], v[220:223], v[44:47], v[212:215]
    ds_read_b64_tr_b16 v[238:239], v20 offset:2048
    s_waitcnt lgkmcnt(6)
    v_mfma_f32_16x16x32_bf16 v[200:203], v[224:227], v[48:51], v[200:203]
    ds_read_b64_tr_b16 v[240:241], v19 offset:4096
    v_mfma_f32_16x16x32_bf16 v[208:211], v[224:227], v[52:55], v[208:211]
    ds_read_b64_tr_b16 v[242:243], v19 offset:6144
    s_waitcnt lgkmcnt(6)
    v_mfma_f32_16x16x32_bf16 v[204:207], v[228:231], v[48:51], v[204:207]
    ds_read_b64_tr_b16 v[244:245], v20 offset:4096
    v_mfma_f32_16x16x32_bf16 v[212:215], v[228:231], v[52:55], v[212:215]
    ds_read_b64_tr_b16 v[246:247], v20 offset:6144
    s_waitcnt lgkmcnt(6)
    v_mfma_f32_16x16x32_bf16 v[200:203], v[232:235], v[56:59], v[200:203]
    ds_read_b64_tr_b16 v[216:217], v19 offset:8192
    v_mfma_f32_16x16x32_bf16 v[208:211], v[232:235], v[60:63], v[208:211]
    ds_read_b64_tr_b16 v[218:219], v19 offset:10240
    s_add_u32 m0, s18, 24576
    s_add_u32 s48, s51, 74112
    buffer_load_dwordx4 v3, s[24:27], s48 offen lds
    s_waitcnt lgkmcnt(6)
    v_mfma_f32_16x16x32_bf16 v[204:207], v[236:239], v[56:59], v[204:207]
    ds_read_b64_tr_b16 v[220:221], v20 offset:8192
    v_mfma_f32_16x16x32_bf16 v[212:215], v[236:239], v[60:63], v[212:215]
    ds_read_b64_tr_b16 v[222:223], v20 offset:10240
    s_waitcnt lgkmcnt(6)
    v_mfma_f32_16x16x32_bf16 v[200:203], v[240:243], v[64:67], v[200:203]
    ds_read_b64_tr_b16 v[224:225], v19 offset:12288
    v_mfma_f32_16x16x32_bf16 v[208:211], v[240:243], v[68:71], v[208:211]
    ds_read_b64_tr_b16 v[226:227], v19 offset:14336
    s_waitcnt lgkmcnt(6)
    v_mfma_f32_16x16x32_bf16 v[204:207], v[244:247], v[64:67], v[204:207]
    ds_read_b64_tr_b16 v[228:229], v20 offset:12288
    v_mfma_f32_16x16x32_bf16 v[212:215], v[244:247], v[68:71], v[212:215]
    ds_read_b64_tr_b16 v[230:231], v20 offset:14336
    s_waitcnt lgkmcnt(6)
    v_mfma_f32_16x16x32_bf16 v[200:203], v[216:219], v[136:139], v[200:203]
    ds_read_b64_tr_b16 v[232:233], v19 offset:16384
    v_mfma_f32_16x16x32_bf16 v[208:211], v[216:219], v[140:143], v[208:211]
    ds_read_b64_tr_b16 v[234:235], v19 offset:18432
    s_add_u32 m0, s18, 32768
    s_add_u32 s48, s51, 147840
    buffer_load_dwordx4 v3, s[24:27], s48 offen lds
    s_waitcnt lgkmcnt(6)
    v_mfma_f32_16x16x32_bf16 v[204:207], v[220:223], v[136:139], v[204:207]
    ds_read_b64_tr_b16 v[236:237], v20 offset:16384
    v_mfma_f32_16x16x32_bf16 v[212:215], v[220:223], v[140:143], v[212:215]
    ds_read_b64_tr_b16 v[238:239], v20 offset:18432
    s_waitcnt lgkmcnt(6)
    v_mfma_f32_16x16x32_bf16 v[200:203], v[224:227], v[144:147], v[200:203]
    ds_read_b64_tr_b16 v[240:241], v19 offset:20480
    v_mfma_f32_16x16x32_bf16 v[208:211], v[224:227], v[148:151], v[208:211]
    ds_read_b64_tr_b16 v[242:243], v19 offset:22528
    s_waitcnt lgkmcnt(6)
    v_mfma_f32_16x16x32_bf16 v[204:207], v[228:231], v[144:147], v[204:207]
    ds_read_b64_tr_b16 v[244:245], v20 offset:20480
    v_mfma_f32_16x16x32_bf16 v[212:215], v[228:231], v[148:151], v[212:215]
    ds_read_b64_tr_b16 v[246:247], v20 offset:22528
    s_waitcnt vmcnt(5)
    s_barrier
    v_mov_b32 v16, 5
    buffer_store_dword v16, v14, s[28:31], s56 offen sc1
    s_waitcnt lgkmcnt(6)
    v_mfma_f32_16x16x32_bf16 v[200:203], v[232:235], v[152:155], v[200:203]
    ds_read_b64_tr_b16 v[216:217], v19 offset:24576
    v_mfma_f32_16x16x32_bf16 v[208:211], v[232:235], v[156:159], v[208:211]
    ds_read_b64_tr_b16 v[218:219], v19 offset:26624
    s_add_u32 m0, s18, 40960
    s_add_u32 s48, s51, 221568
    buffer_load_dwordx4 v3, s[24:27], s48 offen lds
    s_waitcnt lgkmcnt(6)
    v_mfma_f32_16x16x32_bf16 v[204:207], v[236:239], v[152:155], v[204:207]
    ds_read_b64_tr_b16 v[220:221], v20 offset:24576
    v_mfma_f32_16x16x32_bf16 v[212:215], v[236:239], v[156:159], v[212:215]
    ds_read_b64_tr_b16 v[222:223], v20 offset:26624
    s_waitcnt lgkmcnt(6)
    v_mfma_f32_16x16x32_bf16 v[200:203], v[240:243], v[160:163], v[200:203]
    ds_read_b64_tr_b16 v[224:225], v19 offset:28672
    v_mfma_f32_16x16x32_bf16 v[208:211], v[240:243], v[164:167], v[208:211]
    ds_read_b64_tr_b16 v[226:227], v19 offset:30720
    s_waitcnt lgkmcnt(6)
    v_mfma_f32_16x16x32_bf16 v[204:207], v[244:247], v[160:163], v[204:207]
    ds_read_b64_tr_b16 v[228:229], v20 offset:28672
    v_mfma_f32_16x16x32_bf16 v[212:215], v[244:247], v[164:167], v[212:215]
    ds_read_b64_tr_b16 v[230:231], v20 offset:30720
    s_waitcnt lgkmcnt(6)
    v_mfma_f32_16x16x32_bf16 v[168:171], v[216:219], v[72:75], 0
    ds_read_b64_tr_b16 v[232:233], v19 offset:32768
    v_mfma_f32_16x16x32_bf16 v[176:179], v[216:219], v[76:79], 0
    ds_read_b64_tr_b16 v[234:235], v19 offset:34816
    s_add_u32 m0, s18, 49152
    s_add_u32 s48, s52, 384
    buffer_load_dwordx4 v3, s[24:27], s48 offen lds
    s_waitcnt lgkmcnt(6)
    v_mfma_f32_16x16x32_bf16 v[172:175], v[220:223], v[72:75], 0
    ds_read_b64_tr_b16 v[236:237], v20 offset:32768
    v_mfma_f32_16x16x32_bf16 v[180:183], v[220:223], v[76:79], 0
    ds_read_b64_tr_b16 v[238:239], v20 offset:34816
    v_cvt_pk_bf16_f32 v200, v200, v201
    v_cvt_pk_bf16_f32 v201, v202, v203
    v_cvt_pk_bf16_f32 v202, v204, v205
    v_cvt_pk_bf16_f32 v203, v206, v207
    v_min_u32 v200, -2, v200
    v_min_u32 v201, -2, v201
    v_min_u32 v202, -2, v202
    v_min_u32 v203, -2, v203
    s_add_u32 s49, s47, 4096
    s_not_b64 exec, s[4:5]
    buffer_store_dwordx4 v[200:203], v4, s[32:35], s49 offen sc1
    s_mov_b64 exec, s[4:5]
    ds_write_b128 v12, v[200:203] offset:32768
    s_mov_b64 exec, -1
    s_waitcnt lgkmcnt(7)
    v_mfma_f32_16x16x32_bf16 v[168:171], v[224:227], v[80:83], v[168:171]
    ds_read_b64_tr_b16 v[240:241], v19 offset:36864
    v_mfma_f32_16x16x32_bf16 v[176:179], v[224:227], v[84:87], v[176:179]
    ds_read_b64_tr_b16 v[242:243], v19 offset:38912
    v_cvt_pk_bf16_f32 v208, v208, v209
    v_cvt_pk_bf16_f32 v209, v210, v211
    v_cvt_pk_bf16_f32 v210, v212, v213
    v_cvt_pk_bf16_f32 v211, v214, v215
    v_min_u32 v208, -2, v208
    v_min_u32 v209, -2, v209
    v_min_u32 v210, -2, v210
    v_min_u32 v211, -2, v211
    s_add_u32 s49, s47, 22528
    s_not_b64 exec, s[6:7]
    buffer_store_dwordx4 v[208:211], v4, s[32:35], s49 offen sc1
    s_mov_b64 exec, s[6:7]
    ds_write_b128 v12, v[208:211] offset:32768
    s_mov_b64 exec, -1
    s_waitcnt lgkmcnt(8)
    v_mfma_f32_16x16x32_bf16 v[172:175], v[228:231], v[80:83], v[172:175]
    ds_read_b64_tr_b16 v[244:245], v20 offset:36864
    v_mfma_f32_16x16x32_bf16 v[180:183], v[228:231], v[84:87], v[180:183]
    ds_read_b64_tr_b16 v[246:247], v20 offset:38912
    s_waitcnt lgkmcnt(8)
    v_mfma_f32_16x16x32_bf16 v[168:171], v[232:235], v[88:91], v[168:171]
    ds_read_b64_tr_b16 v[216:217], v17 offset:0
    v_mfma_f32_16x16x32_bf16 v[176:179], v[232:235], v[92:95], v[176:179]
    ds_read_b64_tr_b16 v[218:219], v17 offset:2048
    s_add_u32 m0, s18, 57344
    s_add_u32 s48, s53, 0
    buffer_load_dwordx4 v1, s[24:27], s48 offen lds
    s_waitcnt lgkmcnt(8)
    v_mfma_f32_16x16x32_bf16 v[172:175], v[236:239], v[88:91], v[172:175]
    ds_read_b64_tr_b16 v[220:221], v18 offset:0
    v_mfma_f32_16x16x32_bf16 v[180:183], v[236:239], v[92:95], v[180:183]
    ds_read_b64_tr_b16 v[222:223], v18 offset:2048
    s_waitcnt lgkmcnt(7)
    v_mfma_f32_16x16x32_bf16 v[168:171], v[240:243], v[96:99], v[168:171]
    ds_read_b64_tr_b16 v[224:225], v17 offset:4096
    v_mfma_f32_16x16x32_bf16 v[176:179], v[240:243], v[100:103], v[176:179]
    ds_read_b64_tr_b16 v[226:227], v17 offset:6144
    s_waitcnt lgkmcnt(6)
    v_mfma_f32_16x16x32_bf16 v[172:175], v[244:247], v[96:99], v[172:175]
    ds_read_b64_tr_b16 v[228:229], v18 offset:4096
    v_mfma_f32_16x16x32_bf16 v[180:183], v[244:247], v[100:103], v[180:183]
    ds_read_b64_tr_b16 v[230:231], v18 offset:6144
    s_waitcnt vmcnt(7)
    s_barrier
    s_waitcnt lgkmcnt(6)
    v_mfma_f32_16x16x32_bf16 v[168:171], v[216:219], v[104:107], v[168:171]
    ds_read_b64_tr_b16 v[232:233], v17 offset:8192
    v_mfma_f32_16x16x32_bf16 v[176:179], v[216:219], v[108:111], v[176:179]
    ds_read_b64_tr_b16 v[234:235], v17 offset:10240
    s_add_u32 m0, s18, 65536
    s_add_u32 s48, s53, 147456
    buffer_load_dwordx4 v1, s[24:27], s48 offen lds
    s_waitcnt lgkmcnt(6)
    v_mfma_f32_16x16x32_bf16 v[172:175], v[220:223], v[104:107], v[172:175]
    ds_read_b64_tr_b16 v[236:237], v18 offset:8192
    v_mfma_f32_16x16x32_bf16 v[180:183], v[220:223], v[108:111], v[180:183]
    ds_read_b64_tr_b16 v[238:239], v18 offset:10240
    buffer_load_dword v13, v15, s[28:31], s57 offen sc1
    s_waitcnt lgkmcnt(6)
    v_mfma_f32_16x16x32_bf16 v[168:171], v[224:227], v[112:115], v[168:171]
    ds_read_b64_tr_b16 v[240:241], v17 offset:12288
    v_mfma_f32_16x16x32_bf16 v[176:179], v[224:227], v[116:119], v[176:179]
    ds_read_b64_tr_b16 v[242:243], v17 offset:14336
    s_waitcnt lgkmcnt(6)
    v_mfma_f32_16x16x32_bf16 v[172:175], v[228:231], v[112:115], v[172:175]
    ds_read_b64_tr_b16 v[244:245], v18 offset:12288
    v_mfma_f32_16x16x32_bf16 v[180:183], v[228:231], v[116:119], v[180:183]
    ds_read_b64_tr_b16 v[246:247], v18 offset:14336
    s_waitcnt lgkmcnt(6)
    v_mfma_f32_16x16x32_bf16 v[168:171], v[232:235], v[120:123], v[168:171]
    ds_read_b64_tr_b16 v[216:217], v17 offset:16384
    v_mfma_f32_16x16x32_bf16 v[176:179], v[232:235], v[124:127], v[176:179]
    ds_read_b64_tr_b16 v[218:219], v17 offset:18432
    s_add_u32 m0, s18, 73728
    s_add_u32 s48, s58, 0
    buffer_load_dwordx4 v1, s[24:27], s48 offen lds
    s_waitcnt lgkmcnt(6)
    v_mfma_f32_16x16x32_bf16 v[172:175], v[236:239], v[120:123], v[172:175]
    ds_read_b64_tr_b16 v[220:221], v18 offset:16384
    v_mfma_f32_16x16x32_bf16 v[180:183], v[236:239], v[124:127], v[180:183]
    ds_read_b64_tr_b16 v[222:223], v18 offset:18432
    s_waitcnt lgkmcnt(6)
    v_mfma_f32_16x16x32_bf16 v[168:171], v[240:243], v[128:131], v[168:171]
    ds_read_b64_tr_b16 v[224:225], v17 offset:20480
    v_mfma_f32_16x16x32_bf16 v[176:179], v[240:243], v[132:135], v[176:179]
    ds_read_b64_tr_b16 v[226:227], v17 offset:22528
    s_waitcnt lgkmcnt(6)
    v_mfma_f32_16x16x32_bf16 v[172:175], v[244:247], v[128:131], v[172:175]
    ds_read_b64_tr_b16 v[228:229], v18 offset:20480
    v_mfma_f32_16x16x32_bf16 v[180:183], v[244:247], v[132:135], v[180:183]
    ds_read_b64_tr_b16 v[230:231], v18 offset:22528
    s_waitcnt lgkmcnt(6)
    v_mfma_f32_16x16x32_bf16 v[168:171], v[216:219], v[24:27], v[168:171]
    ds_read_b64_tr_b16 v[232:233], v17 offset:24576
    v_mfma_f32_16x16x32_bf16 v[176:179], v[216:219], v[28:31], v[176:179]
    ds_read_b64_tr_b16 v[234:235], v17 offset:26624
    s_add_u32 m0, s18, 81920
    s_add_u32 s48, s58, 147456
    buffer_load_dwordx4 v1, s[24:27], s48 offen lds
    s_waitcnt lgkmcnt(6)
    v_mfma_f32_16x16x32_bf16 v[172:175], v[220:223], v[24:27], v[172:175]
    ds_read_b64_tr_b16 v[236:237], v18 offset:24576
    v_mfma_f32_16x16x32_bf16 v[180:183], v[220:223], v[28:31], v[180:183]
    ds_read_b64_tr_b16 v[238:239], v18 offset:26624
    s_waitcnt lgkmcnt(6)
    v_mfma_f32_16x16x32_bf16 v[168:171], v[224:227], v[32:35], v[168:171]
    ds_read_b64_tr_b16 v[240:241], v17 offset:28672
    v_mfma_f32_16x16x32_bf16 v[176:179], v[224:227], v[36:39], v[176:179]
    ds_read_b64_tr_b16 v[242:243], v17 offset:30720
    s_waitcnt lgkmcnt(6)
    v_mfma_f32_16x16x32_bf16 v[172:175], v[228:231], v[32:35], v[172:175]
    ds_read_b64_tr_b16 v[244:245], v18 offset:28672
    v_mfma_f32_16x16x32_bf16 v[180:183], v[228:231], v[36:39], v[180:183]
    ds_read_b64_tr_b16 v[246:247], v18 offset:30720
    s_waitcnt vmcnt(5)
    s_barrier
    v_mov_b32 v16, 6
    buffer_store_dword v16, v14, s[28:31], s56 offen sc1
    s_waitcnt lgkmcnt(6)
    v_mfma_f32_16x16x32_bf16 v[168:171], v[232:235], v[40:43], v[168:171]
    ds_read_b64_tr_b16 v[216:217], v17 offset:32768
    v_mfma_f32_16x16x32_bf16 v[176:179], v[232:235], v[44:47], v[176:179]
    ds_read_b64_tr_b16 v[218:219], v17 offset:34816
    s_add_u32 m0, s18, 0
    s_add_u32 s48, s39, 0
    buffer_load_dwordx4 v1, s[24:27], s48 offen lds
    s_waitcnt lgkmcnt(6)
    v_mfma_f32_16x16x32_bf16 v[172:175], v[236:239], v[40:43], v[172:175]
    ds_read_b64_tr_b16 v[220:221], v18 offset:32768
    v_mfma_f32_16x16x32_bf16 v[180:183], v[236:239], v[44:47], v[180:183]
    ds_read_b64_tr_b16 v[222:223], v18 offset:34816
    s_waitcnt vmcnt(4)
    v_cmp_gt_u32 vcc, s80, v13
    s_nop 0
    s_cmp_eq_u64 vcc, 0
    s_cselect_b64 s[92:93], -1, 0
    s_cselect_b32 s80, 64, s80
    s_cselect_b32 s82, 1, s82
    s_waitcnt lgkmcnt(6)
    v_mfma_f32_16x16x32_bf16 v[168:171], v[240:243], v[48:51], v[168:171]
    ds_read_b64_tr_b16 v[224:225], v17 offset:36864
    v_mfma_f32_16x16x32_bf16 v[176:179], v[240:243], v[52:55], v[176:179]
    ds_read_b64_tr_b16 v[226:227], v17 offset:38912
    s_mov_b64 exec, s[92:93]
    s_add_u32 m0, s83, 1024
    s_xor_b32 s48, s3, 1
    s_mul_i32 s48, s48, 2359296
    s_add_u32 s48, s48, s81
    buffer_load_dwordx4 v4, s[20:23], s48 offen sc1 lds
    s_add_u32 m0, s83, 2048
    s_xor_b32 s48, s3, 2
    s_mul_i32 s48, s48, 2359296
    s_add_u32 s48, s48, s81
    buffer_load_dwordx4 v4, s[20:23], s48 offen sc1 lds
    s_add_u32 m0, s83, 3072
    s_xor_b32 s48, s3, 3
    s_mul_i32 s48, s48, 2359296
    s_add_u32 s48, s48, s81
    buffer_load_dwordx4 v4, s[20:23], s48 offen sc1 lds
    s_mov_b64 exec, -1
    s_waitcnt lgkmcnt(6)
    v_mfma_f32_16x16x32_bf16 v[172:175], v[244:247], v[48:51], v[172:175]
    ds_read_b64_tr_b16 v[228:229], v18 offset:36864
    v_mfma_f32_16x16x32_bf16 v[180:183], v[244:247], v[52:55], v[180:183]
    ds_read_b64_tr_b16 v[230:231], v18 offset:38912
    s_mov_b64 exec, s[92:93]
    s_add_u32 m0, s83, 4096
    s_xor_b32 s48, s3, 4
    s_mul_i32 s48, s48, 2359296
    s_add_u32 s48, s48, s81
    buffer_load_dwordx4 v4, s[20:23], s48 offen sc1 lds
    s_add_u32 m0, s83, 5120
    s_xor_b32 s48, s3, 5
    s_mul_i32 s48, s48, 2359296
    s_add_u32 s48, s48, s81
    buffer_load_dwordx4 v4, s[20:23], s48 offen sc1 lds
    s_add_u32 m0, s83, 6144
    s_xor_b32 s48, s3, 6
    s_mul_i32 s48, s48, 2359296
    s_add_u32 s48, s48, s81
    buffer_load_dwordx4 v4, s[20:23], s48 offen sc1 lds
    s_add_u32 m0, s83, 7168
    s_xor_b32 s48, s3, 7
    s_mul_i32 s48, s48, 2359296
    s_add_u32 s48, s48, s81
    buffer_load_dwordx4 v4, s[20:23], s48 offen sc1 lds
    s_mov_b64 exec, -1
    s_waitcnt lgkmcnt(6)
    v_mfma_f32_16x16x32_bf16 v[168:171], v[216:219], v[56:59], v[168:171]
    ds_read_b64_tr_b16 v[232:233], v17 offset:40960
    v_mfma_f32_16x16x32_bf16 v[176:179], v[216:219], v[60:63], v[176:179]
    ds_read_b64_tr_b16 v[234:235], v17 offset:43008
    s_waitcnt lgkmcnt(6)
    v_mfma_f32_16x16x32_bf16 v[172:175], v[220:223], v[56:59], v[172:175]
    ds_read_b64_tr_b16 v[236:237], v18 offset:40960
    v_mfma_f32_16x16x32_bf16 v[180:183], v[220:223], v[60:63], v[180:183]
    ds_read_b64_tr_b16 v[238:239], v18 offset:43008
    s_waitcnt lgkmcnt(6)
    v_mfma_f32_16x16x32_bf16 v[168:171], v[224:227], v[64:67], v[168:171]
    ds_read_b64_tr_b16 v[240:241], v17 offset:45056
    v_mfma_f32_16x16x32_bf16 v[176:179], v[224:227], v[68:71], v[176:179]
    ds_read_b64_tr_b16 v[242:243], v17 offset:47104
    s_waitcnt lgkmcnt(6)
    v_mfma_f32_16x16x32_bf16 v[172:175], v[228:231], v[64:67], v[172:175]
    ds_read_b64_tr_b16 v[244:245], v18 offset:45056
    v_mfma_f32_16x16x32_bf16 v[180:183], v[228:231], v[68:71], v[180:183]
    ds_read_b64_tr_b16 v[246:247], v18 offset:47104
    s_waitcnt lgkmcnt(6)
    v_mfma_f32_16x16x32_bf16 v[168:171], v[232:235], v[136:139], v[168:171]
    ds_read_b64_tr_b16 v[216:217], v19 offset:0
    v_mfma_f32_16x16x32_bf16 v[176:179], v[232:235], v[140:143], v[176:179]
    ds_read_b64_tr_b16 v[218:219], v19 offset:2048
    s_waitcnt lgkmcnt(6)
    v_mfma_f32_16x16x32_bf16 v[172:175], v[236:239], v[136:139], v[172:175]
    ds_read_b64_tr_b16 v[220:221], v20 offset:0
    v_mfma_f32_16x16x32_bf16 v[180:183], v[236:239], v[140:143], v[180:183]
    ds_read_b64_tr_b16 v[222:223], v20 offset:2048
    s_waitcnt lgkmcnt(6)
    v_mfma_f32_16x16x32_bf16 v[168:171], v[240:243], v[144:147], v[168:171]
    ds_read_b64_tr_b16 v[224:225], v19 offset:4096
    v_mfma_f32_16x16x32_bf16 v[176:179], v[240:243], v[148:151], v[176:179]
    ds_read_b64_tr_b16 v[226:227], v19 offset:6144
    s_waitcnt lgkmcnt(6)
    v_mfma_f32_16x16x32_bf16 v[172:175], v[244:247], v[144:147], v[172:175]
    ds_read_b64_tr_b16 v[228:229], v20 offset:4096
    v_mfma_f32_16x16x32_bf16 v[180:183], v[244:247], v[148:151], v[180:183]
    ds_read_b64_tr_b16 v[230:231], v20 offset:6144
    s_waitcnt vmcnt(10)
    s_barrier
    s_waitcnt lgkmcnt(6)
    v_mfma_f32_16x16x32_bf16 v[168:171], v[216:219], v[152:155], v[168:171]
    ds_read_b64_tr_b16 v[232:233], v22 offset:8192
    v_mfma_f32_16x16x32_bf16 v[176:179], v[216:219], v[156:159], v[176:179]
    ds_read_b64_tr_b16 v[234:235], v22 offset:9216
    buffer_load_dword v13, v15, s[28:31], s57 offen sc1
    s_waitcnt lgkmcnt(6)
    v_mfma_f32_16x16x32_bf16 v[172:175], v[220:223], v[152:155], v[172:175]
    ds_read_b64_tr_b16 v[236:237], v22 offset:10240
    v_mfma_f32_16x16x32_bf16 v[180:183], v[220:223], v[156:159], v[180:183]
    ds_read_b64_tr_b16 v[238:239], v22 offset:11264
    s_waitcnt lgkmcnt(6)
    v_mfma_f32_16x16x32_bf16 v[168:171], v[224:227], v[160:163], v[168:171]
    ds_read_b64_tr_b16 v[240:241], v22 offset:12288
    v_mfma_f32_16x16x32_bf16 v[176:179], v[224:227], v[164:167], v[176:179]
    ds_read_b64_tr_b16 v[242:243], v22 offset:13312
    s_waitcnt lgkmcnt(6)
    v_mfma_f32_16x16x32_bf16 v[172:175], v[228:231], v[160:163], v[172:175]
    ds_read_b64_tr_b16 v[244:245], v22 offset:14336
    v_mfma_f32_16x16x32_bf16 v[180:183], v[228:231], v[164:167], v[180:183]
    ds_read_b64_tr_b16 v[246:247], v22 offset:15360
    s_waitcnt lgkmcnt(6)
    v_mfma_f32_16x16x32_bf16 v[184:187], v[232:235], v[72:75], 0
    ds_read_b64_tr_b16 v[216:217], v22 offset:16384
    v_mfma_f32_16x16x32_bf16 v[188:191], v[232:235], v[76:79], 0
    ds_read_b64_tr_b16 v[218:219], v22 offset:17408
    v_cvt_pk_bf16_f32 v168, v168, v169
    v_cvt_pk_bf16_f32 v169, v170, v171
    v_cvt_pk_bf16_f32 v170, v172, v173
    v_cvt_pk_bf16_f32 v171, v174, v175
    v_min_u32 v168, -2, v168
    v_min_u32 v169, -2, v169
    v_min_u32 v170, -2, v170
    v_min_u32 v171, -2, v171
    s_add_u32 s49, s47, 6144
    s_not_b64 exec, s[4:5]
    buffer_store_dwordx4 v[168:171], v4, s[32:35], s49 offen sc1
    s_mov_b64 exec, s[4:5]
    ds_write_b128 v12, v[168:171] offset:49152
    s_mov_b64 exec, -1
    s_waitcnt lgkmcnt(7)
    v_mfma_f32_16x16x32_bf16 v[192:195], v[236:239], v[80:83], 0
    ds_read_b64_tr_b16 v[220:221], v22 offset:18432
    v_mfma_f32_16x16x32_bf16 v[196:199], v[236:239], v[84:87], 0
    ds_read_b64_tr_b16 v[222:223], v22 offset:19456
    v_cvt_pk_bf16_f32 v176, v176, v177
    v_cvt_pk_bf16_f32 v177, v178, v179
    v_cvt_pk_bf16_f32 v178, v180, v181
    v_cvt_pk_bf16_f32 v179, v182, v183
    v_min_u32 v176, -2, v176
    v_min_u32 v177, -2, v177
    v_min_u32 v178, -2, v178
    v_min_u32 v179, -2, v179
    s_add_u32 s49, s47, 24576
    s_not_b64 exec, s[6:7]
    buffer_store_dwordx4 v[176:179], v4, s[32:35], s49 offen sc1
    s_mov_b64 exec, s[6:7]
    ds_write_b128 v12, v[176:179] offset:49152
    s_mov_b64 exec, -1
    s_waitcnt lgkmcnt(8)
    v_mfma_f32_16x16x32_bf16 v[184:187], v[240:243], v[88:91], v[184:187]
    ds_read_b64_tr_b16 v[224:225], v22 offset:20480
    v_mfma_f32_16x16x32_bf16 v[188:191], v[240:243], v[92:95], v[188:191]
    ds_read_b64_tr_b16 v[226:227], v22 offset:21504
    s_waitcnt lgkmcnt(8)
    v_mfma_f32_16x16x32_bf16 v[192:195], v[244:247], v[96:99], v[192:195]
    ds_read_b64_tr_b16 v[228:229], v22 offset:22528
    v_mfma_f32_16x16x32_bf16 v[196:199], v[244:247], v[100:103], v[196:199]
    ds_read_b64_tr_b16 v[230:231], v22 offset:23552
    s_waitcnt lgkmcnt(8)
    v_mfma_f32_16x16x32_bf16 v[184:187], v[216:219], v[104:107], v[184:187]
    ds_read_b64_tr_b16 v[232:233], v22 offset:24576
    v_mfma_f32_16x16x32_bf16 v[188:191], v[216:219], v[108:111], v[188:191]
    ds_read_b64_tr_b16 v[234:235], v22 offset:25600
    s_waitcnt lgkmcnt(7)
    v_mfma_f32_16x16x32_bf16 v[192:195], v[220:223], v[112:115], v[192:195]
    ds_read_b64_tr_b16 v[236:237], v22 offset:26624
    v_mfma_f32_16x16x32_bf16 v[196:199], v[220:223], v[116:119], v[196:199]
    ds_read_b64_tr_b16 v[238:239], v22 offset:27648
    s_waitcnt lgkmcnt(6)
    v_mfma_f32_16x16x32_bf16 v[184:187], v[224:227], v[120:123], v[184:187]
    ds_read_b64_tr_b16 v[240:241], v22 offset:28672
    v_mfma_f32_16x16x32_bf16 v[188:191], v[224:227], v[124:127], v[188:191]
    ds_read_b64_tr_b16 v[242:243], v22 offset:29696
    s_waitcnt lgkmcnt(6)
    v_mfma_f32_16x16x32_bf16 v[192:195], v[228:231], v[128:131], v[192:195]
    ds_read_b64_tr_b16 v[244:245], v22 offset:30720
    v_mfma_f32_16x16x32_bf16 v[196:199], v[228:231], v[132:135], v[196:199]
    ds_read_b64_tr_b16 v[246:247], v22 offset:31744
    s_waitcnt vmcnt(10)
    s_barrier
    s_waitcnt lgkmcnt(6)
    v_mfma_f32_16x16x32_bf16 v[184:187], v[232:235], v[24:27], v[184:187]
    ds_read_b64_tr_b16 v[216:217], v22 offset:32768
    v_mfma_f32_16x16x32_bf16 v[188:191], v[232:235], v[28:31], v[188:191]
    ds_read_b64_tr_b16 v[218:219], v22 offset:33792
    s_waitcnt lgkmcnt(6)
    v_mfma_f32_16x16x32_bf16 v[192:195], v[236:239], v[32:35], v[192:195]
    ds_read_b64_tr_b16 v[220:221], v22 offset:34816
    v_mfma_f32_16x16x32_bf16 v[196:199], v[236:239], v[36:39], v[196:199]
    ds_read_b64_tr_b16 v[222:223], v22 offset:35840
    s_waitcnt lgkmcnt(6)
    v_mfma_f32_16x16x32_bf16 v[184:187], v[240:243], v[40:43], v[184:187]
    ds_read_b64_tr_b16 v[224:225], v22 offset:36864
    v_mfma_f32_16x16x32_bf16 v[188:191], v[240:243], v[44:47], v[188:191]
    ds_read_b64_tr_b16 v[226:227], v22 offset:37888
    s_waitcnt lgkmcnt(6)
    v_mfma_f32_16x16x32_bf16 v[192:195], v[244:247], v[48:51], v[192:195]
    ds_read_b64_tr_b16 v[228:229], v22 offset:38912
    v_mfma_f32_16x16x32_bf16 v[196:199], v[244:247], v[52:55], v[196:199]
    ds_read_b64_tr_b16 v[230:231], v22 offset:39936
    s_waitcnt lgkmcnt(6)
    v_mfma_f32_16x16x32_bf16 v[184:187], v[216:219], v[56:59], v[184:187]
    ds_read_b64_tr_b16 v[232:233], v21 offset:0
    v_mfma_f32_16x16x32_bf16 v[188:191], v[216:219], v[60:63], v[188:191]
    ds_read_b64_tr_b16 v[234:235], v21 offset:1024
    s_waitcnt lgkmcnt(6)
    v_mfma_f32_16x16x32_bf16 v[192:195], v[220:223], v[64:67], v[192:195]
    ds_read_b64_tr_b16 v[236:237], v21 offset:2048
    v_mfma_f32_16x16x32_bf16 v[196:199], v[220:223], v[68:71], v[196:199]
    ds_read_b64_tr_b16 v[238:239], v21 offset:3072
    s_waitcnt lgkmcnt(6)
    v_mfma_f32_16x16x32_bf16 v[184:187], v[224:227], v[136:139], v[184:187]
    v_mfma_f32_16x16x32_bf16 v[188:191], v[224:227], v[140:143], v[188:191]
    s_waitcnt lgkmcnt(4)
    v_mfma_f32_16x16x32_bf16 v[192:195], v[228:231], v[144:147], v[192:195]
    v_mfma_f32_16x16x32_bf16 v[196:199], v[228:231], v[148:151], v[196:199]
    s_waitcnt lgkmcnt(2)
    v_mfma_f32_16x16x32_bf16 v[184:187], v[232:235], v[152:155], v[184:187]
    v_mfma_f32_16x16x32_bf16 v[188:191], v[232:235], v[156:159], v[188:191]
    s_waitcnt lgkmcnt(0)
    v_mfma_f32_16x16x32_bf16 v[192:195], v[236:239], v[160:163], v[192:195]
    v_mfma_f32_16x16x32_bf16 v[196:199], v[236:239], v[164:167], v[196:199]
    s_nop 6
    v_add_f32 v184, v184, v192
    v_add_f32 v185, v185, v193
    v_add_f32 v186, v186, v194
    v_add_f32 v187, v187, v195
    v_add_f32 v188, v188, v196
    v_add_f32 v189, v189, v197
    v_add_f32 v190, v190, v198
    v_add_f32 v191, v191, v199
    v_cvt_pk_bf16_f32 v184, v184, v185
    v_cvt_pk_bf16_f32 v185, v186, v187
    v_cvt_pk_bf16_f32 v186, v188, v189
    v_cvt_pk_bf16_f32 v187, v190, v191
    v_min_u32 v184, -2, v184
    v_min_u32 v185, -2, v185
    v_min_u32 v186, -2, v186
    v_min_u32 v187, -2, v187
    s_not_b64 exec, s[8:9]
    buffer_store_dwordx4 v[184:187], v4, s[32:35], s94 offen sc1
    s_mov_b64 exec, s[8:9]
    ds_write_b128 v11, v[184:187]
    s_mov_b64 exec, -1
    s_waitcnt lgkmcnt(0)
    s_barrier
    s_add_u32 s24, s62, 5242880
    s_addc_u32 s25, s63, 0
    s_mov_b32 s26, 2359296
    s_mov_b32 s27, 0x20000
    s_add_u32 s36, s62, 4608
    s_addc_u32 s37, s63, 0
    s_mov_b32 s38, 2304
    s_mov_b32 s39, 0x20000
    s_mov_b32 s40, s60
    s_mov_b32 s41, s61
    s_mov_b32 s42, 2359296
    s_mov_b32 s43, 0x20000
    s_lshr_b32 s45, s15, 1
    s_add_u32 s45, s45, 4
    s_cmp_eq_u32 s45, 7
    s_cselect_b32 s45, 1, s45
    s_mul_i32 s44, s13, 10
    s_add_u32 s44, s44, s15
    s_lshl_b32 s46, s14, 3
    s_lshr_b32 s47, s12, 1
    s_add_u32 s46, s46, s47
    s_lshr_b32 s50, s46, 1
    s_mul_i32 s50, s50, 1152
    s_and_b32 s51, s46, 1
    s_mul_i32 s46, s46, 18
    s_add_u32 s47, s46, s44
    s_lshl_b32 s47, s47, 10
    s_mul_i32 s48, s13, -18424
    s_lshl_b32 s49, s44, 10
    s_add_u32 s48, s48, s49
    s_add_u32 s48, s48, s47
    s_add_u32 s49, s48, 1024
    s_lshl_b32 s52, s44, 7
    s_add_u32 s53, s52, 64
    s_mul_i32 s54, s51, 1179648
    s_add_u32 s54, s54, s50
    s_lshl_b32 s55, s44, 6
    s_add_u32 s54, s54, s55
    s_add_u32 s55, s54, 32
    v_bfe_u32 v17, v4, 4, 4
    v_lshrrev_b32 v18, 8, v4
    v_lshlrev_b32 v20, 4, v18
    v_mul_u32_u24 v19, 73728, v17
    v_lshl_add_u32 v19, v18, 3, v19
    s_mov_b32 s59, 0x100000
    s_cmp_eq_u32 s82, 0
    s_cbranch_scc1 K4_dir
    buffer_load_dwordx2 v[216:217], v4, s[24:27], s48 offen
    buffer_load_dwordx2 v[218:219], v4, s[24:27], s49 offen
    buffer_load_dwordx4 v[220:223], v20, s[36:39], s52 offen
    buffer_load_dwordx4 v[224:227], v20, s[36:39], s53 offen
    v_add_u32 v9, s83, v4
    s_waitcnt vmcnt(4)
    ds_read_b128 v[24:27], v9 offset:0
    ds_read_b128 v[28:31], v9 offset:1024
    ds_read_b128 v[32:35], v9 offset:2048
    ds_read_b128 v[36:39], v9 offset:3072
    ds_read_b128 v[40:43], v9 offset:4096
    ds_read_b128 v[44:47], v9 offset:5120
    ds_read_b128 v[48:51], v9 offset:6144
    ds_read_b128 v[52:55], v9 offset:7168
    s_waitcnt lgkmcnt(0)
    s_branch K4_sum
K4_dir:
    s_waitcnt vmcnt(3)
    v_cmp_gt_u32 vcc, s45, v13
    s_cbranch_vccz K4_again
K4_spin:
    buffer_load_dword v13, v15, s[28:31], s57 offen sc1
    s_sub_u32 s59, s59, 1
    s_cbranch_scc1 K4_fin
    s_waitcnt vmcnt(0)
    v_cmp_gt_u32 vcc, s45, v13
    s_cbranch_vccnz K4_spin
K4_again:
    v_add_u32 v9, s83, v4
    ds_read_b128 v[24:27], v9
    s_xor_b32 s58, s3, 1
    s_mul_i32 s58, s58, 2359296
    s_add_u32 s58, s58, s47
    buffer_load_dwordx4 v[28:31], v4, s[20:23], s58 offen sc1
    s_xor_b32 s58, s3, 2
    s_mul_i32 s58, s58, 2359296
    s_add_u32 s58, s58, s47
    buffer_load_dwordx4 v[32:35], v4, s[20:23], s58 offen sc1
    s_xor_b32 s58, s3, 3
    s_mul_i32 s58, s58, 2359296
    s_add_u32 s58, s58, s47
    buffer_load_dwordx4 v[36:39], v4, s[20:23], s58 offen sc1
    s_xor_b32 s58, s3, 4
    s_mul_i32 s58, s58, 2359296
    s_add_u32 s58, s58, s47
    buffer_load_dwordx4 v[40:43], v4, s[20:23], s58 offen sc1
    s_xor_b32 s58, s3, 5
    s_mul_i32 s58, s58, 2359296
    s_add_u32 s58, s58, s47
    buffer_load_dwordx4 v[44:47], v4, s[20:23], s58 offen sc1
    s_xor_b32 s58, s3, 6
    s_mul_i32 s58, s58, 2359296
    s_add_u32 s58, s58, s47
    buffer_load_dwordx4 v[48:51], v4, s[20:23], s58 offen sc1
    s_xor_b32 s58, s3, 7
    s_mul_i32 s58, s58, 2359296
    s_add_u32 s58, s58, s47
    buffer_load_dwordx4 v[52:55], v4, s[20:23], s58 offen sc1
    buffer_load_dwordx2 v[216:217], v4, s[24:27], s48 offen
    buffer_load_dwordx2 v[218:219], v4, s[24:27], s49 offen
    buffer_load_dwordx4 v[220:223], v20, s[36:39], s52 offen
    buffer_load_dwordx4 v[224:227], v20, s[36:39], s53 offen
K4_sum:
    s_waitcnt lgkmcnt(0)
    v_max3_u32 v16, v24, v25, v24
    v_max3_u32 v16, v26, v27, v16
    v_lshlrev_b32 v232, 16, v24
    v_and_b32 v233, 0xffff0000, v24
    v_lshlrev_b32 v234, 16, v25
    v_and_b32 v235, 0xffff0000, v25
    v_lshlrev_b32 v236, 16, v26
    v_and_b32 v237, 0xffff0000, v26
    v_lshlrev_b32 v238, 16, v27
    v_and_b32 v239, 0xffff0000, v27
    s_waitcnt vmcnt(10)
    v_max3_u32 v16, v28, v29, v16
    v_max3_u32 v16, v30, v31, v16
    v_lshlrev_b32 v9, 16, v28
    v_and_b32 v28, 0xffff0000, v28
    v_add_f32 v232, v232, v9
    v_add_f32 v233, v233, v28
    v_lshlrev_b32 v9, 16, v29
    v_and_b32 v29, 0xffff0000, v29
    v_add_f32 v234, v234, v9
    v_add_f32 v235, v235, v29
    v_lshlrev_b32 v9, 16, v30
    v_and_b32 v30, 0xffff0000, v30
    v_add_f32 v236, v236, v9
    v_add_f32 v237, v237, v30
    v_lshlrev_b32 v9, 16, v31
    v_and_b32 v31, 0xffff0000, v31
    v_add_f32 v238, v238, v9
    v_add_f32 v239, v239, v31
    s_waitcnt vmcnt(9)
    v_max3_u32 v16, v32, v33, v16
    v_max3_u32 v16, v34, v35, v16
    v_lshlrev_b32 v9, 16, v32
    v_and_b32 v32, 0xffff0000, v32
    v_add_f32 v232, v232, v9
    v_add_f32 v233, v233, v32
    v_lshlrev_b32 v9, 16, v33
    v_and_b32 v33, 0xffff0000, v33
    v_add_f32 v234, v234, v9
    v_add_f32 v235, v235, v33
    v_lshlrev_b32 v9, 16, v34
    v_and_b32 v34, 0xffff0000, v34
    v_add_f32 v236, v236, v9
    v_add_f32 v237, v237, v34
    v_lshlrev_b32 v9, 16, v35
    v_and_b32 v35, 0xffff0000, v35
    v_add_f32 v238, v238, v9
    v_add_f32 v239, v239, v35
    s_waitcnt vmcnt(8)
    v_max3_u32 v16, v36, v37, v16
    v_max3_u32 v16, v38, v39, v16
    v_lshlrev_b32 v9, 16, v36
    v_and_b32 v36, 0xffff0000, v36
    v_add_f32 v232, v232, v9
    v_add_f32 v233, v233, v36
    v_lshlrev_b32 v9, 16, v37
    v_and_b32 v37, 0xffff0000, v37
    v_add_f32 v234, v234, v9
    v_add_f32 v235, v235, v37
    v_lshlrev_b32 v9, 16, v38
    v_and_b32 v38, 0xffff0000, v38
    v_add_f32 v236, v236, v9
    v_add_f32 v237, v237, v38
    v_lshlrev_b32 v9, 16, v39
    v_and_b32 v39, 0xffff0000, v39
    v_add_f32 v238, v238, v9
    v_add_f32 v239, v239, v39
    s_waitcnt vmcnt(7)
    v_max3_u32 v16, v40, v41, v16
    v_max3_u32 v16, v42, v43, v16
    v_lshlrev_b32 v9, 16, v40
    v_and_b32 v40, 0xffff0000, v40
    v_add_f32 v232, v232, v9
    v_add_f32 v233, v233, v40
    v_lshlrev_b32 v9, 16, v41
    v_and_b32 v41, 0xffff0000, v41
    v_add_f32 v234, v234, v9
    v_add_f32 v235, v235, v41
    v_lshlrev_b32 v9, 16, v42
    v_and_b32 v42, 0xffff0000, v42
    v_add_f32 v236, v236, v9
    v_add_f32 v237, v237, v42
    v_lshlrev_b32 v9, 16, v43
    v_and_b32 v43, 0xffff0000, v43
    v_add_f32 v238, v238, v9
    v_add_f32 v239, v239, v43
    s_waitcnt vmcnt(6)
    v_max3_u32 v16, v44, v45, v16
    v_max3_u32 v16, v46, v47, v16
    v_lshlrev_b32 v9, 16, v44
    v_and_b32 v44, 0xffff0000, v44
    v_add_f32 v232, v232, v9
    v_add_f32 v233, v233, v44
    v_lshlrev_b32 v9, 16, v45
    v_and_b32 v45, 0xffff0000, v45
    v_add_f32 v234, v234, v9
    v_add_f32 v235, v235, v45
    v_lshlrev_b32 v9, 16, v46
    v_and_b32 v46, 0xffff0000, v46
    v_add_f32 v236, v236, v9
    v_add_f32 v237, v237, v46
    v_lshlrev_b32 v9, 16, v47
    v_and_b32 v47, 0xffff0000, v47
    v_add_f32 v238, v238, v9
    v_add_f32 v239, v239, v47
    s_waitcnt vmcnt(5)
    v_max3_u32 v16, v48, v49, v16
    v_max3_u32 v16, v50, v51, v16
    v_lshlrev_b32 v9, 16, v48
    v_and_b32 v48, 0xffff0000, v48
    v_add_f32 v232, v232, v9
    v_add_f32 v233, v233, v48
    v_lshlrev_b32 v9, 16, v49
    v_and_b32 v49, 0xffff0000, v49
    v_add_f32 v234, v234, v9
    v_add_f32 v235, v235, v49
    v_lshlrev_b32 v9, 16, v50
    v_and_b32 v50, 0xffff0000, v50
    v_add_f32 v236, v236, v9
    v_add_f32 v237, v237, v50
    v_lshlrev_b32 v9, 16, v51
    v_and_b32 v51, 0xffff0000, v51
    v_add_f32 v238, v238, v9
    v_add_f32 v239, v239, v51
    s_waitcnt vmcnt(4)
    v_max3_u32 v16, v52, v53, v16
    v_max3_u32 v16, v54, v55, v16
    v_lshlrev_b32 v9, 16, v52
    v_and_b32 v52, 0xffff0000, v52
    v_add_f32 v232, v232, v9
    v_add_f32 v233, v233, v52
    v_lshlrev_b32 v9, 16, v53
    v_and_b32 v53, 0xffff0000, v53
    v_add_f32 v234, v234, v9
    v_add_f32 v235, v235, v53
    v_lshlrev_b32 v9, 16, v54
    v_and_b32 v54, 0xffff0000, v54
    v_add_f32 v236, v236, v9
    v_add_f32 v237, v237, v54
    v_lshlrev_b32 v9, 16, v55
    v_and_b32 v55, 0xffff0000, v55
    v_add_f32 v238, v238, v9
    v_add_f32 v239, v239, v55
    v_cmp_eq_u32 vcc, -1, v16
    s_sub_u32 s59, s59, 1
    s_cselect_b64 vcc, 0, vcc
    s_waitcnt vmcnt(0)
    s_cbranch_vccnz K4_again
    v_and_b32 v220, 0xffff0000, v220
    v_lshlrev_b32 v9, 16, v216
    v_fma_f32 v232, v232, v220, v9
    v_and_b32 v221, 0xffff0000, v221
    v_and_b32 v9, 0xffff0000, v216
    v_fma_f32 v233, v233, v221, v9
    v_and_b32 v222, 0xffff0000, v222
    v_lshlrev_b32 v9, 16, v217
    v_fma_f32 v234, v234, v222, v9
    v_and_b32 v223, 0xffff0000, v223
    v_and_b32 v9, 0xffff0000, v217
    v_fma_f32 v235, v235, v223, v9
    v_and_b32 v224, 0xffff0000, v224
    v_lshlrev_b32 v9, 16, v218
    v_fma_f32 v236, v236, v224, v9
    v_and_b32 v225, 0xffff0000, v225
    v_and_b32 v9, 0xffff0000, v218
    v_fma_f32 v237, v237, v225, v9
    v_and_b32 v226, 0xffff0000, v226
    v_lshlrev_b32 v9, 16, v219
    v_fma_f32 v238, v238, v226, v9
    v_and_b32 v227, 0xffff0000, v227
    v_and_b32 v9, 0xffff0000, v219
    v_fma_f32 v239, v239, v227, v9
    v_cvt_pk_bf16_f32 v240, v232, v233
    v_cvt_pk_bf16_f32 v241, v234, v235
    v_cvt_pk_bf16_f32 v242, v236, v237
    v_cvt_pk_bf16_f32 v243, v238, v239
    buffer_store_dwordx2 v[240:241], v19, s[40:43], s54 offen
    buffer_store_dwordx2 v[242:243], v19, s[40:43], s55 offen
    s_cmp_lg_u32 s15, 0
    s_cbranch_scc1 K4_fin
    s_mov_b32 s15, 1
    s_mov_b32 s83, 155648
    s_mov_b32 s59, 0x100000
    s_add_u32 s47, s46, s13
    s_add_u32 s47, s47, 8
    s_lshl_b32 s47, s47, 10
    s_mul_i32 s48, s51, 17
    s_sub_u32 s48, s46, s48
    s_lshl_b32 s48, s48, 10
    s_mul_i32 s49, s13, -16376
    s_add_u32 s48, s48, s49
    s_add_u32 s48, s48, 16384
    s_add_u32 s49, s48, 18432
    s_lshl_b32 s52, s13, 1
    s_add_u32 s52, s52, s51
    s_lshl_b32 s54, s52, 5
    s_add_u32 s54, s54, s50
    s_add_u32 s54, s54, 512
    s_add_u32 s55, s54, 1179648
    s_lshl_b32 s52, s52, 6
    s_add_u32 s52, s52, 1024
    s_mov_b32 s53, s52
    s_branch K4_again
K4_fin:
K4_end:
    s_endpgm
CODE_END:
.section .rodata,"a"
.p2align 6
.amdhsa_kernel k1_kernel
  .amdhsa_next_free_vgpr 252
  .amdhsa_next_free_sgpr 64
  .amdhsa_accum_offset 252
  .amdhsa_group_segment_fixed_size 0
  .amdhsa_kernarg_size 96
  .amdhsa_user_sgpr_count 2
  .amdhsa_user_sgpr_kernarg_segment_ptr 1
  .amdhsa_system_sgpr_workgroup_id_x 1
  .amdhsa_float_denorm_mode_32 3
  .amdhsa_float_denorm_mode_16_64 3
.end_amdhsa_kernel
.p2align 6
.amdhsa_kernel k2_kernel
  .amdhsa_next_free_vgpr 136
  .amdhsa_next_free_sgpr 48
  .amdhsa_accum_offset 136
  .amdhsa_group_segment_fixed_size 0
  .amdhsa_kernarg_size 96
  .amdhsa_user_sgpr_count 2
  .amdhsa_user_sgpr_kernarg_segment_ptr 1
  .amdhsa_system_sgpr_workgroup_id_x 1
  .amdhsa_float_denorm_mode_32 3
  .amdhsa_float_denorm_mode_16_64 3
.end_amdhsa_kernel
.p2align 6
.amdhsa_kernel k3_kernel
  .amdhsa_next_free_vgpr 164
  .amdhsa_next_free_sgpr 64
  .amdhsa_accum_offset 164
  .amdhsa_group_segment_fixed_size 0
  .amdhsa_kernarg_size 96
  .amdhsa_user_sgpr_count 2
  .amdhsa_user_sgpr_kernarg_segment_ptr 1
  .amdhsa_system_sgpr_workgroup_id_x 1
  .amdhsa_float_denorm_mode_32 3
  .amdhsa_float_denorm_mode_16_64 3
.end_amdhsa_kernel
.p2align 6
.amdhsa_kernel k4_kernel
  .amdhsa_next_free_vgpr 248
  .amdhsa_next_free_sgpr 96
  .amdhsa_accum_offset 248
  .amdhsa_group_segment_fixed_size 0
  .amdhsa_kernarg_size 96
  .amdhsa_user_sgpr_count 2
  .amdhsa_user_sgpr_kernarg_segment_ptr 1
  .amdhsa_system_sgpr_workgroup_id_x 1
  .amdhsa_float_denorm_mode_32 3
  .amdhsa_float_denorm_mode_16_64 3
.end_amdhsa_kernel
```
